```python
import torch

def _softmax(x, axis=-1):
    return torch.softmax(x, dim=axis)
def _gelu(x):
    return torch.nn.functional.gelu(x, approximate="tanh")
def _silu(x):
    return torch.nn.functional.silu(x)
def _sigmoid(x):
    return torch.sigmoid(x)
def _layernorm(x, axis=-1, eps=1e-5):
    m = x.mean(dim=axis, keepdim=True)
    v = x.var(dim=axis, keepdim=True, unbiased=False)
    return (x - m) / torch.sqrt(v + eps)
def _scatter_add(tgt, idx, src, axis=0):
    return tgt.clone().index_add_(axis, idx, src)
def _segment_sum(src, seg, n):
    out = torch.zeros((n,) + src.shape[1:], dtype=src.dtype)
    return out.index_add_(0, seg, src)
def _pad(x, pw):
    flat = tuple(v for pair in reversed(pw) for v in pair)
    return torch.nn.functional.pad(x, flat)

kernel_name = 'interleave_layers__linear_attn_block__grouped_kv_mqa__prompt'

def setup_inputs():

    _w = (lambda a: (lambda t: t.to(torch.bfloat16) if t.is_floating_point() else t)(torch.as_tensor(a)))
    def _A_setup():
        B, S, D = 1, 2048, 640
        return {
            "x": _w((lambda *s: torch.randn(*s, dtype=torch.bfloat16) * 0.05)(B, S, D)),
            "wqkv": _w((lambda *s: torch.randn(*s, dtype=torch.bfloat16) * 0.1)(D, 3 * D)),
            "wo": _w((lambda *s: torch.randn(*s, dtype=torch.bfloat16) * 0.05)(D, D)),
        }
    _A_in = _A_setup()

    def _B_setup():
        B, S, D, H = 1, 2048, 640, 32
        Dh = D // H
        return {
            "x": _w((lambda *s: torch.randn(*s, dtype=torch.bfloat16) * 0.05)(B, S, D)),
            "wq": _w((lambda *s: torch.randn(*s, dtype=torch.bfloat16) * 0.1)(D, H * Dh)),
            "wk": _w((lambda *s: torch.randn(*s, dtype=torch.bfloat16) * 0.1)(D, Dh)),
            "wv": _w((lambda *s: torch.randn(*s, dtype=torch.bfloat16) * 0.05)(D, Dh)),
            "wo": _w((lambda *s: torch.randn(*s, dtype=torch.bfloat16) * 0.05)(H * Dh, D)),
        }
    _B_in = _B_setup()

    return {
        "A_x": _A_in["x"],
        "A_wqkv": _A_in["wqkv"],
        "A_wo": _A_in["wo"],
        "B_x": _B_in["x"],
        "B_wq": _B_in["wq"],
        "B_wk": _B_in["wk"],
        "B_wv": _B_in["wv"],
        "B_wo": _B_in["wo"],
    }

def reference(A_x, A_wqkv, A_wo, B_x, B_wq, B_wk, B_wv, B_wo):
    def _A_ref(x, wqkv, wo):
        B, S, D = x.shape
        H = 32; Dh = D // H
        qkv = (lambda x, *d: x.permute(*d))((x @ wqkv).reshape(B, S, 3, H, Dh), 2, 0, 3, 1, 4)
        q, k, v = qkv[0], qkv[1], qkv[2]
        phi = lambda t: torch.where(t > 0, t + 1, torch.exp(t)) + 1e-6
        pq, pk = phi(q), phi(k)
        kv = torch.einsum("bhsd,bhse->bhde", pk, v)
        z = torch.einsum("bhsd->bhd", pk)
        num = torch.einsum("bhqd,bhde->bhqe", pq, kv)
        den = torch.einsum("bhqd,bhd->bhq", pq, z)[..., None] + 1e-6
        o = num / den
        return (lambda x, *d: x.permute(*d))(o, 0, 2, 1, 3).reshape(B, S, D) @ wo

    def _B_ref(x, wq, wk, wv, wo):
        B, S, D = x.shape
        H = 32
        Dh = D // H
        q = (lambda x, *d: x.permute(*d))((x @ wq).reshape(B, S, H, Dh), 0, 2, 1, 3)
        k = x @ wk
        v = x @ wv
        scores = torch.einsum("bhqd,bkd->bhqk", q, k) * (Dh ** -0.5)
        p = _softmax(scores, axis=-1)
        o = torch.einsum("bhqk,bkd->bhqd", p, v)
        return (lambda x, *d: x.permute(*d))(o, 0, 2, 1, 3).reshape(B, S, H * Dh) @ wo

    x = A_x
    x = x + _A_ref(_layernorm(x, axis=-1), A_wqkv, A_wo)
    x = x + _B_ref(_layernorm(x, axis=-1), B_wq, B_wk, B_wv, B_wo)
    x = x + _A_ref(_layernorm(x, axis=-1), A_wqkv, A_wo)
    x = x + _B_ref(_layernorm(x, axis=-1), B_wq, B_wk, B_wv, B_wo)
    return x
```

```asm
; @launch grid=(256,1,1) block=(256,1,1) lds=163840
.amdgcn_target "amdgcn-amd-amdhsa--gfx950"
.text
.globl interleave_layers__linear_attn_block__grouped_kv_mqa__prompt_kernel
.p2align 8
.type interleave_layers__linear_attn_block__grouped_kv_mqa__prompt_kernel,@function
interleave_layers__linear_attn_block__grouped_kv_mqa__prompt_kernel:
    s_cmp_ge_u32 s2, 256
    s_cbranch_scc1 L_end
    s_load_dwordx16 s[48:63], s[0:1], 0
    s_load_dwordx4 s[64:67], s[0:1], 64
    s_load_dwordx2 s[68:69], s[0:1], 80
    v_and_b32 v1, 63, v0
    v_lshrrev_b32 v22, 6, v0
    v_and_b32 v2, 15, v0
    v_readfirstlane_b32 s71, v22
    v_lshrrev_b32 v3, 4, v1
    v_lshlrev_b32 v4, 4, v1
    s_and_b32 s72, s2, 7
    s_lshr_b32 s76, s2, 3
    s_getpc_b64 s[96:97]
L_pc:
    s_lshl_b32 s95, s76, 2
    s_add_u32 s95, s95, s71
    s_mul_i32 s95, s95, (L_codeend - L_pc + 127*128)/(128*128)*128
    v_min_u32 v23, (L_codeend - L_pc + 127*128)/(128*128) - 1, v1
    v_lshlrev_b32 v23, 7, v23
    v_add_u32 v23, s95, v23
    v_min_u32 v23, L_codeend - L_pc - 4, v23
    global_load_dword v203, v23, s[96:97]
    s_lshr_b32 s73, s76, 4
    s_and_b32 s74, s76, 15
    s_lshr_b32 s75, s76, 3
    s_and_b32 s76, s76, 7
    s_lshl_b32 s81, s72, 4
    s_lshl_b32 s80, s73, 3
    s_add_u32 s80, s80, s81
    s_lshl_b32 s94, s71, 1
    s_add_u32 s80, s80, s94
    s_lshl_b32 s94, s75, 2
    s_add_u32 s81, s81, s94
    s_add_u32 s81, s81, s71
    s_lshr_b32 s94, s71, 1
    s_mul_i32 s95, s81, 20480
    s_mul_i32 s96, s76, 160
    s_add_u32 s95, s95, s96
    s_waitcnt lgkmcnt(0)
    s_mov_b32 s4, s48
    s_and_b32 s5, s49, 0xffff
    s_mov_b32 s6, 2621440
    s_mov_b32 s7, 0x00020000
    v_mul_u32_u24 v24, 1280, v2
    v_lshl_add_u32 v24, v3, 3, v24
    buffer_load_dwordx2 a[246:247], v24, s[4:7], s95 offen offset:0
    buffer_load_dwordx2 a[248:249], v24, s[4:7], s95 offen offset:32
    buffer_load_dwordx2 a[250:251], v24, s[4:7], s95 offen offset:64
    buffer_load_dwordx2 a[252:253], v24, s[4:7], s95 offen offset:96
    buffer_load_dwordx2 a[254:255], v24, s[4:7], s95 offen offset:128
    s_mov_b32 s40, s68
    s_and_b32 s41, s69, 0xffff
    s_mov_b32 s42, 268435456
    s_mov_b32 s43, 0x00020000
    s_mov_b32 s36, s64
    s_and_b32 s37, s65, 0xffff
    s_mov_b32 s38, 2621440
    s_mov_b32 s39, 0x00020000
    s_load_dword s70, s[68:69], 0
    s_lshr_b32 s19, s2, 3
    s_mov_b32 s28, 256
    s_mov_b32 s29, 256
    s_cmp_ge_u32 s19, 15
    s_cbranch_scc1 L_rp_b
    s_add_u32 s93, s2, 40
    s_cmp_ge_u32 s93, 120
    s_cselect_b32 s20, 120, 0
    s_sub_u32 s93, s93, s20
    s_mov_b32 s44, s50
    s_and_b32 s45, s51, 0xffff
    s_mov_b32 s46, 2457600
    s_mov_b32 s47, 0x00020000
    s_and_b32 s10, s93, 3
    s_lshr_b32 s19, s93, 2
    s_lshl_b32 s9, s19, 7
    s_mov_b32 s12, 8
    s_mov_b32 s13, 16
    s_mov_b32 s14, 2
    s_mov_b32 s15, 8
    s_mov_b32 s16, 4
    s_mov_b32 s17, 64
    s_lshr_b32 s23, s10, 1
    s_lshl_b32 s18, s10, 5
    s_lshl_b32 s69, s23, 4
    s_add_u32 s18, s18, s69
    s_mov_b32 s8, 3840
    s_lshl_b32 s19, s19, 3
    s_lshl_b32 s69, s71, 1
    s_add_u32 s19, s19, s69
    s_mul_i32 s20, s19, 205
    s_lshr_b32 s20, s20, 14
    s_mul_i32 s21, s20, 80
    s_sub_u32 s19, s19, s21
    s_cmp_eq_u32 s20, 0
    s_cselect_b32 s11, 1, 2
    s_mul_i32 s11, s11, 2560
    s_mul_i32 s21, s19, 205
    s_lshr_b32 s21, s21, 10
    s_mul_i32 s22, s21, 5
    s_sub_u32 s22, s19, s22
    s_cmp_eq_u32 s20, 2
    s_cselect_b32 s23, 5, 0
    s_add_u32 s22, s22, s23
    s_cmp_eq_u32 s20, 0
    s_cselect_b32 s23, 10, 0
    s_add_u32 s22, s22, s23
    s_cmp_eq_u32 s22, 14
    s_cselect_b32 s28, 128, s28
    s_lshr_b32 s23, s22, 1
    s_and_b32 s22, s22, 1
    s_mul_i32 s24, s21, 153600
    s_lshl_b32 s69, s23, 10
    s_add_u32 s24, s24, s69
    s_lshl_b32 s69, s22, 7
    s_add_u32 s24, s24, s69
    s_lshl_b32 s26, s21, 12
    s_lshl_b32 s69, s23, 9
    s_add_u32 s26, s26, s69
    s_lshl_b32 s69, s22, 6
    s_add_u32 s26, s26, s69
    s_cmp_eq_u32 s20, 0
    s_cselect_b32 s23, 97280, 0
    s_add_u32 s24, s24, s23
    s_add_u32 s19, s19, 1
    s_mul_i32 s21, s19, 205
    s_lshr_b32 s21, s21, 10
    s_mul_i32 s22, s21, 5
    s_sub_u32 s22, s19, s22
    s_cmp_eq_u32 s20, 2
    s_cselect_b32 s23, 5, 0
    s_add_u32 s22, s22, s23
    s_cmp_eq_u32 s20, 0
    s_cselect_b32 s23, 10, 0
    s_add_u32 s22, s22, s23
    s_cmp_eq_u32 s22, 14
    s_cselect_b32 s29, 128, s29
    s_lshr_b32 s23, s22, 1
    s_and_b32 s22, s22, 1
    s_mul_i32 s25, s21, 153600
    s_lshl_b32 s69, s23, 10
    s_add_u32 s25, s25, s69
    s_lshl_b32 s69, s22, 7
    s_add_u32 s25, s25, s69
    s_lshl_b32 s27, s21, 12
    s_lshl_b32 s69, s23, 9
    s_add_u32 s27, s27, s69
    s_lshl_b32 s69, s22, 6
    s_add_u32 s27, s27, s69
    s_cmp_eq_u32 s20, 0
    s_cselect_b32 s23, 97280, 0
    s_add_u32 s25, s25, s23
    s_mov_b32 s62, 0
    s_mov_b32 s58, 1
    s_branch L_rp_go
L_rp_b:
    s_sub_u32 s19, s2, 120
    s_cmp_ge_u32 s19, 120
    s_cbranch_scc1 L_rp_u
    s_add_u32 s93, s19, 120
    s_and_b32 s10, s19, 3
    s_lshr_b32 s19, s19, 2
    s_lshl_b32 s20, s19, 2
    s_add_u32 s20, s20, s71
    s_mul_i32 s21, s20, 205
    s_lshr_b32 s21, s21, 10
    s_mul_i32 s24, s21, 97280
    s_lshl_b32 s69, s20, 10
    s_add_u32 s24, s24, s69
    s_add_u32 s24, s24, 2457600
    s_lshl_b32 s26, s20, 9
    s_add_u32 s26, s26, 65536
    s_mov_b32 s8, 1280
    s_mov_b32 s11, 5120
    s_lshl_b32 s9, s19, 7
    s_cmp_ge_u32 s19, 10
    s_cbranch_scc1 L_rp_b1
    s_mov_b32 s44, s52
    s_and_b32 s45, s53, 0xffff
    s_mov_b32 s46, 819200
    s_mov_b32 s47, 0x00020000
    s_mov_b32 s12, 8
    s_mov_b32 s13, 20
    s_mov_b32 s14, 2
    s_mov_b32 s15, 40
    s_mov_b32 s16, 20
    s_mov_b32 s17, 16
    s_mul_i32 s18, s10, 40
    s_mov_b32 s62, 0
    s_branch L_rp_b3
L_rp_b1:
    s_cmp_ge_u32 s19, 20
    s_cbranch_scc1 L_rp_b2
    s_mov_b32 s44, s56
    s_and_b32 s45, s57, 0xffff
    s_mov_b32 s46, 819200
    s_mov_b32 s47, 0x00020000
    s_mov_b32 s12, 8
    s_mov_b32 s13, 16
    s_mov_b32 s14, 2
    s_mov_b32 s15, 8
    s_mov_b32 s16, 4
    s_mov_b32 s17, 64
    s_lshr_b32 s23, s10, 1
    s_lshl_b32 s18, s10, 5
    s_lshl_b32 s69, s23, 4
    s_add_u32 s18, s18, s69
    s_sub_u32 s9, s9, 1280
    s_mov_b32 s62, 0
    s_branch L_rp_b3
L_rp_b2:
    s_mov_b32 s44, s62
    s_and_b32 s45, s63, 0xffff
    s_mov_b32 s46, 819200
    s_mov_b32 s47, 0x00020000
    s_mov_b32 s12, 20
    s_mov_b32 s13, 8
    s_mov_b32 s14, 20
    s_mov_b32 s15, 40
    s_mov_b32 s16, 2
    s_mov_b32 s17, 16
    s_mul_i32 s18, s10, 40
    s_sub_u32 s9, s9, 2560
    s_mov_b32 s62, 0
    s_branch L_rp_b3
L_rp_u:
    s_and_b32 s19, s19, 7
    s_add_u32 s93, s19, 240
    s_and_b32 s10, s19, 3
    s_lshr_b32 s19, s19, 2
    s_mov_b32 s12, 8
    s_mov_b32 s13, 16
    s_mov_b32 s14, 2
    s_mov_b32 s15, 8
    s_mov_b32 s16, 4
    s_mov_b32 s17, 64
    s_lshr_b32 s23, s10, 1
    s_lshl_b32 s18, s10, 5
    s_lshl_b32 s69, s23, 4
    s_add_u32 s18, s18, s69
    s_mov_b32 s8, 40
    s_mov_b32 s11, 1024
    s_mov_b32 s9, 0
    s_lshl_b32 s20, s19, 1
    s_add_u32 s20, s20, s71
    s_mul_i32 s24, s20, 20480
    s_add_u32 s24, s24, 4915200
    s_lshl_b32 s26, s20, 9
    s_add_u32 s26, s26, 126976
    s_cmp_eq_u32 s19, 1
    s_cselect_b32 s52, s60, s58
    s_cselect_b32 s53, s61, s59
    s_mov_b32 s44, s52
    s_and_b32 s45, s53, 0xffff
    s_mov_b32 s46, 25600
    s_mov_b32 s47, 0x00020000
    s_mov_b32 s62, s94
L_rp_b3:
    s_add_u32 s25, s24, 128
    s_add_u32 s27, s26, 64
    s_mov_b32 s58, 0
L_rp_go:
    v_lshrrev_b32 v24, 3, v1
    v_and_b32 v25, 7, v1
    v_lshlrev_b32 v25, 4, v25
    v_mad_u32_u24 v18, v24, s8, v25
    v_and_b32 v19, 1, v24
    v_bfe_u32 v28, v24, 1, 1
    v_mad_u32_u24 v19, v28, s14, v19
    v_bfe_u32 v28, v24, 2, 1
    v_mad_u32_u24 v19, v28, s15, v19
    v_mad_u32_u24 v19, v19, s8, v25
    s_and_b32 s19, s71, 1
    s_mul_i32 s20, s19, s12
    s_mul_i32 s21, s94, s13
    s_add_u32 s18, s18, s20
    s_add_u32 s18, s18, s21
    s_mul_i32 s18, s18, s8
    s_add_u32 s18, s18, s9
    s_mov_b32 s64, s18
    s_mul_i32 s66, s8, 160
    s_mul_i32 s21, s94, s16
    s_mul_i32 s65, s10, 160
    s_add_u32 s65, s65, s17
    s_mul_i32 s69, s19, 80
    s_add_u32 s65, s65, s69
    s_add_u32 s65, s65, s21
    s_mul_i32 s65, s65, s8
    s_add_u32 s65, s65, s9
    s_cmp_eq_u32 s58, 0
    s_cbranch_scc1 L_rp_l0
    s_lshl_b32 s101, s71, 10
    s_add_u32 m0, s101, 51200
    s_nop 0
    buffer_load_dwordx4 v18, s[44:47], s64 offen  lds
    s_add_u32 s64, s64, s66
    s_add_u32 m0, s101, 55296
    s_nop 0
    buffer_load_dwordx4 v18, s[44:47], s64 offen  lds
    s_add_u32 s64, s64, s66
    s_add_u32 m0, s101, 59392
    s_nop 0
    buffer_load_dwordx4 v18, s[44:47], s64 offen  lds
    s_add_u32 s64, s64, s66
    s_add_u32 m0, s101, 63488
    s_nop 0
    buffer_load_dwordx4 v18, s[44:47], s64 offen  lds
    s_add_u32 m0, s101, 67584
    s_nop 0
    buffer_load_dwordx4 v19, s[44:47], s65 offen  lds
L_rp_l0:
    v_cmp_gt_u32 vcc, 8, v2
    v_mov_b32 v24, s24
    v_mov_b32 v20, s25
    v_cndmask_b32 v20, v20, v24, vcc
    v_mov_b32 v24, s26
    v_mov_b32 v21, s27
    v_cndmask_b32 v21, v21, v24, vcc
    v_mov_b32 v24, s28
    v_mov_b32 v28, s29
    v_cndmask_b32 v28, v28, v24, vcc
    v_mad_u32_u24 v20, v28, v3, v20
    v_and_b32 v28, 7, v2
    v_lshl_add_u32 v20, v28, 4, v20
    v_lshl_add_u32 v21, v28, 3, v21
    s_mul_i32 s60, s11, s10
    s_add_u32 s60, s60, 4194304
    s_lshl_b32 s59, s11, 2
    s_lshl_b32 s63, s10, 7
    s_add_u32 s63, s63, 1179648
    s_lshl_b32 s61, s93, 7
    s_add_u32 s61, s61, 1114112
    v_cmp_eq_u32 s[82:83], 0, v3
    s_mov_b32 s77, 0
    s_mov_b32 s79, 0
    s_mov_b32 s92, 2097152
    s_mov_b32 s86, 0x3fb8aa3b
    s_mov_b32 s88, 0x358637bd
    s_mov_b32 s87, 0x3fb8aa3b
    s_mov_b32 s89, 0x358637bd
    v_add_u32 v5, 51200, v4
    v_add_u32 v6, 102400, v4
    v_add_u32 v9, 20480, v4
    v_lshlrev_b32 v8, 2, v2
    v_and_b32 v24, 7, v2
    v_lshlrev_b32 v24, 4, v24
    v_lshl_add_u32 v7, v3, 7, v24
    v_add_u32 v7, 51200, v7
    v_mov_b32 v24, 0x3f803f80
    v_accvgpr_write_b32 a240, v24
    v_accvgpr_write_b32 a241, v24
    v_accvgpr_write_b32 a242, v24
    v_accvgpr_write_b32 a243, v24
    v_lshlrev_b32 v24, 3, v2
    v_accvgpr_write_b32 a202, v24
    v_lshl_add_u32 v24, v3, 8, v24
    v_accvgpr_write_b32 a203, v24
    v_lshlrev_b32 v24, 4, v2
    v_lshl_add_u32 v25, v3, 3, v24
    v_accvgpr_write_b32 a200, v25
    v_lshrrev_b32 v25, 1, v3
    v_lshl_add_u32 v25, v25, 8, v24
    v_and_b32 v26, 1, v3
    v_lshl_add_u32 v25, v26, 3, v25
    v_accvgpr_write_b32 a201, v25
    v_mul_u32_u24 v26, 20480, v26
    v_add_u32 v26, v26, v24
    v_lshrrev_b32 v25, 5, v1
    v_lshl_add_u32 v24, v25, 8, v26
    v_accvgpr_write_b32 a204, v24
    v_lshl_add_u32 v24, v25, 3, v26
    v_accvgpr_write_b32 a205, v24
    v_lshrrev_b32 v24, 4, v0
    v_sub_u32 v24, v0, v24
    v_lshlrev_b32 v25, 3, v24
    v_add_u32 v25, 157696, v25
    v_accvgpr_write_b32 a244, v25
    v_min_u32 v24, 209, v24
    v_cmp_le_u32 vcc, 105, v24
    s_nop 1
    v_cndmask_b32 v29, 0, 1, vcc
    v_mul_u32_u24 v25, 105, v29
    v_sub_u32 v24, v24, v25
    v_mul_u32_u24 v27, 205, v24
    v_lshrrev_b32 v27, 10, v27
    v_mul_u32_u24 v25, 5, v27
    v_sub_u32 v28, v24, v25
    v_mad_u32_u24 v28, v29, 5, v28
    v_mad_u32_u24 v24, v29, 20, v27
    v_add_u32 v24, 8, v24
    v_lshrrev_b32 v25, 4, v24
    v_lshrrev_b32 v26, 2, v28
    v_lshl_add_u32 v29, v26, 1, v25
    v_add_u32 v29, 2, v29
    v_subrev_u32 v25, 1, v25
    v_cmp_eq_u32 vcc, 2, v26
    s_nop 1
    v_cndmask_b32 v29, v29, v25, vcc
    v_and_b32 v24, 15, v24
    v_add_u32 v26, 7, v26
    v_cmp_eq_u32 vcc, 20, v27
    s_nop 1
    v_cndmask_b32 v29, v29, v26, vcc
    v_and_b32 v28, 3, v28
    v_lshl_add_u32 v24, v28, 4, v24
    v_lshlrev_b32 v24, 4, v24
    v_lshl_add_u32 v24, v29, 10, v24
    v_add_u32 v24, 102400, v24
    v_accvgpr_write_b32 a206, v24
    s_lshl_b32 s49, s72, 1
    s_add_u32 s49, s49, s73
    s_lshl_b32 s50, s72, 2
    s_add_u32 s50, s50, s75
    s_mul_i32 s8, s80, 20480
    s_add_u32 s8, s8, 13107200
    s_lshl_b32 s9, s80, 10
    s_add_u32 s9, s9, 2621440
    s_lshl_b32 s11, s74, 13
    s_add_u32 s11, s11, 131072
    s_lshl_b32 s10, s74, 7
    s_add_u32 s10, s10, 24576
    s_lshl_b32 s13, s74, 11
    s_add_u32 s13, s13, 1048576
    s_mov_b32 s12, s13
    s_lshl_b32 s69, s49, 7
    s_add_u32 s12, s12, s69
    s_mul_i32 s14, s80, 20480
    s_lshl_b32 s69, s74, 10
    s_add_u32 s14, s14, s69
    s_add_u32 s14, s14, 10485760
    s_lshr_b32 s51, s74, 2
    s_and_b32 s52, s74, 3
    s_mul_i32 s15, s80, 20480
    s_lshl_b32 s69, s51, 10
    s_add_u32 s15, s15, s69
    s_lshl_b32 s69, s52, 8
    s_add_u32 s15, s15, s69
    s_add_u32 s15, s15, 10502144
    s_lshl_b32 s17, s49, 7
    s_add_u32 s17, s17, 10240
    s_mov_b32 s16, s17
    s_lshl_b32 s69, s74, 2
    s_add_u32 s16, s16, s69
    s_lshl_b32 s30, s49, 7
    s_add_u32 s30, s30, 22528
    s_mov_b32 s29, s30
    s_lshl_b32 s69, s74, 2
    s_add_u32 s29, s29, s69
    s_mul_i32 s18, s81, 20480
    s_add_u32 s18, s18, 10485760
    s_mul_i32 s19, s81, 20480
    s_add_u32 s19, s19, 13107200
    s_mov_b32 s20, s19
    s_lshl_b32 s69, s76, 11
    s_add_u32 s20, s20, s69
    s_lshr_b32 s51, s76, 1
    s_and_b32 s52, s76, 1
    s_mov_b32 s21, s19
    s_lshl_b32 s69, s51, 10
    s_add_u32 s21, s21, s69
    s_lshl_b32 s69, s52, 9
    s_add_u32 s21, s21, s69
    s_add_u32 s21, s21, 16384
    s_lshl_b32 s23, s81, 10
    s_add_u32 s23, s23, 2621440
    s_mov_b32 s22, s23
    s_lshl_b32 s69, s76, 7
    s_add_u32 s22, s22, s69
    s_lshl_b32 s25, s50, 7
    s_add_u32 s25, s25, 12288
    s_mov_b32 s24, s25
    s_lshl_b32 s69, s76, 2
    s_add_u32 s24, s24, s69
    s_lshl_b32 s28, s50, 7
    s_add_u32 s28, s28, 18432
    s_mov_b32 s27, s28
    s_lshl_b32 s69, s76, 2
    s_add_u32 s27, s27, s69
    s_lshl_b32 s26, s50, 7
    s_lshl_b32 s69, s76, 2
    s_add_u32 s26, s26, s69
    s_add_u32 s26, s26, 1081344
    s_and_b32 s53, s71, 1
    s_mul_i32 s31, s50, 81920
    s_mul_i32 s69, s53, 40960
    s_add_u32 s31, s31, s69
    s_add_u32 s31, s31, 10485760
    s_mov_b32 s32, s31
    s_lshl_b32 s69, s51, 10
    s_add_u32 s32, s32, s69
    s_lshl_b32 s69, s52, 9
    s_add_u32 s32, s32, s69
    s_lshl_b32 s69, s94, 8
    s_add_u32 s32, s32, s69
    s_add_u32 s32, s32, 16384
    s_lshl_b32 s69, s76, 11
    s_add_u32 s31, s31, s69
    s_lshl_b32 s69, s94, 10
    s_add_u32 s31, s31, s69
    s_mul_i32 s33, s76, 102400
    s_mul_i32 s34, s74, 153600
    v_lshlrev_b32 v24, 5, v2
    v_lshl_add_u32 v24, v3, 3, v24
    v_accvgpr_write_b32 a207, v24
    v_mov_b32 v25, 0x73625410
    v_lshrrev_b32 v25, v8, v25
    v_and_b32 v25, 15, v25
    v_cmp_gt_u32 vcc, 8, v2
    s_nop 1
    v_cndmask_b32 v25, v2, v25, vcc
    v_add_u32 v25, 16, v25
    v_lshlrev_b32 v25, 5, v25
    v_lshl_add_u32 v25, v3, 3, v25
    v_lshlrev_b32 v24, 4, v2
    s_cmp_lt_u32 s76, 4
    s_cselect_b64 vcc, -1, 0
    v_cndmask_b32 v25, v25, v24, vcc
    v_accvgpr_write_b32 a215, v25
    s_lshl_b32 s97, s81, 10
    s_add_u32 s97, s97, 131072
    s_lshl_b32 s51, s81, 9
    s_lshl_b32 s52, s50, 9
    s_lshl_b32 s69, s53, 8
    s_add_u32 s52, s52, s69
    s_lshl_b32 s69, s94, 3
    s_add_u32 s52, s52, s69
    s_add_u32 s52, s52, 65536
    s_cmp_lt_u32 s76, 4
    s_cselect_b32 s35, s51, s97
    s_cselect_b32 s97, s52, s97
    s_waitcnt lgkmcnt(0)
    s_add_u32 s78, s70, 1
    s_mov_b32 s70, s78
    s_getreg_b32 s3, hwreg(HW_REG_XCC_ID, 0, 4)
    v_mov_b32 v24, s78
    v_mov_b32 v25, s3
    s_lshr_b32 s51, s2, 3
    s_lshl_b32 s51, s51, 7
    s_lshl_b32 s69, s72, 12
    s_add_u32 s51, s51, s69
    s_add_u32 s51, s51, 1146880
    s_mov_b64 exec, 1
    buffer_store_dwordx2 v[24:25], off, s[40:43], s51 sc1
    s_mov_b64 exec, -1
    v_mov_b32 v112, 0
    v_mov_b32 v113, 0
    v_mov_b32 v114, 0
    v_mov_b32 v115, 0
    v_mov_b32 v116, 0
    v_mov_b32 v117, 0
    v_mov_b32 v118, 0
    v_mov_b32 v119, 0
    v_mov_b32 v120, 0
    v_mov_b32 v121, 0
    v_mov_b32 v122, 0
    v_mov_b32 v123, 0
    v_mov_b32 v124, 0
    v_mov_b32 v125, 0
    v_mov_b32 v126, 0
    v_mov_b32 v127, 0
    v_mov_b32 v128, 0
    v_mov_b32 v129, 0
    v_mov_b32 v130, 0
    v_mov_b32 v131, 0
    s_and_b32 s67, s2, 0x87
    s_cbranch_scc1 L_noz
    v_lshlrev_b32 v24, 4, v0
    s_add_u32 s51, s11, 4096
    buffer_store_dwordx4 v[112:115], v24, s[40:43], s11 offen sc1
    buffer_store_dwordx4 v[112:115], v24, s[40:43], s51 offen sc1
L_noz:
    s_waitcnt vmcnt(6)
    s_cmp_lg_u32 s58, 0
    s_cbranch_scc1 L_rp_l1
    s_waitcnt vmcnt(1)
L_rp_l1:
    v_accvgpr_read_b32 v30, a201
    v_accvgpr_read_b32 v31, a202
    v_accvgpr_read_b32 v150, a246
    v_accvgpr_read_b32 v151, a247
    v_accvgpr_read_b32 v152, a248
    v_accvgpr_read_b32 v153, a249
    v_accvgpr_read_b32 v154, a250
    v_accvgpr_read_b32 v155, a251
    v_accvgpr_read_b32 v156, a252
    v_accvgpr_read_b32 v157, a253
    v_accvgpr_read_b32 v158, a254
    v_accvgpr_read_b32 v159, a255
    v_lshlrev_b32 v24, 16, v150
    v_and_b32 v25, 0xffff0000, v150
    v_pk_add_f32 v[112:113], v[112:113], v[24:25]
    v_cvt_pk_bf16_f32 v150, v112, v113
    v_lshlrev_b32 v26, 16, v151
    v_and_b32 v27, 0xffff0000, v151
    v_pk_add_f32 v[114:115], v[114:115], v[26:27]
    v_cvt_pk_bf16_f32 v151, v114, v115
    v_lshlrev_b32 v24, 16, v152
    v_and_b32 v25, 0xffff0000, v152
    v_pk_add_f32 v[116:117], v[116:117], v[24:25]
    v_cvt_pk_bf16_f32 v152, v116, v117
    v_lshlrev_b32 v26, 16, v153
    v_and_b32 v27, 0xffff0000, v153
    v_pk_add_f32 v[118:119], v[118:119], v[26:27]
    v_cvt_pk_bf16_f32 v153, v118, v119
    v_lshlrev_b32 v24, 16, v154
    v_and_b32 v25, 0xffff0000, v154
    v_pk_add_f32 v[120:121], v[120:121], v[24:25]
    v_cvt_pk_bf16_f32 v154, v120, v121
    v_lshlrev_b32 v26, 16, v155
    v_and_b32 v27, 0xffff0000, v155
    v_pk_add_f32 v[122:123], v[122:123], v[26:27]
    v_cvt_pk_bf16_f32 v155, v122, v123
    v_lshlrev_b32 v24, 16, v156
    v_and_b32 v25, 0xffff0000, v156
    v_pk_add_f32 v[124:125], v[124:125], v[24:25]
    v_cvt_pk_bf16_f32 v156, v124, v125
    v_lshlrev_b32 v26, 16, v157
    v_and_b32 v27, 0xffff0000, v157
    v_pk_add_f32 v[126:127], v[126:127], v[26:27]
    v_cvt_pk_bf16_f32 v157, v126, v127
    v_lshlrev_b32 v24, 16, v158
    v_and_b32 v25, 0xffff0000, v158
    v_pk_add_f32 v[128:129], v[128:129], v[24:25]
    v_cvt_pk_bf16_f32 v158, v128, v129
    v_lshlrev_b32 v26, 16, v159
    v_and_b32 v27, 0xffff0000, v159
    v_pk_add_f32 v[130:131], v[130:131], v[26:27]
    v_cvt_pk_bf16_f32 v159, v130, v131
    buffer_store_dwordx4 v[150:153], v4, s[40:43], s20 offen sc1
    buffer_store_dwordx4 v[154:157], v4, s[40:43], s20 offen offset:1024 sc1
    buffer_store_dwordx2 v[158:159], v30, s[40:43], s21 offen sc1
    v_pk_add_f32 v[24:25], v[112:113], v[114:115]
    v_pk_mul_f32 v[26:27], v[112:113], v[112:113]
    v_pk_fma_f32 v[26:27], v[114:115], v[114:115], v[26:27]
    v_pk_add_f32 v[24:25], v[24:25], v[116:117]
    v_pk_fma_f32 v[26:27], v[116:117], v[116:117], v[26:27]
    v_pk_add_f32 v[24:25], v[24:25], v[118:119]
    v_pk_fma_f32 v[26:27], v[118:119], v[118:119], v[26:27]
    v_pk_add_f32 v[24:25], v[24:25], v[120:121]
    v_pk_fma_f32 v[26:27], v[120:121], v[120:121], v[26:27]
    v_pk_add_f32 v[24:25], v[24:25], v[122:123]
    v_pk_fma_f32 v[26:27], v[122:123], v[122:123], v[26:27]
    v_pk_add_f32 v[24:25], v[24:25], v[124:125]
    v_pk_fma_f32 v[26:27], v[124:125], v[124:125], v[26:27]
    v_pk_add_f32 v[24:25], v[24:25], v[126:127]
    v_pk_fma_f32 v[26:27], v[126:127], v[126:127], v[26:27]
    v_pk_add_f32 v[24:25], v[24:25], v[128:129]
    v_pk_fma_f32 v[26:27], v[128:129], v[128:129], v[26:27]
    v_pk_add_f32 v[24:25], v[24:25], v[130:131]
    v_pk_fma_f32 v[26:27], v[130:131], v[130:131], v[26:27]
    v_add_f32 v28, v24, v25
    v_add_f32 v29, v26, v27
    v_mov_b32 v24, v28
    v_mov_b32 v25, v29
    s_nop 0
    v_permlane16_swap_b32 v28, v24
    v_permlane16_swap_b32 v29, v25
    v_add_f32 v28, v28, v24
    v_add_f32 v29, v29, v25
    v_mov_b32 v24, v28
    v_mov_b32 v25, v29
    s_nop 0
    v_permlane32_swap_b32 v28, v24
    v_permlane32_swap_b32 v29, v25
    v_add_f32 v28, v28, v24
    v_add_f32 v29, v29, v25
    s_mov_b64 exec, 0xffff
    buffer_store_dwordx2 v[28:29], v31, s[40:43], s22 offen sc1
    s_mov_b64 exec, -1
    v_accvgpr_write_b32 a246, v150
    v_accvgpr_write_b32 a247, v151
    v_accvgpr_write_b32 a248, v152
    v_accvgpr_write_b32 a249, v153
    v_accvgpr_write_b32 a250, v154
    v_accvgpr_write_b32 a251, v155
    v_accvgpr_write_b32 a252, v156
    v_accvgpr_write_b32 a253, v157
    v_accvgpr_write_b32 a254, v158
    v_accvgpr_write_b32 a255, v159
    v_lshrrev_b32 v24, 2, v2
    v_lshl_add_u32 v24, v3, 2, v24
    v_and_b32 v25, 3, v2
    v_lshlrev_b32 v25, 3, v25
    v_lshl_add_u32 v24, v24, 7, v25
    s_lshl_b32 s49, s71, 5
    s_add_u32 s49, s49, 51200
    v_add_u32 v17, s49, v24
    s_cmp_eq_u32 s58, 0
    s_cbranch_scc1 L_rp_l2
    s_waitcnt vmcnt(5)
    s_barrier
    s_cmp_lg_u32 s62, 0
    s_cbranch_scc1 Lrp_1
    ds_read_b64_tr_b16 v[192:193], v17 offset:0
    ds_read_b64_tr_b16 v[194:195], v17 offset:2048
    ds_read_b64_tr_b16 v[196:197], v17 offset:4096
    ds_read_b64_tr_b16 v[198:199], v17 offset:6144
    ds_read_b64_tr_b16 v[200:201], v17 offset:8192
    ds_read_b64_tr_b16 v[202:203], v17 offset:10240
    ds_read_b64_tr_b16 v[204:205], v17 offset:12288
    ds_read_b64_tr_b16 v[206:207], v17 offset:14336
    ds_read_b64_tr_b16 v[208:209], v17 offset:16384
    ds_read_b64_tr_b16 v[210:211], v17 offset:18432
    s_waitcnt lgkmcnt(8)
    buffer_store_dwordx4 v[192:195], v20, s[40:43], s60 offen sc1
    v_mfma_f32_16x16x32_bf16 v[216:219], a[240:243], v[192:195], 0
    s_add_u32 s60, s60, s59
    s_waitcnt lgkmcnt(6)
    buffer_store_dwordx4 v[196:199], v20, s[40:43], s60 offen sc1
    v_mfma_f32_16x16x32_bf16 v[216:219], a[240:243], v[196:199], v[216:219]
    s_add_u32 s60, s60, s59
    s_waitcnt lgkmcnt(4)
    buffer_store_dwordx4 v[200:203], v20, s[40:43], s60 offen sc1
    v_mfma_f32_16x16x32_bf16 v[216:219], a[240:243], v[200:203], v[216:219]
    s_add_u32 s60, s60, s59
    s_waitcnt lgkmcnt(2)
    buffer_store_dwordx4 v[204:207], v20, s[40:43], s60 offen sc1
    v_mfma_f32_16x16x32_bf16 v[216:219], a[240:243], v[204:207], v[216:219]
    s_add_u32 s60, s60, s59
    s_waitcnt lgkmcnt(0)
    buffer_store_dwordx4 v[208:211], v20, s[40:43], s60 offen sc1
    v_mfma_f32_16x16x32_bf16 v[216:219], a[240:243], v[208:211], v[216:219]
    s_nop 7
    v_cvt_pk_bf16_f32 v220, v216, v216
    v_and_b32 v217, 0xffff0000, v220
    v_sub_f32 v217, v216, v217
    v_cvt_pk_bf16_f32 v221, v217, 0
    s_mov_b64 exec, 0xffff
    buffer_store_dwordx2 v[220:221], v21, s[40:43], s63 offen sc1
    s_mov_b64 exec, -1
Lrp_1:
    s_waitcnt vmcnt(0)
    s_barrier
    s_cmp_lg_u32 s71, 0
    s_cbranch_scc1 Lfl_2
    v_mov_b32 v22, s78
    s_mov_b64 exec, 1
    buffer_store_dword v22, off, s[40:43], s61 sc1
    s_mov_b64 exec, -1
Lfl_2:
    s_cmp_lg_u32 s71, 0
    s_cbranch_scc1 Lfl_3
    v_mov_b32 v22, s78
    s_mov_b64 exec, 1
    buffer_store_dword v22, off, s[40:43], s29 sc1
    s_mov_b64 exec, -1
Lfl_3:
    s_branch L_rp_l3
L_rp_l2:
    s_lshl_b32 s101, s71, 10
    s_add_u32 m0, s101, 51200
    s_nop 0
    buffer_load_dwordx4 v18, s[44:47], s64 offen  lds
    s_add_u32 s64, s64, s66
    s_add_u32 m0, s101, 55296
    s_nop 0
    buffer_load_dwordx4 v18, s[44:47], s64 offen  lds
    s_add_u32 s64, s64, s66
    s_add_u32 m0, s101, 59392
    s_nop 0
    buffer_load_dwordx4 v18, s[44:47], s64 offen  lds
    s_add_u32 s64, s64, s66
    s_add_u32 m0, s101, 63488
    s_nop 0
    buffer_load_dwordx4 v18, s[44:47], s64 offen  lds
    s_add_u32 m0, s101, 67584
    s_nop 0
    buffer_load_dwordx4 v19, s[44:47], s65 offen  lds
    s_waitcnt vmcnt(5)
    s_barrier
    s_cmp_lg_u32 s71, 0
    s_cbranch_scc1 Lfl_4
    v_mov_b32 v22, s78
    s_mov_b64 exec, 1
    buffer_store_dword v22, off, s[40:43], s29 sc1
    s_mov_b64 exec, -1
Lfl_4:
L_rp_l3:
    s_cmp_lg_u32 s67, 0
    s_cbranch_scc1 L_noz2
    s_cmp_lg_u32 s71, 0
    s_cbranch_scc1 Lfl_5
    v_mov_b32 v22, s78
    s_mov_b64 exec, 1
    buffer_store_dword v22, off, s[40:43], s10 sc1
    s_mov_b64 exec, -1
Lfl_5:
L_noz2:
    v_and_b32 v24, 31, v1
    v_lshrrev_b32 v25, 5, v1
    s_and_b32 s49, s71, 1
    s_mul_i32 s49, s49, 5120
    s_add_u32 s49, s49, 153600
    v_mul_u32_u24 v145, 160, v24
    v_add_u32 v145, s49, v145
    v_lshl_add_u32 v144, v25, 4, v145
    v_mad_u32_u24 v145, v25, 40, v145
    v_mul_u32_u24 v146, 160, v2
    v_lshl_add_u32 v146, v3, 3, v146
    s_mul_i32 s49, s71, 2560
    s_add_u32 s49, s49, 153600
    v_add_u32 v146, s49, v146
    v_and_b32 v28, 19, v24
    v_bfe_u32 v29, v24, 2, 1
    v_lshl_add_u32 v28, v29, 3, v28
    v_bfe_u32 v29, v24, 3, 1
    v_lshl_add_u32 v28, v29, 2, v28
    v_lshlrev_b32 v29, 4, v25
    s_lshl_b32 s49, s94, 10
    s_add_u32 s50, s49, 65536
    v_lshl_add_u32 v141, v28, 4, s50
    s_lshl_b32 s49, s49, 2
    v_lshl_add_u32 v140, v28, 5, v29
    v_add_u32 v140, s49, v140
    s_lshl_b32 s49, s49, 1
    s_add_u32 s49, s49, 131072
    v_lshl_add_u32 v142, v24, 5, v29
    v_add_u32 v142, s49, v142
    v_accvgpr_write_b32 a208, v140
    v_accvgpr_write_b32 a209, v141
    v_accvgpr_write_b32 a210, v142
    v_accvgpr_write_b32 a211, v144
    v_accvgpr_write_b32 a212, v145
    v_accvgpr_write_b32 a213, v146
    v_min_u32 v247, 23, v1
    v_lshrrev_b32 v25, 3, v247
    v_mul_u32_u24 v25, 1280, v25
    v_bfe_u32 v26, v247, 2, 1
    v_mul_u32_u24 v26, 79, v26
    s_mul_i32 s49, s74, 80
    v_add3_u32 v25, v25, v26, s49
    v_lshrrev_b32 v25, 7, v25
    v_and_b32 v247, 3, v247
    v_lshl_add_u32 v247, v25, 2, v247
    v_lshlrev_b32 v247, 7, v247
    v_add_u32 v247, 1114112, v247
    v_lshrrev_b32 v248, 3, v1
    v_mul_u32_u24 v248, 1280, v248
    v_bfe_u32 v249, v1, 2, 1
    v_mul_u32_u24 v249, 159, v249
    s_mul_i32 s49, s76, 160
    v_add3_u32 v248, v248, v249, s49
    v_lshrrev_b32 v248, 7, v248
    s_lshr_b32 s49, s76, 2
    s_add_u32 s49, s49, 30
    v_mov_b32 v249, s49
    v_cmp_gt_u32 vcc, 24, v1
    s_nop 1
    v_cndmask_b32 v248, v249, v248, vcc
    v_and_b32 v249, 3, v1
    v_lshl_add_u32 v248, v248, 2, v249
    v_lshlrev_b32 v248, 7, v248
    v_add_u32 v248, 1129472, v248
    v_and_b32 v249, 31, v1
    s_lshl_b32 s49, s72, 12
    s_add_u32 s49, s49, 1146880
    v_lshl_add_u32 v249, v249, 7, s49
    s_mov_b32 s49, 0
    s_mov_b32 exec_lo, 0xff000000
    s_mov_b32 exec_hi, 0x0
    v_mov_b32 v247, s10
    s_mov_b32 exec_lo, 0x0
    s_mov_b32 exec_hi, 0xffff
    v_add_u32 v247, s30, v8
    s_mov_b64 exec, -1
    v_mov_b32 v24, v247
    s_lshl_b32 s10, s72, 7
    s_lshl_b32 s69, s75, 5
    s_add_u32 s10, s10, s69
    s_lshl_b32 s69, s76, 2
    s_add_u32 s10, s10, s69
    s_add_u32 s10, s10, 16384
    s_cmp_lg_u32 s71, 0
    s_cbranch_scc1 Lpd_7
    s_mov_b32 s48, 0
Lpoll_6:
    buffer_load_dword v22, v24, s[40:43], s49 offen sc1
    s_add_u32 s48, s48, 1
    s_waitcnt vmcnt(0)
    v_cmp_ne_u32 vcc, s78, v22
    s_cbranch_vccz Lpd_7
    s_sleep 2
    s_cmp_lt_u32 s48, 0x20000
    s_cbranch_scc1 Lpoll_6
Lpd_7:
    s_waitcnt vmcnt(0)
    s_barrier
    s_mul_i32 s101, s71, 12800
    s_add_u32 s100, s101, s34
    s_add_u32 s100, s100, 4194304
    s_add_u32 m0, s101, 102400
    s_nop 0
    buffer_load_dwordx4 v4, s[40:43], s100 offen offset:0 lds
    buffer_load_dwordx4 v4, s[40:43], s100 offen offset:1024 lds
    buffer_load_dwordx4 v4, s[40:43], s100 offen offset:2048 lds
    buffer_load_dwordx4 v4, s[40:43], s100 offen offset:3072 lds
    s_add_u32 s100, s100, 4096
    s_add_u32 m0, s101, 106496
    s_nop 0
    buffer_load_dwordx4 v4, s[40:43], s100 offen offset:0 lds
    buffer_load_dwordx4 v4, s[40:43], s100 offen offset:1024 lds
    buffer_load_dwordx4 v4, s[40:43], s100 offen offset:2048 lds
    buffer_load_dwordx4 v4, s[40:43], s100 offen offset:3072 lds
    s_add_u32 s100, s100, 4096
    s_add_u32 m0, s101, 110592
    s_nop 0
    buffer_load_dwordx4 v4, s[40:43], s100 offen offset:0 lds
    buffer_load_dwordx4 v4, s[40:43], s100 offen offset:1024 lds
    buffer_load_dwordx4 v4, s[40:43], s100 offen offset:2048 lds
    buffer_load_dwordx4 v4, s[40:43], s100 offen offset:3072 lds
    s_add_u32 s100, s100, 4096
    s_add_u32 m0, s101, 114688
    s_mov_b32 exec_hi, 0
    buffer_load_dwordx4 v4, s[40:43], s100 offen offset:0 lds
    s_mov_b32 exec_hi, -1
    v_lshlrev_b32 v30, 3, v1
    s_lshl_b32 s49, s74, 12
    s_add_u32 s49, s49, 1179648
    buffer_load_dwordx2 a[48:49], v30, s[40:43], s49 offen offset:0 sc1
    buffer_load_dwordx2 a[50:51], v30, s[40:43], s49 offen offset:512 sc1
    buffer_load_dwordx2 a[52:53], v30, s[40:43], s49 offen offset:1024 sc1
    buffer_load_dwordx2 a[54:55], v30, s[40:43], s49 offen offset:1536 sc1
    buffer_load_dwordx2 a[56:57], v30, s[40:43], s49 offen offset:2048 sc1
    buffer_load_dwordx2 a[58:59], v30, s[40:43], s49 offen offset:2560 sc1
    buffer_load_dwordx2 a[60:61], v30, s[40:43], s49 offen offset:3072 sc1
    v_accvgpr_write_b32 a62, 0
    v_accvgpr_write_b32 a63, 0
    v_accvgpr_write_b32 a64, 0
    v_accvgpr_write_b32 a65, 0
    s_mov_b32 exec_lo, 0xff00ff
    s_mov_b32 exec_hi, 0xff00ff
    buffer_load_dwordx2 a[62:63], v30, s[40:43], s49 offen offset:3584 sc1
    s_mov_b64 exec, -1
    s_mov_b32 s95, s8
    buffer_load_dwordx4 v[32:35], v4, s[40:43], s95 offen offset:0 sc1
    buffer_load_dwordx4 v[36:39], v9, s[40:43], s95 offen offset:0 sc1
    buffer_load_dwordx4 v[40:43], v4, s[40:43], s95 offen offset:1024 sc1
    buffer_load_dwordx4 v[44:47], v9, s[40:43], s95 offen offset:1024 sc1
    buffer_load_dwordx4 v[48:51], v4, s[40:43], s95 offen offset:2048 sc1
    buffer_load_dwordx4 v[52:55], v9, s[40:43], s95 offen offset:2048 sc1
    buffer_load_dwordx4 v[56:59], v4, s[40:43], s95 offen offset:3072 sc1
    buffer_load_dwordx4 v[60:63], v9, s[40:43], s95 offen offset:3072 sc1
    s_add_u32 s95, s95, 4096
    buffer_load_dwordx4 v[64:67], v4, s[40:43], s95 offen offset:0 sc1
    buffer_load_dwordx4 v[68:71], v9, s[40:43], s95 offen offset:0 sc1
    buffer_load_dwordx4 v[72:75], v4, s[40:43], s95 offen offset:1024 sc1
    buffer_load_dwordx4 v[76:79], v9, s[40:43], s95 offen offset:1024 sc1
    s_mul_i32 s101, s71, 12800
    s_add_u32 s100, s101, s34
    s_add_u32 s100, s100, 4245504
    s_add_u32 m0, s101, 0
    s_nop 0
    buffer_load_dwordx4 v4, s[40:43], s100 offen offset:0 lds
    buffer_load_dwordx4 v4, s[40:43], s100 offen offset:1024 lds
    buffer_load_dwordx4 v4, s[40:43], s100 offen offset:2048 lds
    buffer_load_dwordx4 v4, s[40:43], s100 offen offset:3072 lds
    s_add_u32 s100, s100, 4096
    s_add_u32 m0, s101, 4096
    s_nop 0
    buffer_load_dwordx4 v4, s[40:43], s100 offen offset:0 lds
    buffer_load_dwordx4 v4, s[40:43], s100 offen offset:1024 lds
    buffer_load_dwordx4 v4, s[40:43], s100 offen offset:2048 lds
    buffer_load_dwordx4 v4, s[40:43], s100 offen offset:3072 lds
    s_add_u32 s100, s100, 4096
    s_add_u32 m0, s101, 8192
    s_nop 0
    buffer_load_dwordx4 v4, s[40:43], s100 offen offset:0 lds
    buffer_load_dwordx4 v4, s[40:43], s100 offen offset:1024 lds
    buffer_load_dwordx4 v4, s[40:43], s100 offen offset:2048 lds
    buffer_load_dwordx4 v4, s[40:43], s100 offen offset:3072 lds
    s_add_u32 s100, s100, 4096
    s_add_u32 m0, s101, 12288
    s_mov_b32 exec_hi, 0
    buffer_load_dwordx4 v4, s[40:43], s100 offen offset:0 lds
    s_mov_b32 exec_hi, -1
    s_cmp_lg_u32 s58, 0
    s_cbranch_scc1 L_rp_l4
    s_cmp_lg_u32 s62, 0
    s_cbranch_scc1 Lrp_8
    ds_read_b64_tr_b16 v[192:193], v17 offset:0
    ds_read_b64_tr_b16 v[194:195], v17 offset:2048
    ds_read_b64_tr_b16 v[196:197], v17 offset:4096
    ds_read_b64_tr_b16 v[198:199], v17 offset:6144
    ds_read_b64_tr_b16 v[200:201], v17 offset:8192
    ds_read_b64_tr_b16 v[202:203], v17 offset:10240
    ds_read_b64_tr_b16 v[204:205], v17 offset:12288
    ds_read_b64_tr_b16 v[206:207], v17 offset:14336
    ds_read_b64_tr_b16 v[208:209], v17 offset:16384
    ds_read_b64_tr_b16 v[210:211], v17 offset:18432
    s_waitcnt lgkmcnt(8)
    buffer_store_dwordx4 v[192:195], v20, s[40:43], s60 offen sc1
    v_mfma_f32_16x16x32_bf16 v[216:219], a[240:243], v[192:195], 0
    s_add_u32 s60, s60, s59
    s_waitcnt lgkmcnt(6)
    buffer_store_dwordx4 v[196:199], v20, s[40:43], s60 offen sc1
    v_mfma_f32_16x16x32_bf16 v[216:219], a[240:243], v[196:199], v[216:219]
    s_add_u32 s60, s60, s59
    s_waitcnt lgkmcnt(4)
    buffer_store_dwordx4 v[200:203], v20, s[40:43], s60 offen sc1
    v_mfma_f32_16x16x32_bf16 v[216:219], a[240:243], v[200:203], v[216:219]
    s_add_u32 s60, s60, s59
    s_waitcnt lgkmcnt(2)
    buffer_store_dwordx4 v[204:207], v20, s[40:43], s60 offen sc1
    v_mfma_f32_16x16x32_bf16 v[216:219], a[240:243], v[204:207], v[216:219]
    s_add_u32 s60, s60, s59
    s_waitcnt lgkmcnt(0)
    buffer_store_dwordx4 v[208:211], v20, s[40:43], s60 offen sc1
    v_mfma_f32_16x16x32_bf16 v[216:219], a[240:243], v[208:211], v[216:219]
    s_nop 7
    v_cvt_pk_bf16_f32 v220, v216, v216
    v_and_b32 v217, 0xffff0000, v220
    v_sub_f32 v217, v216, v217
    v_cvt_pk_bf16_f32 v221, v217, 0
    s_mov_b64 exec, 0xffff
    buffer_store_dwordx2 v[220:221], v21, s[40:43], s63 offen sc1
    s_mov_b64 exec, -1
Lrp_8:
L_rp_l4:
    v_accvgpr_read_b32 v25, a203
    s_waitcnt vmcnt(25)
    s_barrier
    ds_read_b128 a[0:3], v6 offset:0
    ds_read_b128 a[4:7], v6 offset:1024
    ds_read_b128 a[8:11], v6 offset:2048
    ds_read_b128 a[12:15], v6 offset:3072
    ds_read_b128 a[16:19], v6 offset:4096
    ds_read_b128 a[20:23], v6 offset:5120
    ds_read_b128 a[24:27], v6 offset:6144
    ds_read_b128 a[28:31], v6 offset:7168
    buffer_load_dwordx2 v[14:15], v25, s[40:43], s9 offen offset:0 sc1
    buffer_load_dwordx2 v[16:17], v25, s[40:43], s9 offen offset:128 sc1
    buffer_load_dwordx2 v[18:19], v25, s[40:43], s9 offen offset:1024 sc1
    buffer_load_dwordx2 v[20:21], v25, s[40:43], s9 offen offset:1152 sc1
    s_waitcnt lgkmcnt(6)
    s_waitcnt vmcnt(27)
    v_mfma_f32_16x16x32_bf16 v[192:195], v[32:35], a[0:3], 0
    ds_read_b128 a[32:35], v6 offset:8192
    buffer_load_dwordx4 v[80:83], v4, s[40:43], s95 offen offset:2048 sc1
    buffer_load_dwordx4 v[84:87], v9, s[40:43], s95 offen offset:2048 sc1
    v_mfma_f32_16x16x32_bf16 v[196:199], v[36:39], a[0:3], 0
    v_mfma_f32_16x16x32_bf16 v[200:203], v[32:35], a[4:7], 0
    ds_read_b128 a[36:39], v6 offset:9216
    v_mfma_f32_16x16x32_bf16 v[204:207], v[36:39], a[4:7], 0
    s_waitcnt lgkmcnt(6)
    v_mfma_f32_16x16x32_bf16 v[208:211], v[32:35], a[8:11], 0
    ds_read_b128 a[0:3], v6 offset:10240
    v_mfma_f32_16x16x32_bf16 v[212:215], v[36:39], a[8:11], 0
    v_mfma_f32_16x16x32_bf16 v[216:219], v[32:35], a[12:15], 0
    ds_read_b128 a[4:7], v6 offset:11264
    v_mfma_f32_16x16x32_bf16 v[220:223], v[36:39], a[12:15], 0
    s_waitcnt lgkmcnt(6)
    v_mfma_f32_16x16x32_bf16 v[224:227], v[32:35], a[16:19], 0
    ds_read_b128 a[8:11], v6 offset:12288
    v_mfma_f32_16x16x32_bf16 v[228:231], v[36:39], a[16:19], 0
    s_waitcnt vmcnt(27)
    v_mfma_f32_16x16x32_bf16 v[192:195], v[40:43], a[20:23], v[192:195]
    ds_read_b128 a[12:15], v6 offset:13312
    buffer_load_dwordx4 v[88:91], v4, s[40:43], s95 offen offset:3072 sc1
    buffer_load_dwordx4 v[92:95], v9, s[40:43], s95 offen offset:3072 sc1
    s_add_u32 s95, s95, 4096
    v_mfma_f32_16x16x32_bf16 v[196:199], v[44:47], a[20:23], v[196:199]
    s_waitcnt lgkmcnt(6)
    v_mfma_f32_16x16x32_bf16 v[200:203], v[40:43], a[24:27], v[200:203]
    ds_read_b128 a[16:19], v6 offset:14336
    v_mfma_f32_16x16x32_bf16 v[204:207], v[44:47], a[24:27], v[204:207]
    v_mfma_f32_16x16x32_bf16 v[208:211], v[40:43], a[28:31], v[208:211]
    ds_read_b128 a[20:23], v6 offset:15360
    v_mfma_f32_16x16x32_bf16 v[212:215], v[44:47], a[28:31], v[212:215]
    s_waitcnt lgkmcnt(6)
    v_mfma_f32_16x16x32_bf16 v[216:219], v[40:43], a[32:35], v[216:219]
    ds_read_b128 a[24:27], v6 offset:16384
    v_mfma_f32_16x16x32_bf16 v[220:223], v[44:47], a[32:35], v[220:223]
    v_mfma_f32_16x16x32_bf16 v[224:227], v[40:43], a[36:39], v[224:227]
    ds_read_b128 a[28:31], v6 offset:17408
    v_mfma_f32_16x16x32_bf16 v[228:231], v[44:47], a[36:39], v[228:231]
    s_waitcnt lgkmcnt(6)
    s_waitcnt vmcnt(27)
    v_mfma_f32_16x16x32_bf16 v[192:195], v[48:51], a[0:3], v[192:195]
    ds_read_b128 a[32:35], v6 offset:18432
    buffer_load_dwordx4 v[96:99], v4, s[40:43], s95 offen offset:0 sc1
    buffer_load_dwordx4 v[100:103], v9, s[40:43], s95 offen offset:0 sc1
    v_mfma_f32_16x16x32_bf16 v[196:199], v[52:55], a[0:3], v[196:199]
    v_mfma_f32_16x16x32_bf16 v[200:203], v[48:51], a[4:7], v[200:203]
    ds_read_b128 a[36:39], v6 offset:19456
    v_mfma_f32_16x16x32_bf16 v[204:207], v[52:55], a[4:7], v[204:207]
    s_waitcnt lgkmcnt(6)
    v_mfma_f32_16x16x32_bf16 v[208:211], v[48:51], a[8:11], v[208:211]
    ds_read_b128 a[0:3], v6 offset:20480
    v_mfma_f32_16x16x32_bf16 v[212:215], v[52:55], a[8:11], v[212:215]
    v_mfma_f32_16x16x32_bf16 v[216:219], v[48:51], a[12:15], v[216:219]
    ds_read_b128 a[4:7], v6 offset:21504
    v_mfma_f32_16x16x32_bf16 v[220:223], v[52:55], a[12:15], v[220:223]
    s_waitcnt lgkmcnt(6)
    v_mfma_f32_16x16x32_bf16 v[224:227], v[48:51], a[16:19], v[224:227]
    ds_read_b128 a[8:11], v6 offset:22528
    v_mfma_f32_16x16x32_bf16 v[228:231], v[52:55], a[16:19], v[228:231]
    s_waitcnt vmcnt(27)
    v_mfma_f32_16x16x32_bf16 v[192:195], v[56:59], a[20:23], v[192:195]
    ds_read_b128 a[12:15], v6 offset:23552
    buffer_load_dwordx4 v[104:107], v4, s[40:43], s95 offen offset:1024 sc1
    buffer_load_dwordx4 v[108:111], v9, s[40:43], s95 offen offset:1024 sc1
    v_mfma_f32_16x16x32_bf16 v[196:199], v[60:63], a[20:23], v[196:199]
    s_waitcnt lgkmcnt(6)
    v_mfma_f32_16x16x32_bf16 v[200:203], v[56:59], a[24:27], v[200:203]
    ds_read_b128 a[16:19], v6 offset:24576
    v_mfma_f32_16x16x32_bf16 v[204:207], v[60:63], a[24:27], v[204:207]
    v_mfma_f32_16x16x32_bf16 v[208:211], v[56:59], a[28:31], v[208:211]
    ds_read_b128 a[20:23], v6 offset:25600
    v_mfma_f32_16x16x32_bf16 v[212:215], v[60:63], a[28:31], v[212:215]
    s_waitcnt lgkmcnt(6)
    v_mfma_f32_16x16x32_bf16 v[216:219], v[56:59], a[32:35], v[216:219]
    ds_read_b128 a[24:27], v6 offset:26624
    v_mfma_f32_16x16x32_bf16 v[220:223], v[60:63], a[32:35], v[220:223]
    v_mfma_f32_16x16x32_bf16 v[224:227], v[56:59], a[36:39], v[224:227]
    ds_read_b128 a[28:31], v6 offset:27648
    v_mfma_f32_16x16x32_bf16 v[228:231], v[60:63], a[36:39], v[228:231]
    s_waitcnt lgkmcnt(6)
    s_waitcnt vmcnt(27)
    v_mfma_f32_16x16x32_bf16 v[192:195], v[64:67], a[0:3], v[192:195]
    ds_read_b128 a[32:35], v6 offset:28672
    buffer_load_dwordx4 v[112:115], v4, s[40:43], s95 offen offset:2048 sc1
    buffer_load_dwordx4 v[116:119], v9, s[40:43], s95 offen offset:2048 sc1
    v_mfma_f32_16x16x32_bf16 v[196:199], v[68:71], a[0:3], v[196:199]
    v_mfma_f32_16x16x32_bf16 v[200:203], v[64:67], a[4:7], v[200:203]
    ds_read_b128 a[36:39], v6 offset:29696
    v_mfma_f32_16x16x32_bf16 v[204:207], v[68:71], a[4:7], v[204:207]
    s_waitcnt lgkmcnt(6)
    v_mfma_f32_16x16x32_bf16 v[208:211], v[64:67], a[8:11], v[208:211]
    ds_read_b128 a[0:3], v6 offset:30720
    v_mfma_f32_16x16x32_bf16 v[212:215], v[68:71], a[8:11], v[212:215]
    v_mfma_f32_16x16x32_bf16 v[216:219], v[64:67], a[12:15], v[216:219]
    ds_read_b128 a[4:7], v6 offset:31744
    v_mfma_f32_16x16x32_bf16 v[220:223], v[68:71], a[12:15], v[220:223]
    s_waitcnt lgkmcnt(6)
    v_mfma_f32_16x16x32_bf16 v[224:227], v[64:67], a[16:19], v[224:227]
    ds_read_b128 a[8:11], v6 offset:32768
    v_mfma_f32_16x16x32_bf16 v[228:231], v[68:71], a[16:19], v[228:231]
    s_waitcnt vmcnt(27)
    v_mfma_f32_16x16x32_bf16 v[192:195], v[72:75], a[20:23], v[192:195]
    ds_read_b128 a[12:15], v6 offset:33792
    buffer_load_dwordx4 v[120:123], v4, s[40:43], s95 offen offset:3072 sc1
    buffer_load_dwordx4 v[124:127], v9, s[40:43], s95 offen offset:3072 sc1
    s_add_u32 s95, s95, 4096
    v_mfma_f32_16x16x32_bf16 v[196:199], v[76:79], a[20:23], v[196:199]
    s_waitcnt lgkmcnt(6)
    s_waitcnt vmcnt(12)
    v_mfma_f32_16x16x32_bf16 v[200:203], v[72:75], a[24:27], v[200:203]
    ds_read_b128 a[16:19], v6 offset:34816
    v_add_f32 v14, v14, v16
    v_mfma_f32_16x16x32_bf16 v[204:207], v[76:79], a[24:27], v[204:207]
    v_add_f32 v15, v15, v17
    v_mfma_f32_16x16x32_bf16 v[208:211], v[72:75], a[28:31], v[208:211]
    ds_read_b128 a[20:23], v6 offset:35840
    v_add_f32 v18, v18, v20
    v_mfma_f32_16x16x32_bf16 v[212:215], v[76:79], a[28:31], v[212:215]
    s_waitcnt lgkmcnt(6)
    v_mfma_f32_16x16x32_bf16 v[216:219], v[72:75], a[32:35], v[216:219]
    ds_read_b128 a[24:27], v6 offset:36864
    v_add_f32 v19, v19, v21
    v_mfma_f32_16x16x32_bf16 v[220:223], v[76:79], a[32:35], v[220:223]
    v_mov_b32 v24, v14
    v_mfma_f32_16x16x32_bf16 v[224:227], v[72:75], a[36:39], v[224:227]
    ds_read_b128 a[28:31], v6 offset:37888
    v_mov_b32 v25, v15
    v_mfma_f32_16x16x32_bf16 v[228:231], v[76:79], a[36:39], v[228:231]
    s_waitcnt lgkmcnt(6)
    s_waitcnt vmcnt(10)
    v_mfma_f32_16x16x32_bf16 v[192:195], v[80:83], a[0:3], v[192:195]
    ds_read_b128 a[32:35], v6 offset:38912
    buffer_load_dwordx4 v[128:131], v4, s[40:43], s95 offen offset:0 sc1
    buffer_load_dwordx4 v[132:135], v9, s[40:43], s95 offen offset:0 sc1
    v_mfma_f32_16x16x32_bf16 v[196:199], v[84:87], a[0:3], v[196:199]
    v_mov_b32 v26, v18
    s_barrier
    v_mfma_f32_16x16x32_bf16 v[200:203], v[80:83], a[4:7], v[200:203]
    ds_read_b128 a[36:39], v6 offset:39936
    v_mov_b32 v27, v19
    v_mfma_f32_16x16x32_bf16 v[204:207], v[84:87], a[4:7], v[204:207]
    v_permlane16_swap_b32 v14, v24
    s_cmp_lg_u32 s58, 0
    s_cbranch_scc1 L_rp_l5
    s_cmp_lg_u32 s71, 0
    s_cbranch_scc1 Lfl_9
    v_mov_b32 v22, s78
    s_mov_b64 exec, 1
    buffer_store_dword v22, off, s[40:43], s61 sc1
    s_mov_b64 exec, -1
Lfl_9:
L_rp_l5:
    s_waitcnt lgkmcnt(6)
    v_mfma_f32_16x16x32_bf16 v[208:211], v[80:83], a[8:11], v[208:211]
    ds_read_b128 a[0:3], v6 offset:40960
    v_permlane16_swap_b32 v15, v25
    v_mfma_f32_16x16x32_bf16 v[212:215], v[84:87], a[8:11], v[212:215]
    v_mfma_f32_16x16x32_bf16 v[216:219], v[80:83], a[12:15], v[216:219]
    ds_read_b128 a[4:7], v6 offset:41984
    v_permlane16_swap_b32 v18, v26
    v_mfma_f32_16x16x32_bf16 v[220:223], v[84:87], a[12:15], v[220:223]
    s_waitcnt lgkmcnt(6)
    v_mfma_f32_16x16x32_bf16 v[224:227], v[80:83], a[16:19], v[224:227]
    ds_read_b128 a[8:11], v6 offset:43008
    v_permlane16_swap_b32 v19, v27
    v_mfma_f32_16x16x32_bf16 v[228:231], v[84:87], a[16:19], v[228:231]
    v_add_f32 v14, v14, v24
    s_waitcnt vmcnt(10)
    v_mfma_f32_16x16x32_bf16 v[192:195], v[88:91], a[20:23], v[192:195]
    ds_read_b128 a[12:15], v6 offset:44032
    buffer_load_dwordx4 v[136:139], v4, s[40:43], s95 offen offset:1024 sc1
    buffer_load_dwordx4 v[140:143], v9, s[40:43], s95 offen offset:1024 sc1
    v_mfma_f32_16x16x32_bf16 v[196:199], v[92:95], a[20:23], v[196:199]
    v_add_f32 v15, v15, v25
    s_waitcnt lgkmcnt(6)
    v_mfma_f32_16x16x32_bf16 v[200:203], v[88:91], a[24:27], v[200:203]
    ds_read_b128 a[16:19], v6 offset:45056
    v_add_f32 v18, v18, v26
    v_mfma_f32_16x16x32_bf16 v[204:207], v[92:95], a[24:27], v[204:207]
    v_mfma_f32_16x16x32_bf16 v[208:211], v[88:91], a[28:31], v[208:211]
    ds_read_b128 a[20:23], v6 offset:46080
    v_add_f32 v19, v19, v27
    v_mfma_f32_16x16x32_bf16 v[212:215], v[92:95], a[28:31], v[212:215]
    v_mov_b32 v24, v14
    s_waitcnt lgkmcnt(6)
    v_mfma_f32_16x16x32_bf16 v[216:219], v[88:91], a[32:35], v[216:219]
    ds_read_b128 a[24:27], v6 offset:47104
    v_mov_b32 v25, v15
    v_mfma_f32_16x16x32_bf16 v[220:223], v[92:95], a[32:35], v[220:223]
    v_mfma_f32_16x16x32_bf16 v[224:227], v[88:91], a[36:39], v[224:227]
    ds_read_b128 a[28:31], v6 offset:48128
    v_mov_b32 v26, v18
    v_mfma_f32_16x16x32_bf16 v[228:231], v[92:95], a[36:39], v[228:231]
    s_waitcnt lgkmcnt(6)
    s_waitcnt vmcnt(10)
    v_mfma_f32_16x16x32_bf16 v[192:195], v[96:99], a[0:3], v[192:195]
    ds_read_b128 a[32:35], v6 offset:49152
    buffer_load_dwordx4 v[144:147], v4, s[40:43], s95 offen offset:2048 sc1
    buffer_load_dwordx4 v[148:151], v9, s[40:43], s95 offen offset:2048 sc1
    v_mfma_f32_16x16x32_bf16 v[196:199], v[100:103], a[0:3], v[196:199]
    v_mov_b32 v27, v19
    v_permlane32_swap_b32 v14, v24
    v_mfma_f32_16x16x32_bf16 v[200:203], v[96:99], a[4:7], v[200:203]
    ds_read_b128 a[36:39], v6 offset:50176
    v_permlane32_swap_b32 v15, v25
    v_mfma_f32_16x16x32_bf16 v[204:207], v[100:103], a[4:7], v[204:207]
    s_waitcnt lgkmcnt(6)
    v_mfma_f32_16x16x32_bf16 v[208:211], v[96:99], a[8:11], v[208:211]
    ds_read_b128 a[0:3], v4 offset:0
    v_permlane32_swap_b32 v18, v26
    v_mfma_f32_16x16x32_bf16 v[212:215], v[100:103], a[8:11], v[212:215]
    v_mfma_f32_16x16x32_bf16 v[216:219], v[96:99], a[12:15], v[216:219]
    ds_read_b128 a[4:7], v4 offset:1024
    v_permlane32_swap_b32 v19, v27
    v_mfma_f32_16x16x32_bf16 v[220:223], v[100:103], a[12:15], v[220:223]
    v_add_f32 v14, v14, v24
    s_waitcnt lgkmcnt(6)
    v_mfma_f32_16x16x32_bf16 v[224:227], v[96:99], a[16:19], v[224:227]
    ds_read_b128 a[8:11], v4 offset:2048
    v_add_f32 v15, v15, v25
    v_mfma_f32_16x16x32_bf16 v[228:231], v[100:103], a[16:19], v[228:231]
    s_waitcnt vmcnt(10)
    v_mfma_f32_16x16x32_bf16 v[192:195], v[104:107], a[20:23], v[192:195]
    ds_read_b128 a[12:15], v4 offset:3072
    buffer_load_dwordx4 v[152:155], v4, s[40:43], s95 offen offset:3072 sc1
    buffer_load_dwordx4 v[156:159], v9, s[40:43], s95 offen offset:3072 sc1
    s_add_u32 s95, s95, 4096
    v_mfma_f32_16x16x32_bf16 v[196:199], v[108:111], a[20:23], v[196:199]
    v_add_f32 v18, v18, v26
    v_add_f32 v19, v19, v27
    s_waitcnt lgkmcnt(6)
    v_mfma_f32_16x16x32_bf16 v[200:203], v[104:107], a[24:27], v[200:203]
    ds_read_b128 a[16:19], v4 offset:4096
    v_mul_f32 v24, 0xbacccccd, v14
    v_mfma_f32_16x16x32_bf16 v[204:207], v[108:111], a[24:27], v[204:207]
    v_mfma_f32_16x16x32_bf16 v[208:211], v[104:107], a[28:31], v[208:211]
    ds_read_b128 a[20:23], v4 offset:5120
    v_mul_f32 v15, 0x3acccccd, v15
    v_mfma_f32_16x16x32_bf16 v[212:215], v[108:111], a[28:31], v[212:215]
    s_waitcnt lgkmcnt(6)
    v_mfma_f32_16x16x32_bf16 v[216:219], v[104:107], a[32:35], v[216:219]
    ds_read_b128 a[24:27], v4 offset:6144
    v_fma_f32 v15, -v24, v24, v15
    v_mfma_f32_16x16x32_bf16 v[220:223], v[108:111], a[32:35], v[220:223]
    v_max_f32 v15, 0, v15
    v_mfma_f32_16x16x32_bf16 v[224:227], v[104:107], a[36:39], v[224:227]
    ds_read_b128 a[28:31], v4 offset:7168
    v_add_f32 v15, 0x3727c5ac, v15
    v_mfma_f32_16x16x32_bf16 v[228:231], v[108:111], a[36:39], v[228:231]
    s_waitcnt lgkmcnt(6)
    s_waitcnt vmcnt(10)
    v_mfma_f32_16x16x32_bf16 v[192:195], v[112:115], a[0:3], v[192:195]
    ds_read_b128 a[32:35], v4 offset:8192
    buffer_load_dwordx4 v[160:163], v4, s[40:43], s95 offen offset:0 sc1
    buffer_load_dwordx4 v[164:167], v9, s[40:43], s95 offen offset:0 sc1
    v_mfma_f32_16x16x32_bf16 v[196:199], v[116:119], a[0:3], v[196:199]
    v_cvt_pk_bf16_f32 v25, v24, v24
    v_mfma_f32_16x16x32_bf16 v[200:203], v[112:115], a[4:7], v[200:203]
    ds_read_b128 a[36:39], v4 offset:9216
    v_rsq_f32 v12, v15
    v_mfma_f32_16x16x32_bf16 v[204:207], v[116:119], a[4:7], v[204:207]
    v_and_b32 v25, 0xffff0000, v25
    s_waitcnt lgkmcnt(6)
    v_mfma_f32_16x16x32_bf16 v[208:211], v[112:115], a[8:11], v[208:211]
    ds_read_b128 a[0:3], v4 offset:10240
    v_sub_f32 v26, v24, v25
    v_mfma_f32_16x16x32_bf16 v[212:215], v[116:119], a[8:11], v[212:215]
    v_mfma_f32_16x16x32_bf16 v[216:219], v[112:115], a[12:15], v[216:219]
    ds_read_b128 a[4:7], v4 offset:11264
    v_cvt_pk_bf16_f32 v27, v25, v26
    v_mfma_f32_16x16x32_bf16 v[220:223], v[116:119], a[12:15], v[220:223]
    s_waitcnt lgkmcnt(6)
    v_mfma_f32_16x16x32_bf16 v[224:227], v[112:115], a[16:19], v[224:227]
    ds_read_b128 a[8:11], v4 offset:12288
    v_lshrrev_b32 v25, 16, v25
    v_mfma_f32_16x16x32_bf16 v[228:231], v[116:119], a[16:19], v[228:231]
    v_accvgpr_write_b32 a40, v27
    s_waitcnt vmcnt(10)
    v_mfma_f32_16x16x32_bf16 v[192:195], v[120:123], a[20:23], v[192:195]
    ds_read_b128 a[12:15], v4 offset:13312
    buffer_load_dwordx4 v[168:171], v4, s[40:43], s95 offen offset:1024 sc1
    buffer_load_dwordx4 v[172:175], v9, s[40:43], s95 offen offset:1024 sc1
    v_mfma_f32_16x16x32_bf16 v[196:199], v[124:127], a[20:23], v[196:199]
    v_accvgpr_write_b32 a41, v25
    s_waitcnt lgkmcnt(6)
    v_mfma_f32_16x16x32_bf16 v[200:203], v[120:123], a[24:27], v[200:203]
    ds_read_b128 a[16:19], v4 offset:14336
    v_accvgpr_write_b32 a42, 0
    v_mfma_f32_16x16x32_bf16 v[204:207], v[124:127], a[24:27], v[204:207]
    v_mfma_f32_16x16x32_bf16 v[208:211], v[120:123], a[28:31], v[208:211]
    ds_read_b128 a[20:23], v4 offset:15360
    v_accvgpr_write_b32 a43, 0
    v_mfma_f32_16x16x32_bf16 v[212:215], v[124:127], a[28:31], v[212:215]
    v_mul_f32 v24, 0xbacccccd, v18
    s_waitcnt lgkmcnt(6)
    v_mfma_f32_16x16x32_bf16 v[216:219], v[120:123], a[32:35], v[216:219]
    ds_read_b128 a[24:27], v4 offset:16384
    v_mul_f32 v19, 0x3acccccd, v19
    v_mfma_f32_16x16x32_bf16 v[220:223], v[124:127], a[32:35], v[220:223]
    v_mfma_f32_16x16x32_bf16 v[224:227], v[120:123], a[36:39], v[224:227]
    ds_read_b128 a[28:31], v4 offset:17408
    v_fma_f32 v19, -v24, v24, v19
    v_mfma_f32_16x16x32_bf16 v[228:231], v[124:127], a[36:39], v[228:231]
    s_waitcnt lgkmcnt(6)
    s_waitcnt vmcnt(10)
    s_barrier
    v_mfma_f32_16x16x32_bf16 v[192:195], v[128:131], a[0:3], v[192:195]
    ds_read_b128 a[32:35], v4 offset:18432
    buffer_load_dwordx4 v[176:179], v4, s[40:43], s95 offen offset:2048 sc1
    buffer_load_dwordx4 v[180:183], v9, s[40:43], s95 offen offset:2048 sc1
    v_mfma_f32_16x16x32_bf16 v[196:199], v[132:135], a[0:3], v[196:199]
    v_max_f32 v19, 0, v19
    v_add_f32 v19, 0x3727c5ac, v19
    v_mfma_f32_16x16x32_bf16 v[200:203], v[128:131], a[4:7], v[200:203]
    ds_read_b128 a[36:39], v4 offset:19456
    v_cvt_pk_bf16_f32 v25, v24, v24
    v_mfma_f32_16x16x32_bf16 v[204:207], v[132:135], a[4:7], v[204:207]
    s_waitcnt lgkmcnt(6)
    v_mfma_f32_16x16x32_bf16 v[208:211], v[128:131], a[8:11], v[208:211]
    ds_read_b128 a[0:3], v4 offset:20480
    v_rsq_f32 v13, v19
    v_mfma_f32_16x16x32_bf16 v[212:215], v[132:135], a[8:11], v[212:215]
    v_and_b32 v25, 0xffff0000, v25
    v_mfma_f32_16x16x32_bf16 v[216:219], v[128:131], a[12:15], v[216:219]
    ds_read_b128 a[4:7], v4 offset:21504
    v_sub_f32 v26, v24, v25
    v_mfma_f32_16x16x32_bf16 v[220:223], v[132:135], a[12:15], v[220:223]
    s_waitcnt lgkmcnt(6)
    v_mfma_f32_16x16x32_bf16 v[224:227], v[128:131], a[16:19], v[224:227]
    ds_read_b128 a[8:11], v4 offset:22528
    v_cvt_pk_bf16_f32 v27, v25, v26
    v_mfma_f32_16x16x32_bf16 v[228:231], v[132:135], a[16:19], v[228:231]
    s_waitcnt vmcnt(10)
    v_mfma_f32_16x16x32_bf16 v[192:195], v[136:139], a[20:23], v[192:195]
    ds_read_b128 a[12:15], v4 offset:23552
    buffer_load_dwordx4 v[184:187], v4, s[40:43], s95 offen offset:3072 sc1
    buffer_load_dwordx4 v[188:191], v9, s[40:43], s95 offen offset:3072 sc1
    v_mfma_f32_16x16x32_bf16 v[196:199], v[140:143], a[20:23], v[196:199]
    v_lshrrev_b32 v25, 16, v25
    v_accvgpr_write_b32 a44, v27
    s_waitcnt lgkmcnt(6)
    v_mfma_f32_16x16x32_bf16 v[200:203], v[136:139], a[24:27], v[200:203]
    ds_read_b128 a[16:19], v4 offset:24576
    v_accvgpr_write_b32 a45, v25
    v_mfma_f32_16x16x32_bf16 v[204:207], v[140:143], a[24:27], v[204:207]
    v_mfma_f32_16x16x32_bf16 v[208:211], v[136:139], a[28:31], v[208:211]
    ds_read_b128 a[20:23], v4 offset:25600
    v_accvgpr_write_b32 a46, 0
    v_mfma_f32_16x16x32_bf16 v[212:215], v[140:143], a[28:31], v[212:215]
    s_waitcnt lgkmcnt(6)
    v_mfma_f32_16x16x32_bf16 v[216:219], v[136:139], a[32:35], v[216:219]
    ds_read_b128 a[24:27], v4 offset:26624
    v_accvgpr_write_b32 a47, 0
    v_mfma_f32_16x16x32_bf16 v[220:223], v[140:143], a[32:35], v[220:223]
    v_mov_b32_dpp v14, v12 row_newbcast:0 row_mask:0x1 bank_mask:0xf
    v_mfma_f32_16x16x32_bf16 v[224:227], v[136:139], a[36:39], v[224:227]
    ds_read_b128 a[28:31], v4 offset:27648
    v_mov_b32_dpp v14, v12 row_newbcast:4 row_mask:0x2 bank_mask:0xf
    v_mfma_f32_16x16x32_bf16 v[228:231], v[140:143], a[36:39], v[228:231]
    s_waitcnt lgkmcnt(6)
    s_waitcnt vmcnt(10)
    v_mfma_f32_16x16x32_bf16 v[192:195], v[144:147], a[0:3], v[192:195]
    ds_read_b128 a[32:35], v4 offset:28672
    v_mov_b32_dpp v14, v12 row_newbcast:8 row_mask:0x4 bank_mask:0xf
    v_mfma_f32_16x16x32_bf16 v[196:199], v[148:151], a[0:3], v[196:199]
    v_mfma_f32_16x16x32_bf16 v[200:203], v[144:147], a[4:7], v[200:203]
    ds_read_b128 a[36:39], v4 offset:29696
    v_mov_b32_dpp v14, v12 row_newbcast:12 row_mask:0x8 bank_mask:0xf
    v_mfma_f32_16x16x32_bf16 v[204:207], v[148:151], a[4:7], v[204:207]
    v_mov_b32_dpp v15, v12 row_newbcast:1 row_mask:0x1 bank_mask:0xf
    s_waitcnt lgkmcnt(6)
    v_mfma_f32_16x16x32_bf16 v[208:211], v[144:147], a[8:11], v[208:211]
    ds_read_b128 a[0:3], v4 offset:30720
    v_mov_b32_dpp v15, v12 row_newbcast:5 row_mask:0x2 bank_mask:0xf
    v_mfma_f32_16x16x32_bf16 v[212:215], v[148:151], a[8:11], v[212:215]
    v_mfma_f32_16x16x32_bf16 v[216:219], v[144:147], a[12:15], v[216:219]
    ds_read_b128 a[4:7], v4 offset:31744
    v_mov_b32_dpp v15, v12 row_newbcast:9 row_mask:0x4 bank_mask:0xf
    v_mfma_f32_16x16x32_bf16 v[220:223], v[148:151], a[12:15], v[220:223]
    s_waitcnt lgkmcnt(6)
    v_mfma_f32_16x16x32_bf16 v[224:227], v[144:147], a[16:19], v[224:227]
    ds_read_b128 a[8:11], v4 offset:32768
    v_mov_b32_dpp v15, v12 row_newbcast:13 row_mask:0x8 bank_mask:0xf
    v_mfma_f32_16x16x32_bf16 v[228:231], v[148:151], a[16:19], v[228:231]
    v_mov_b32_dpp v16, v12 row_newbcast:2 row_mask:0x1 bank_mask:0xf
    s_waitcnt vmcnt(8)
    v_mfma_f32_16x16x32_bf16 v[192:195], v[152:155], a[20:23], v[192:195]
    ds_read_b128 a[12:15], v4 offset:33792
    v_mov_b32_dpp v16, v12 row_newbcast:6 row_mask:0x2 bank_mask:0xf
    v_mfma_f32_16x16x32_bf16 v[196:199], v[156:159], a[20:23], v[196:199]
    s_waitcnt lgkmcnt(6)
    v_mfma_f32_16x16x32_bf16 v[200:203], v[152:155], a[24:27], v[200:203]
    ds_read_b128 a[16:19], v4 offset:34816
    v_mov_b32_dpp v16, v12 row_newbcast:10 row_mask:0x4 bank_mask:0xf
    v_mfma_f32_16x16x32_bf16 v[204:207], v[156:159], a[24:27], v[204:207]
    s_mul_i32 s101, s71, 12800
    s_add_u32 s100, s101, s34
    s_add_u32 s100, s100, 4296704
    s_add_u32 m0, s101, 51200
    s_nop 0
    buffer_load_dwordx4 v4, s[40:43], s100 offen offset:0 lds
    v_mfma_f32_16x16x32_bf16 v[208:211], v[152:155], a[28:31], v[208:211]
    ds_read_b128 a[20:23], v4 offset:35840
    v_mov_b32_dpp v16, v12 row_newbcast:14 row_mask:0x8 bank_mask:0xf
    v_mfma_f32_16x16x32_bf16 v[212:215], v[156:159], a[28:31], v[212:215]
    v_mov_b32_dpp v17, v12 row_newbcast:3 row_mask:0x1 bank_mask:0xf
    buffer_load_dwordx4 v4, s[40:43], s100 offen offset:1024 lds
    s_waitcnt lgkmcnt(6)
    v_mfma_f32_16x16x32_bf16 v[216:219], v[152:155], a[32:35], v[216:219]
    ds_read_b128 a[24:27], v4 offset:36864
    v_mov_b32_dpp v17, v12 row_newbcast:7 row_mask:0x2 bank_mask:0xf
    v_mfma_f32_16x16x32_bf16 v[220:223], v[156:159], a[32:35], v[220:223]
    v_mfma_f32_16x16x32_bf16 v[224:227], v[152:155], a[36:39], v[224:227]
    ds_read_b128 a[28:31], v4 offset:37888
    v_mov_b32_dpp v17, v12 row_newbcast:11 row_mask:0x4 bank_mask:0xf
    v_mfma_f32_16x16x32_bf16 v[228:231], v[156:159], a[36:39], v[228:231]
    v_mov_b32_dpp v17, v12 row_newbcast:15 row_mask:0x8 bank_mask:0xf
    buffer_load_dwordx4 v4, s[40:43], s100 offen offset:2048 lds
    s_waitcnt lgkmcnt(6)
    s_waitcnt vmcnt(9)
    v_mfma_f32_16x16x32_bf16 v[192:195], v[160:163], a[0:3], v[192:195]
    ds_read_b128 a[32:35], v4 offset:38912
    v_mov_b32_dpp v18, v13 row_newbcast:0 row_mask:0x1 bank_mask:0xf
    v_mfma_f32_16x16x32_bf16 v[196:199], v[164:167], a[0:3], v[196:199]
    v_mfma_f32_16x16x32_bf16 v[200:203], v[160:163], a[4:7], v[200:203]
    ds_read_b128 a[36:39], v4 offset:39936
    v_mov_b32_dpp v18, v13 row_newbcast:4 row_mask:0x2 bank_mask:0xf
    v_mfma_f32_16x16x32_bf16 v[204:207], v[164:167], a[4:7], v[204:207]
    buffer_load_dwordx4 v4, s[40:43], s100 offen offset:3072 lds
    s_waitcnt lgkmcnt(6)
    v_mfma_f32_16x16x32_bf16 v[208:211], v[160:163], a[8:11], v[208:211]
    ds_read_b128 a[0:3], v4 offset:40960
    v_mov_b32_dpp v18, v13 row_newbcast:8 row_mask:0x4 bank_mask:0xf
    v_mfma_f32_16x16x32_bf16 v[212:215], v[164:167], a[8:11], v[212:215]
    v_mov_b32_dpp v18, v13 row_newbcast:12 row_mask:0x8 bank_mask:0xf
    s_add_u32 s100, s100, 4096
    s_add_u32 m0, s101, 55296
    s_nop 0
    buffer_load_dwordx4 v4, s[40:43], s100 offen offset:0 lds
    v_mfma_f32_16x16x32_bf16 v[216:219], v[160:163], a[12:15], v[216:219]
    ds_read_b128 a[4:7], v4 offset:41984
    v_mov_b32_dpp v19, v13 row_newbcast:1 row_mask:0x1 bank_mask:0xf
    v_mfma_f32_16x16x32_bf16 v[220:223], v[164:167], a[12:15], v[220:223]
    s_waitcnt lgkmcnt(6)
    v_mfma_f32_16x16x32_bf16 v[224:227], v[160:163], a[16:19], v[224:227]
    ds_read_b128 a[8:11], v4 offset:43008
    v_mov_b32_dpp v19, v13 row_newbcast:5 row_mask:0x2 bank_mask:0xf
    v_mfma_f32_16x16x32_bf16 v[228:231], v[164:167], a[16:19], v[228:231]
    buffer_load_dwordx4 v4, s[40:43], s100 offen offset:1024 lds
    s_waitcnt vmcnt(10)
    v_mfma_f32_16x16x32_bf16 v[192:195], v[168:171], a[20:23], v[192:195]
    ds_read_b128 a[12:15], v4 offset:44032
    v_mov_b32_dpp v19, v13 row_newbcast:9 row_mask:0x4 bank_mask:0xf
    v_mfma_f32_16x16x32_bf16 v[196:199], v[172:175], a[20:23], v[196:199]
    v_mov_b32_dpp v19, v13 row_newbcast:13 row_mask:0x8 bank_mask:0xf
    s_waitcnt lgkmcnt(6)
    v_mfma_f32_16x16x32_bf16 v[200:203], v[168:171], a[24:27], v[200:203]
    ds_read_b128 a[16:19], v4 offset:45056
    v_mov_b32_dpp v20, v13 row_newbcast:2 row_mask:0x1 bank_mask:0xf
    v_mfma_f32_16x16x32_bf16 v[204:207], v[172:175], a[24:27], v[204:207]
    buffer_load_dwordx4 v4, s[40:43], s100 offen offset:2048 lds
    v_mfma_f32_16x16x32_bf16 v[208:211], v[168:171], a[28:31], v[208:211]
    ds_read_b128 a[20:23], v4 offset:46080
    v_mov_b32_dpp v20, v13 row_newbcast:6 row_mask:0x2 bank_mask:0xf
    v_mfma_f32_16x16x32_bf16 v[212:215], v[172:175], a[28:31], v[212:215]
    buffer_load_dwordx4 v4, s[40:43], s100 offen offset:3072 lds
    s_waitcnt lgkmcnt(6)
    v_mfma_f32_16x16x32_bf16 v[216:219], v[168:171], a[32:35], v[216:219]
    ds_read_b128 a[24:27], v4 offset:47104
    v_mov_b32_dpp v20, v13 row_newbcast:10 row_mask:0x4 bank_mask:0xf
    v_mfma_f32_16x16x32_bf16 v[220:223], v[172:175], a[32:35], v[220:223]
    v_mov_b32_dpp v20, v13 row_newbcast:14 row_mask:0x8 bank_mask:0xf
    v_mfma_f32_16x16x32_bf16 v[224:227], v[168:171], a[36:39], v[224:227]
    ds_read_b128 a[28:31], v4 offset:48128
    v_mov_b32_dpp v21, v13 row_newbcast:3 row_mask:0x1 bank_mask:0xf
    v_mfma_f32_16x16x32_bf16 v[228:231], v[172:175], a[36:39], v[228:231]
    s_add_u32 s100, s100, 4096
    s_add_u32 m0, s101, 59392
    s_nop 0
    buffer_load_dwordx4 v4, s[40:43], s100 offen offset:0 lds
    s_waitcnt lgkmcnt(6)
    s_waitcnt vmcnt(11)
    v_mfma_f32_16x16x32_bf16 v[192:195], v[176:179], a[0:3], v[192:195]
    ds_read_b128 a[32:35], v4 offset:49152
    v_mov_b32_dpp v21, v13 row_newbcast:7 row_mask:0x2 bank_mask:0xf
    v_mfma_f32_16x16x32_bf16 v[196:199], v[180:183], a[0:3], v[196:199]
    v_mfma_f32_16x16x32_bf16 v[200:203], v[176:179], a[4:7], v[200:203]
    ds_read_b128 a[36:39], v4 offset:50176
    v_mov_b32_dpp v21, v13 row_newbcast:11 row_mask:0x4 bank_mask:0xf
    v_mfma_f32_16x16x32_bf16 v[204:207], v[180:183], a[4:7], v[204:207]
    v_mov_b32_dpp v21, v13 row_newbcast:15 row_mask:0x8 bank_mask:0xf
    buffer_load_dwordx4 v4, s[40:43], s100 offen offset:1024 lds
    s_waitcnt lgkmcnt(6)
    v_mfma_f32_16x16x32_bf16 v[208:211], v[176:179], a[8:11], v[208:211]
    s_mul_i32 s52, s71, 10240
    buffer_load_dwordx4 v4, s[40:43], s100 offen offset:2048 lds
    v_mfma_f32_16x16x32_bf16 v[212:215], v[180:183], a[8:11], v[212:215]
    v_mfma_f32_16x16x32_bf16 v[216:219], v[176:179], a[12:15], v[216:219]
    v_add_u32 v23, s52, v6
    v_mfma_f32_16x16x32_bf16 v[220:223], v[180:183], a[12:15], v[220:223]
    s_waitcnt lgkmcnt(4)
    v_mfma_f32_16x16x32_bf16 v[224:227], v[176:179], a[16:19], v[224:227]
    buffer_load_dwordx4 v4, s[40:43], s100 offen offset:3072 lds
    v_mfma_f32_16x16x32_bf16 v[228:231], v[180:183], a[16:19], v[228:231]
    s_waitcnt vmcnt(12)
    v_mfma_f32_16x16x32_bf16 v[192:195], v[184:187], a[20:23], v[192:195]
    v_accvgpr_read_b32 v11, a201
    s_sub_u32 s54, s20, 2621440
    s_sub_u32 s55, s21, 2621440
    buffer_load_dword a214, v4, s[40:43], s54 offen sc1
    buffer_load_dword a214, v4, s[40:43], s54 offen offset:1024 sc1
    buffer_load_dword a214, v11, s[40:43], s55 offen sc1
    v_accvgpr_read_b32 v11, a207
    s_add_u32 s54, s35, 3407872
    buffer_load_dword a214, v11, s[40:43], s54 offen sc1
    v_accvgpr_read_b32 v11, a215
    s_add_u32 s54, s97, 3407872
    buffer_load_dword a214, v11, s[40:43], s54 offen sc1
    v_mfma_f32_16x16x32_bf16 v[196:199], v[188:191], a[20:23], v[196:199]
    s_waitcnt lgkmcnt(2)
    v_mfma_f32_16x16x32_bf16 v[200:203], v[184:187], a[24:27], v[200:203]
    s_add_u32 s100, s100, 4096
    s_add_u32 m0, s101, 63488
    s_mov_b32 exec_hi, 0
    buffer_load_dwordx4 v4, s[40:43], s100 offen offset:0 lds
    s_mov_b32 exec_hi, -1
    v_mfma_f32_16x16x32_bf16 v[204:207], v[188:191], a[24:27], v[204:207]
    v_mfma_f32_16x16x32_bf16 v[208:211], v[184:187], a[28:31], v[208:211]
    v_mfma_f32_16x16x32_bf16 v[212:215], v[188:191], a[28:31], v[212:215]
    s_waitcnt lgkmcnt(0)
    v_mfma_f32_16x16x32_bf16 v[216:219], v[184:187], a[32:35], v[216:219]
    v_mfma_f32_16x16x32_bf16 v[220:223], v[188:191], a[32:35], v[220:223]
    v_mfma_f32_16x16x32_bf16 v[224:227], v[184:187], a[36:39], v[224:227]
    buffer_load_dword v250, v248, s[40:43], 0 offen sc1
    buffer_load_dwordx2 v[252:253], v249, s[40:43], 0 offen sc1
    v_mfma_f32_16x16x32_bf16 v[228:231], v[188:191], a[36:39], v[228:231]
    s_branch L_kvdone
L_pair:
    v_lshlrev_b32 v30, 3, v1
    s_lshl_b32 s49, s74, 12
    s_add_u32 s49, s49, 1179648
    buffer_load_dwordx2 a[48:49], v30, s[40:43], s49 offen offset:0 sc1
    buffer_load_dwordx2 a[50:51], v30, s[40:43], s49 offen offset:512 sc1
    buffer_load_dwordx2 a[52:53], v30, s[40:43], s49 offen offset:1024 sc1
    buffer_load_dwordx2 a[54:55], v30, s[40:43], s49 offen offset:1536 sc1
    buffer_load_dwordx2 a[56:57], v30, s[40:43], s49 offen offset:2048 sc1
    buffer_load_dwordx2 a[58:59], v30, s[40:43], s49 offen offset:2560 sc1
    buffer_load_dwordx2 a[60:61], v30, s[40:43], s49 offen offset:3072 sc1
    v_accvgpr_write_b32 a62, 0
    v_accvgpr_write_b32 a63, 0
    v_accvgpr_write_b32 a64, 0
    v_accvgpr_write_b32 a65, 0
    s_mov_b32 exec_lo, 0xff00ff
    s_mov_b32 exec_hi, 0xff00ff
    buffer_load_dwordx2 a[62:63], v30, s[40:43], s49 offen offset:3584 sc1
    s_mov_b64 exec, -1
    v_accvgpr_read_b32 v25, a203
    s_mov_b32 s95, s8
    s_mul_i32 s49, s71, 12800
    v_add_u32 v31, s49, v4
    ds_write_b128 v31, v[244:247] offset:0
    ds_write_b128 v31, v[248:251] offset:1024
    ds_write_b128 v31, v[252:255] offset:2048
    ds_write_b128 v31, v[160:163] offset:3072
    ds_write_b128 v31, v[164:167] offset:4096
    ds_write_b128 v31, v[168:171] offset:5120
    ds_write_b128 v31, v[172:175] offset:6144
    ds_write_b128 v31, a[216:219] offset:7168
    s_cmp_lg_u32 s71, 0
    s_cbranch_scc1 Lfl_10
    buffer_load_dword v22, v8, s[40:43], s30 offen sc1
Lfl_10:
    ds_write_b128 v31, a[220:223] offset:8192
    ds_write_b128 v31, a[224:227] offset:9216
    ds_write_b128 v31, a[228:231] offset:10240
    ds_write_b128 v31, a[232:235] offset:11264
    s_mov_b32 exec_hi, 0
    ds_write_b128 v31, a[236:239] offset:12288
    s_mov_b32 exec_hi, -1
    s_waitcnt lgkmcnt(0)
    s_waitcnt vmcnt(0)
    s_cmp_lg_u32 s71, 0
    s_cbranch_scc1 Lp2d_12
    s_mov_b32 s48, 0
Lp2_11:
    s_waitcnt vmcnt(0)
    v_cmp_ne_u32 vcc, s78, v22
    s_cbranch_vccz Lp2d_12
    buffer_load_dword v22, v8, s[40:43], s30 offen sc1
    s_add_u32 s48, s48, 1
    s_cmp_lt_u32 s48, 0x20000
    s_cbranch_scc1 Lp2_11
Lp2d_12:
    s_barrier
    buffer_load_dwordx4 v[32:35], v4, s[40:43], s95 offen offset:0 sc1
    buffer_load_dwordx4 v[36:39], v9, s[40:43], s95 offen offset:0 sc1
    ds_read_b128 a[0:3], v6 offset:0
    ds_read_b128 a[4:7], v6 offset:1024
    ds_read_b128 a[8:11], v6 offset:2048
    ds_read_b128 a[12:15], v6 offset:3072
    ds_read_b128 a[16:19], v6 offset:4096
    ds_read_b128 a[20:23], v6 offset:5120
    ds_read_b128 a[24:27], v6 offset:6144
    ds_read_b128 a[28:31], v6 offset:7168
    buffer_load_dwordx4 v[40:43], v4, s[40:43], s95 offen offset:1024 sc1
    buffer_load_dwordx4 v[44:47], v9, s[40:43], s95 offen offset:1024 sc1
    buffer_load_dwordx4 v[48:51], v4, s[40:43], s95 offen offset:2048 sc1
    buffer_load_dwordx4 v[52:55], v9, s[40:43], s95 offen offset:2048 sc1
    buffer_load_dwordx4 v[56:59], v4, s[40:43], s95 offen offset:3072 sc1
    buffer_load_dwordx4 v[60:63], v9, s[40:43], s95 offen offset:3072 sc1
    s_add_u32 s95, s95, 4096
    buffer_load_dwordx4 v[64:67], v4, s[40:43], s95 offen offset:0 sc1
    buffer_load_dwordx4 v[68:71], v9, s[40:43], s95 offen offset:0 sc1
    buffer_load_dwordx2 v[14:15], v25, s[40:43], s9 offen offset:0 sc1
    buffer_load_dwordx2 v[16:17], v25, s[40:43], s9 offen offset:128 sc1
    buffer_load_dwordx2 v[18:19], v25, s[40:43], s9 offen offset:1024 sc1
    buffer_load_dwordx2 v[20:21], v25, s[40:43], s9 offen offset:1152 sc1
    s_waitcnt lgkmcnt(6)
    s_waitcnt vmcnt(12)
    v_mfma_f32_16x16x32_bf16 v[192:195], v[32:35], a[0:3], 0
    ds_read_b128 a[32:35], v6 offset:8192
    buffer_load_dwordx4 v[72:75], v4, s[40:43], s95 offen offset:1024 sc1
    buffer_load_dwordx4 v[76:79], v9, s[40:43], s95 offen offset:1024 sc1
    v_mfma_f32_16x16x32_bf16 v[196:199], v[36:39], a[0:3], 0
    v_mfma_f32_16x16x32_bf16 v[200:203], v[32:35], a[4:7], 0
    ds_read_b128 a[36:39], v6 offset:9216
    v_mfma_f32_16x16x32_bf16 v[204:207], v[36:39], a[4:7], 0
    s_waitcnt lgkmcnt(6)
    v_mfma_f32_16x16x32_bf16 v[208:211], v[32:35], a[8:11], 0
    ds_read_b128 a[0:3], v6 offset:10240
    v_mfma_f32_16x16x32_bf16 v[212:215], v[36:39], a[8:11], 0
    v_mfma_f32_16x16x32_bf16 v[216:219], v[32:35], a[12:15], 0
    ds_read_b128 a[4:7], v6 offset:11264
    v_mfma_f32_16x16x32_bf16 v[220:223], v[36:39], a[12:15], 0
    s_waitcnt lgkmcnt(6)
    v_mfma_f32_16x16x32_bf16 v[224:227], v[32:35], a[16:19], 0
    ds_read_b128 a[8:11], v6 offset:12288
    v_mfma_f32_16x16x32_bf16 v[228:231], v[36:39], a[16:19], 0
    s_waitcnt vmcnt(12)
    v_mfma_f32_16x16x32_bf16 v[192:195], v[40:43], a[20:23], v[192:195]
    ds_read_b128 a[12:15], v6 offset:13312
    buffer_load_dwordx4 v[80:83], v4, s[40:43], s95 offen offset:2048 sc1
    buffer_load_dwordx4 v[84:87], v9, s[40:43], s95 offen offset:2048 sc1
    v_mfma_f32_16x16x32_bf16 v[196:199], v[44:47], a[20:23], v[196:199]
    s_waitcnt lgkmcnt(6)
    v_mfma_f32_16x16x32_bf16 v[200:203], v[40:43], a[24:27], v[200:203]
    ds_read_b128 a[16:19], v6 offset:14336
    v_mfma_f32_16x16x32_bf16 v[204:207], v[44:47], a[24:27], v[204:207]
    v_mfma_f32_16x16x32_bf16 v[208:211], v[40:43], a[28:31], v[208:211]
    ds_read_b128 a[20:23], v6 offset:15360
    v_mfma_f32_16x16x32_bf16 v[212:215], v[44:47], a[28:31], v[212:215]
    s_waitcnt lgkmcnt(6)
    v_mfma_f32_16x16x32_bf16 v[216:219], v[40:43], a[32:35], v[216:219]
    ds_read_b128 a[24:27], v6 offset:16384
    v_mfma_f32_16x16x32_bf16 v[220:223], v[44:47], a[32:35], v[220:223]
    v_mfma_f32_16x16x32_bf16 v[224:227], v[40:43], a[36:39], v[224:227]
    ds_read_b128 a[28:31], v6 offset:17408
    v_mfma_f32_16x16x32_bf16 v[228:231], v[44:47], a[36:39], v[228:231]
    s_waitcnt lgkmcnt(6)
    s_waitcnt vmcnt(12)
    v_mfma_f32_16x16x32_bf16 v[192:195], v[48:51], a[0:3], v[192:195]
    ds_read_b128 a[32:35], v6 offset:18432
    buffer_load_dwordx4 v[88:91], v4, s[40:43], s95 offen offset:3072 sc1
    buffer_load_dwordx4 v[92:95], v9, s[40:43], s95 offen offset:3072 sc1
    s_add_u32 s95, s95, 4096
    v_mfma_f32_16x16x32_bf16 v[196:199], v[52:55], a[0:3], v[196:199]
    v_mfma_f32_16x16x32_bf16 v[200:203], v[48:51], a[4:7], v[200:203]
    ds_read_b128 a[36:39], v6 offset:19456
    v_mfma_f32_16x16x32_bf16 v[204:207], v[52:55], a[4:7], v[204:207]
    s_waitcnt lgkmcnt(6)
    v_mfma_f32_16x16x32_bf16 v[208:211], v[48:51], a[8:11], v[208:211]
    ds_read_b128 a[0:3], v6 offset:20480
    v_mfma_f32_16x16x32_bf16 v[212:215], v[52:55], a[8:11], v[212:215]
    v_mfma_f32_16x16x32_bf16 v[216:219], v[48:51], a[12:15], v[216:219]
    ds_read_b128 a[4:7], v6 offset:21504
    v_mfma_f32_16x16x32_bf16 v[220:223], v[52:55], a[12:15], v[220:223]
    s_waitcnt lgkmcnt(6)
    v_mfma_f32_16x16x32_bf16 v[224:227], v[48:51], a[16:19], v[224:227]
    ds_read_b128 a[8:11], v6 offset:22528
    v_mfma_f32_16x16x32_bf16 v[228:231], v[52:55], a[16:19], v[228:231]
    s_waitcnt vmcnt(12)
    v_mfma_f32_16x16x32_bf16 v[192:195], v[56:59], a[20:23], v[192:195]
    ds_read_b128 a[12:15], v6 offset:23552
    buffer_load_dwordx4 v[96:99], v4, s[40:43], s95 offen offset:0 sc1
    buffer_load_dwordx4 v[100:103], v9, s[40:43], s95 offen offset:0 sc1
    v_mfma_f32_16x16x32_bf16 v[196:199], v[60:63], a[20:23], v[196:199]
    s_waitcnt lgkmcnt(6)
    v_mfma_f32_16x16x32_bf16 v[200:203], v[56:59], a[24:27], v[200:203]
    ds_read_b128 a[16:19], v6 offset:24576
    v_mfma_f32_16x16x32_bf16 v[204:207], v[60:63], a[24:27], v[204:207]
    v_mfma_f32_16x16x32_bf16 v[208:211], v[56:59], a[28:31], v[208:211]
    ds_read_b128 a[20:23], v6 offset:25600
    v_mfma_f32_16x16x32_bf16 v[212:215], v[60:63], a[28:31], v[212:215]
    s_waitcnt lgkmcnt(6)
    v_mfma_f32_16x16x32_bf16 v[216:219], v[56:59], a[32:35], v[216:219]
    ds_read_b128 a[24:27], v6 offset:26624
    v_mfma_f32_16x16x32_bf16 v[220:223], v[60:63], a[32:35], v[220:223]
    v_mfma_f32_16x16x32_bf16 v[224:227], v[56:59], a[36:39], v[224:227]
    ds_read_b128 a[28:31], v6 offset:27648
    v_mfma_f32_16x16x32_bf16 v[228:231], v[60:63], a[36:39], v[228:231]
    s_waitcnt lgkmcnt(6)
    s_waitcnt vmcnt(12)
    v_mfma_f32_16x16x32_bf16 v[192:195], v[64:67], a[0:3], v[192:195]
    ds_read_b128 a[32:35], v6 offset:28672
    buffer_load_dwordx4 v[104:107], v4, s[40:43], s95 offen offset:1024 sc1
    buffer_load_dwordx4 v[108:111], v9, s[40:43], s95 offen offset:1024 sc1
    v_mfma_f32_16x16x32_bf16 v[196:199], v[68:71], a[0:3], v[196:199]
    v_mfma_f32_16x16x32_bf16 v[200:203], v[64:67], a[4:7], v[200:203]
    ds_read_b128 a[36:39], v6 offset:29696
    v_mfma_f32_16x16x32_bf16 v[204:207], v[68:71], a[4:7], v[204:207]
    s_waitcnt lgkmcnt(6)
    v_mfma_f32_16x16x32_bf16 v[208:211], v[64:67], a[8:11], v[208:211]
    ds_read_b128 a[0:3], v6 offset:30720
    v_mfma_f32_16x16x32_bf16 v[212:215], v[68:71], a[8:11], v[212:215]
    v_mfma_f32_16x16x32_bf16 v[216:219], v[64:67], a[12:15], v[216:219]
    ds_read_b128 a[4:7], v6 offset:31744
    v_mfma_f32_16x16x32_bf16 v[220:223], v[68:71], a[12:15], v[220:223]
    s_waitcnt lgkmcnt(6)
    v_mfma_f32_16x16x32_bf16 v[224:227], v[64:67], a[16:19], v[224:227]
    ds_read_b128 a[8:11], v6 offset:32768
    v_mfma_f32_16x16x32_bf16 v[228:231], v[68:71], a[16:19], v[228:231]
    s_waitcnt vmcnt(8)
    v_mfma_f32_16x16x32_bf16 v[192:195], v[72:75], a[20:23], v[192:195]
    ds_read_b128 a[12:15], v6 offset:33792
    buffer_load_dwordx4 v[112:115], v4, s[40:43], s95 offen offset:2048 sc1
    buffer_load_dwordx4 v[116:119], v9, s[40:43], s95 offen offset:2048 sc1
    v_mfma_f32_16x16x32_bf16 v[196:199], v[76:79], a[20:23], v[196:199]
    s_waitcnt lgkmcnt(6)
    v_mfma_f32_16x16x32_bf16 v[200:203], v[72:75], a[24:27], v[200:203]
    ds_read_b128 a[16:19], v6 offset:34816
    v_add_f32 v14, v14, v16
    v_mfma_f32_16x16x32_bf16 v[204:207], v[76:79], a[24:27], v[204:207]
    v_add_f32 v15, v15, v17
    v_mfma_f32_16x16x32_bf16 v[208:211], v[72:75], a[28:31], v[208:211]
    ds_read_b128 a[20:23], v6 offset:35840
    v_add_f32 v18, v18, v20
    v_mfma_f32_16x16x32_bf16 v[212:215], v[76:79], a[28:31], v[212:215]
    s_waitcnt lgkmcnt(6)
    v_mfma_f32_16x16x32_bf16 v[216:219], v[72:75], a[32:35], v[216:219]
    ds_read_b128 a[24:27], v6 offset:36864
    v_add_f32 v19, v19, v21
    v_mfma_f32_16x16x32_bf16 v[220:223], v[76:79], a[32:35], v[220:223]
    v_mov_b32 v24, v14
    v_mfma_f32_16x16x32_bf16 v[224:227], v[72:75], a[36:39], v[224:227]
    ds_read_b128 a[28:31], v6 offset:37888
    v_mov_b32 v25, v15
    v_mfma_f32_16x16x32_bf16 v[228:231], v[76:79], a[36:39], v[228:231]
    s_waitcnt lgkmcnt(6)
    s_waitcnt vmcnt(8)
    v_mfma_f32_16x16x32_bf16 v[192:195], v[80:83], a[0:3], v[192:195]
    ds_read_b128 a[32:35], v6 offset:38912
    buffer_load_dwordx4 v[120:123], v4, s[40:43], s95 offen offset:3072 sc1
    buffer_load_dwordx4 v[124:127], v9, s[40:43], s95 offen offset:3072 sc1
    s_add_u32 s95, s95, 4096
    v_mfma_f32_16x16x32_bf16 v[196:199], v[84:87], a[0:3], v[196:199]
    v_mov_b32 v26, v18
    v_mfma_f32_16x16x32_bf16 v[200:203], v[80:83], a[4:7], v[200:203]
    ds_read_b128 a[36:39], v6 offset:39936
    v_mov_b32 v27, v19
    v_mfma_f32_16x16x32_bf16 v[204:207], v[84:87], a[4:7], v[204:207]
    v_permlane16_swap_b32 v14, v24
    s_waitcnt lgkmcnt(6)
    v_mfma_f32_16x16x32_bf16 v[208:211], v[80:83], a[8:11], v[208:211]
    ds_read_b128 a[0:3], v6 offset:40960
    v_permlane16_swap_b32 v15, v25
    v_mfma_f32_16x16x32_bf16 v[212:215], v[84:87], a[8:11], v[212:215]
    v_mfma_f32_16x16x32_bf16 v[216:219], v[80:83], a[12:15], v[216:219]
    ds_read_b128 a[4:7], v6 offset:41984
    v_permlane16_swap_b32 v18, v26
    v_mfma_f32_16x16x32_bf16 v[220:223], v[84:87], a[12:15], v[220:223]
    s_waitcnt lgkmcnt(6)
    v_mfma_f32_16x16x32_bf16 v[224:227], v[80:83], a[16:19], v[224:227]
    ds_read_b128 a[8:11], v6 offset:43008
    v_permlane16_swap_b32 v19, v27
    v_mfma_f32_16x16x32_bf16 v[228:231], v[84:87], a[16:19], v[228:231]
    v_add_f32 v14, v14, v24
    s_waitcnt vmcnt(8)
    v_mfma_f32_16x16x32_bf16 v[192:195], v[88:91], a[20:23], v[192:195]
    ds_read_b128 a[12:15], v6 offset:44032
    buffer_load_dwordx4 v[128:131], v4, s[40:43], s95 offen offset:0 sc1
    buffer_load_dwordx4 v[132:135], v9, s[40:43], s95 offen offset:0 sc1
    v_mfma_f32_16x16x32_bf16 v[196:199], v[92:95], a[20:23], v[196:199]
    v_add_f32 v15, v15, v25
    s_waitcnt lgkmcnt(6)
    v_mfma_f32_16x16x32_bf16 v[200:203], v[88:91], a[24:27], v[200:203]
    ds_read_b128 a[16:19], v6 offset:45056
    v_add_f32 v18, v18, v26
    v_mfma_f32_16x16x32_bf16 v[204:207], v[92:95], a[24:27], v[204:207]
    v_mfma_f32_16x16x32_bf16 v[208:211], v[88:91], a[28:31], v[208:211]
    ds_read_b128 a[20:23], v6 offset:46080
    v_add_f32 v19, v19, v27
    v_mfma_f32_16x16x32_bf16 v[212:215], v[92:95], a[28:31], v[212:215]
    v_mov_b32 v24, v14
    s_waitcnt lgkmcnt(6)
    v_mfma_f32_16x16x32_bf16 v[216:219], v[88:91], a[32:35], v[216:219]
    ds_read_b128 a[24:27], v6 offset:47104
    v_mov_b32 v25, v15
    v_mfma_f32_16x16x32_bf16 v[220:223], v[92:95], a[32:35], v[220:223]
    v_mfma_f32_16x16x32_bf16 v[224:227], v[88:91], a[36:39], v[224:227]
    ds_read_b128 a[28:31], v6 offset:48128
    v_mov_b32 v26, v18
    v_mfma_f32_16x16x32_bf16 v[228:231], v[92:95], a[36:39], v[228:231]
    s_waitcnt lgkmcnt(6)
    s_waitcnt vmcnt(8)
    v_mfma_f32_16x16x32_bf16 v[192:195], v[96:99], a[0:3], v[192:195]
    ds_read_b128 a[32:35], v6 offset:49152
    buffer_load_dwordx4 v[136:139], v4, s[40:43], s95 offen offset:1024 sc1
    buffer_load_dwordx4 v[140:143], v9, s[40:43], s95 offen offset:1024 sc1
    v_mfma_f32_16x16x32_bf16 v[196:199], v[100:103], a[0:3], v[196:199]
    v_mov_b32 v27, v19
    v_permlane32_swap_b32 v14, v24
    v_mfma_f32_16x16x32_bf16 v[200:203], v[96:99], a[4:7], v[200:203]
    ds_read_b128 a[36:39], v6 offset:50176
    v_permlane32_swap_b32 v15, v25
    v_mfma_f32_16x16x32_bf16 v[204:207], v[100:103], a[4:7], v[204:207]
    s_waitcnt lgkmcnt(6)
    v_mfma_f32_16x16x32_bf16 v[208:211], v[96:99], a[8:11], v[208:211]
    ds_read_b128 a[0:3], v4 offset:0
    v_permlane32_swap_b32 v18, v26
    v_mfma_f32_16x16x32_bf16 v[212:215], v[100:103], a[8:11], v[212:215]
    v_mfma_f32_16x16x32_bf16 v[216:219], v[96:99], a[12:15], v[216:219]
    ds_read_b128 a[4:7], v4 offset:1024
    v_permlane32_swap_b32 v19, v27
    v_mfma_f32_16x16x32_bf16 v[220:223], v[100:103], a[12:15], v[220:223]
    v_add_f32 v14, v14, v24
    s_waitcnt lgkmcnt(6)
    v_mfma_f32_16x16x32_bf16 v[224:227], v[96:99], a[16:19], v[224:227]
    ds_read_b128 a[8:11], v4 offset:2048
    v_add_f32 v15, v15, v25
    v_mfma_f32_16x16x32_bf16 v[228:231], v[100:103], a[16:19], v[228:231]
    s_waitcnt vmcnt(8)
    v_mfma_f32_16x16x32_bf16 v[192:195], v[104:107], a[20:23], v[192:195]
    ds_read_b128 a[12:15], v4 offset:3072
    buffer_load_dwordx4 v[144:147], v4, s[40:43], s95 offen offset:2048 sc1
    buffer_load_dwordx4 v[148:151], v9, s[40:43], s95 offen offset:2048 sc1
    v_mfma_f32_16x16x32_bf16 v[196:199], v[108:111], a[20:23], v[196:199]
    v_add_f32 v18, v18, v26
    v_add_f32 v19, v19, v27
    s_waitcnt lgkmcnt(6)
    v_mfma_f32_16x16x32_bf16 v[200:203], v[104:107], a[24:27], v[200:203]
    ds_read_b128 a[16:19], v4 offset:4096
    v_mul_f32 v24, 0xbacccccd, v14
    v_mfma_f32_16x16x32_bf16 v[204:207], v[108:111], a[24:27], v[204:207]
    v_mfma_f32_16x16x32_bf16 v[208:211], v[104:107], a[28:31], v[208:211]
    ds_read_b128 a[20:23], v4 offset:5120
    v_mul_f32 v15, 0x3acccccd, v15
    v_mfma_f32_16x16x32_bf16 v[212:215], v[108:111], a[28:31], v[212:215]
    s_waitcnt lgkmcnt(6)
    v_mfma_f32_16x16x32_bf16 v[216:219], v[104:107], a[32:35], v[216:219]
    ds_read_b128 a[24:27], v4 offset:6144
    v_fma_f32 v15, -v24, v24, v15
    v_mfma_f32_16x16x32_bf16 v[220:223], v[108:111], a[32:35], v[220:223]
    v_max_f32 v15, 0, v15
    v_mfma_f32_16x16x32_bf16 v[224:227], v[104:107], a[36:39], v[224:227]
    ds_read_b128 a[28:31], v4 offset:7168
    v_add_f32 v15, 0x3727c5ac, v15
    v_mfma_f32_16x16x32_bf16 v[228:231], v[108:111], a[36:39], v[228:231]
    s_waitcnt lgkmcnt(6)
    s_waitcnt vmcnt(8)
    v_mfma_f32_16x16x32_bf16 v[192:195], v[112:115], a[0:3], v[192:195]
    ds_read_b128 a[32:35], v4 offset:8192
    buffer_load_dwordx4 v[152:155], v4, s[40:43], s95 offen offset:3072 sc1
    buffer_load_dwordx4 v[156:159], v9, s[40:43], s95 offen offset:3072 sc1
    s_add_u32 s95, s95, 4096
    v_mfma_f32_16x16x32_bf16 v[196:199], v[116:119], a[0:3], v[196:199]
    v_cvt_pk_bf16_f32 v25, v24, v24
    v_mfma_f32_16x16x32_bf16 v[200:203], v[112:115], a[4:7], v[200:203]
    ds_read_b128 a[36:39], v4 offset:9216
    v_rsq_f32 v12, v15
    v_mfma_f32_16x16x32_bf16 v[204:207], v[116:119], a[4:7], v[204:207]
    v_and_b32 v25, 0xffff0000, v25
    s_waitcnt lgkmcnt(6)
    v_mfma_f32_16x16x32_bf16 v[208:211], v[112:115], a[8:11], v[208:211]
    ds_read_b128 a[0:3], v4 offset:10240
    v_sub_f32 v26, v24, v25
    v_mfma_f32_16x16x32_bf16 v[212:215], v[116:119], a[8:11], v[212:215]
    v_mfma_f32_16x16x32_bf16 v[216:219], v[112:115], a[12:15], v[216:219]
    ds_read_b128 a[4:7], v4 offset:11264
    v_cvt_pk_bf16_f32 v27, v25, v26
    v_mfma_f32_16x16x32_bf16 v[220:223], v[116:119], a[12:15], v[220:223]
    s_waitcnt lgkmcnt(6)
    v_mfma_f32_16x16x32_bf16 v[224:227], v[112:115], a[16:19], v[224:227]
    ds_read_b128 a[8:11], v4 offset:12288
    v_lshrrev_b32 v25, 16, v25
    v_mfma_f32_16x16x32_bf16 v[228:231], v[116:119], a[16:19], v[228:231]
    v_accvgpr_write_b32 a40, v27
    s_waitcnt vmcnt(8)
    v_mfma_f32_16x16x32_bf16 v[192:195], v[120:123], a[20:23], v[192:195]
    ds_read_b128 a[12:15], v4 offset:13312
    buffer_load_dwordx4 v[160:163], v4, s[40:43], s95 offen offset:0 sc1
    buffer_load_dwordx4 v[164:167], v9, s[40:43], s95 offen offset:0 sc1
    v_mfma_f32_16x16x32_bf16 v[196:199], v[124:127], a[20:23], v[196:199]
    v_accvgpr_write_b32 a41, v25
    s_waitcnt lgkmcnt(6)
    v_mfma_f32_16x16x32_bf16 v[200:203], v[120:123], a[24:27], v[200:203]
    ds_read_b128 a[16:19], v4 offset:14336
    v_accvgpr_write_b32 a42, 0
    v_mfma_f32_16x16x32_bf16 v[204:207], v[124:127], a[24:27], v[204:207]
    v_mfma_f32_16x16x32_bf16 v[208:211], v[120:123], a[28:31], v[208:211]
    ds_read_b128 a[20:23], v4 offset:15360
    v_accvgpr_write_b32 a43, 0
    v_mfma_f32_16x16x32_bf16 v[212:215], v[124:127], a[28:31], v[212:215]
    v_mul_f32 v24, 0xbacccccd, v18
    s_waitcnt lgkmcnt(6)
    v_mfma_f32_16x16x32_bf16 v[216:219], v[120:123], a[32:35], v[216:219]
    ds_read_b128 a[24:27], v4 offset:16384
    v_mul_f32 v19, 0x3acccccd, v19
    v_mfma_f32_16x16x32_bf16 v[220:223], v[124:127], a[32:35], v[220:223]
    v_mfma_f32_16x16x32_bf16 v[224:227], v[120:123], a[36:39], v[224:227]
    ds_read_b128 a[28:31], v4 offset:17408
    v_fma_f32 v19, -v24, v24, v19
    v_mfma_f32_16x16x32_bf16 v[228:231], v[124:127], a[36:39], v[228:231]
    s_waitcnt lgkmcnt(6)
    s_waitcnt vmcnt(8)
    s_barrier
    v_mfma_f32_16x16x32_bf16 v[192:195], v[128:131], a[0:3], v[192:195]
    ds_read_b128 a[32:35], v4 offset:18432
    buffer_load_dwordx4 v[168:171], v4, s[40:43], s95 offen offset:1024 sc1
    buffer_load_dwordx4 v[172:175], v9, s[40:43], s95 offen offset:1024 sc1
    v_mfma_f32_16x16x32_bf16 v[196:199], v[132:135], a[0:3], v[196:199]
    v_max_f32 v19, 0, v19
    v_add_f32 v19, 0x3727c5ac, v19
    v_mfma_f32_16x16x32_bf16 v[200:203], v[128:131], a[4:7], v[200:203]
    ds_read_b128 a[36:39], v4 offset:19456
    v_cvt_pk_bf16_f32 v25, v24, v24
    v_mfma_f32_16x16x32_bf16 v[204:207], v[132:135], a[4:7], v[204:207]
    s_waitcnt lgkmcnt(6)
    v_mfma_f32_16x16x32_bf16 v[208:211], v[128:131], a[8:11], v[208:211]
    ds_read_b128 a[0:3], v4 offset:20480
    v_rsq_f32 v13, v19
    v_mfma_f32_16x16x32_bf16 v[212:215], v[132:135], a[8:11], v[212:215]
    v_and_b32 v25, 0xffff0000, v25
    v_mfma_f32_16x16x32_bf16 v[216:219], v[128:131], a[12:15], v[216:219]
    ds_read_b128 a[4:7], v4 offset:21504
    v_sub_f32 v26, v24, v25
    v_mfma_f32_16x16x32_bf16 v[220:223], v[132:135], a[12:15], v[220:223]
    s_waitcnt lgkmcnt(6)
    v_mfma_f32_16x16x32_bf16 v[224:227], v[128:131], a[16:19], v[224:227]
    ds_read_b128 a[8:11], v4 offset:22528
    v_cvt_pk_bf16_f32 v27, v25, v26
    v_mfma_f32_16x16x32_bf16 v[228:231], v[132:135], a[16:19], v[228:231]
    s_waitcnt vmcnt(8)
    v_mfma_f32_16x16x32_bf16 v[192:195], v[136:139], a[20:23], v[192:195]
    ds_read_b128 a[12:15], v4 offset:23552
    buffer_load_dwordx4 v[176:179], v4, s[40:43], s95 offen offset:2048 sc1
    buffer_load_dwordx4 v[180:183], v9, s[40:43], s95 offen offset:2048 sc1
    v_mfma_f32_16x16x32_bf16 v[196:199], v[140:143], a[20:23], v[196:199]
    v_lshrrev_b32 v25, 16, v25
    v_accvgpr_write_b32 a44, v27
    s_waitcnt lgkmcnt(6)
    v_mfma_f32_16x16x32_bf16 v[200:203], v[136:139], a[24:27], v[200:203]
    ds_read_b128 a[16:19], v4 offset:24576
    v_accvgpr_write_b32 a45, v25
    v_mfma_f32_16x16x32_bf16 v[204:207], v[140:143], a[24:27], v[204:207]
    v_mfma_f32_16x16x32_bf16 v[208:211], v[136:139], a[28:31], v[208:211]
    ds_read_b128 a[20:23], v4 offset:25600
    v_accvgpr_write_b32 a46, 0
    v_mfma_f32_16x16x32_bf16 v[212:215], v[140:143], a[28:31], v[212:215]
    s_waitcnt lgkmcnt(6)
    v_mfma_f32_16x16x32_bf16 v[216:219], v[136:139], a[32:35], v[216:219]
    ds_read_b128 a[24:27], v4 offset:26624
    v_accvgpr_write_b32 a47, 0
    v_mfma_f32_16x16x32_bf16 v[220:223], v[140:143], a[32:35], v[220:223]
    v_mov_b32_dpp v14, v12 row_newbcast:0 row_mask:0x1 bank_mask:0xf
    v_mfma_f32_16x16x32_bf16 v[224:227], v[136:139], a[36:39], v[224:227]
    ds_read_b128 a[28:31], v4 offset:27648
    v_mov_b32_dpp v14, v12 row_newbcast:4 row_mask:0x2 bank_mask:0xf
    v_mfma_f32_16x16x32_bf16 v[228:231], v[140:143], a[36:39], v[228:231]
    s_waitcnt lgkmcnt(6)
    s_waitcnt vmcnt(8)
    v_mfma_f32_16x16x32_bf16 v[192:195], v[144:147], a[0:3], v[192:195]
    ds_read_b128 a[32:35], v4 offset:28672
    buffer_load_dwordx4 v[184:187], v4, s[40:43], s95 offen offset:3072 sc1
    buffer_load_dwordx4 v[188:191], v9, s[40:43], s95 offen offset:3072 sc1
    v_mfma_f32_16x16x32_bf16 v[196:199], v[148:151], a[0:3], v[196:199]
    v_mov_b32_dpp v14, v12 row_newbcast:8 row_mask:0x4 bank_mask:0xf
    v_mfma_f32_16x16x32_bf16 v[200:203], v[144:147], a[4:7], v[200:203]
    ds_read_b128 a[36:39], v4 offset:29696
    v_mov_b32_dpp v14, v12 row_newbcast:12 row_mask:0x8 bank_mask:0xf
    v_mfma_f32_16x16x32_bf16 v[204:207], v[148:151], a[4:7], v[204:207]
    v_mov_b32_dpp v15, v12 row_newbcast:1 row_mask:0x1 bank_mask:0xf
    s_waitcnt lgkmcnt(6)
    v_mfma_f32_16x16x32_bf16 v[208:211], v[144:147], a[8:11], v[208:211]
    ds_read_b128 a[0:3], v4 offset:30720
    v_mov_b32_dpp v15, v12 row_newbcast:5 row_mask:0x2 bank_mask:0xf
    v_mfma_f32_16x16x32_bf16 v[212:215], v[148:151], a[8:11], v[212:215]
    v_mfma_f32_16x16x32_bf16 v[216:219], v[144:147], a[12:15], v[216:219]
    ds_read_b128 a[4:7], v4 offset:31744
    v_mov_b32_dpp v15, v12 row_newbcast:9 row_mask:0x4 bank_mask:0xf
    v_mfma_f32_16x16x32_bf16 v[220:223], v[148:151], a[12:15], v[220:223]
    s_waitcnt lgkmcnt(6)
    v_mfma_f32_16x16x32_bf16 v[224:227], v[144:147], a[16:19], v[224:227]
    ds_read_b128 a[8:11], v4 offset:32768
    v_mov_b32_dpp v15, v12 row_newbcast:13 row_mask:0x8 bank_mask:0xf
    v_mfma_f32_16x16x32_bf16 v[228:231], v[148:151], a[16:19], v[228:231]
    v_mov_b32_dpp v16, v12 row_newbcast:2 row_mask:0x1 bank_mask:0xf
    s_waitcnt vmcnt(8)
    v_mfma_f32_16x16x32_bf16 v[192:195], v[152:155], a[20:23], v[192:195]
    ds_read_b128 a[12:15], v4 offset:33792
    v_mov_b32_dpp v16, v12 row_newbcast:6 row_mask:0x2 bank_mask:0xf
    v_mfma_f32_16x16x32_bf16 v[196:199], v[156:159], a[20:23], v[196:199]
    s_waitcnt lgkmcnt(6)
    v_mfma_f32_16x16x32_bf16 v[200:203], v[152:155], a[24:27], v[200:203]
    ds_read_b128 a[16:19], v4 offset:34816
    v_mov_b32_dpp v16, v12 row_newbcast:10 row_mask:0x4 bank_mask:0xf
    v_mfma_f32_16x16x32_bf16 v[204:207], v[156:159], a[24:27], v[204:207]
    s_mul_i32 s101, s71, 12800
    s_add_u32 s100, s101, s34
    s_add_u32 s100, s100, 4296704
    s_add_u32 m0, s101, 51200
    s_nop 0
    buffer_load_dwordx4 v4, s[40:43], s100 offen offset:0 lds
    v_mfma_f32_16x16x32_bf16 v[208:211], v[152:155], a[28:31], v[208:211]
    ds_read_b128 a[20:23], v4 offset:35840
    v_mov_b32_dpp v16, v12 row_newbcast:14 row_mask:0x8 bank_mask:0xf
    v_mfma_f32_16x16x32_bf16 v[212:215], v[156:159], a[28:31], v[212:215]
    v_mov_b32_dpp v17, v12 row_newbcast:3 row_mask:0x1 bank_mask:0xf
    buffer_load_dwordx4 v4, s[40:43], s100 offen offset:1024 lds
    s_waitcnt lgkmcnt(6)
    v_mfma_f32_16x16x32_bf16 v[216:219], v[152:155], a[32:35], v[216:219]
    ds_read_b128 a[24:27], v4 offset:36864
    v_mov_b32_dpp v17, v12 row_newbcast:7 row_mask:0x2 bank_mask:0xf
    v_mfma_f32_16x16x32_bf16 v[220:223], v[156:159], a[32:35], v[220:223]
    v_mfma_f32_16x16x32_bf16 v[224:227], v[152:155], a[36:39], v[224:227]
    ds_read_b128 a[28:31], v4 offset:37888
    v_mov_b32_dpp v17, v12 row_newbcast:11 row_mask:0x4 bank_mask:0xf
    v_mfma_f32_16x16x32_bf16 v[228:231], v[156:159], a[36:39], v[228:231]
    v_mov_b32_dpp v17, v12 row_newbcast:15 row_mask:0x8 bank_mask:0xf
    buffer_load_dwordx4 v4, s[40:43], s100 offen offset:2048 lds
    s_waitcnt lgkmcnt(6)
    s_waitcnt vmcnt(9)
    v_mfma_f32_16x16x32_bf16 v[192:195], v[160:163], a[0:3], v[192:195]
    ds_read_b128 a[32:35], v4 offset:38912
    v_mov_b32_dpp v18, v13 row_newbcast:0 row_mask:0x1 bank_mask:0xf
    v_mfma_f32_16x16x32_bf16 v[196:199], v[164:167], a[0:3], v[196:199]
    v_mfma_f32_16x16x32_bf16 v[200:203], v[160:163], a[4:7], v[200:203]
    ds_read_b128 a[36:39], v4 offset:39936
    v_mov_b32_dpp v18, v13 row_newbcast:4 row_mask:0x2 bank_mask:0xf
    v_mfma_f32_16x16x32_bf16 v[204:207], v[164:167], a[4:7], v[204:207]
    buffer_load_dwordx4 v4, s[40:43], s100 offen offset:3072 lds
    s_waitcnt lgkmcnt(6)
    v_mfma_f32_16x16x32_bf16 v[208:211], v[160:163], a[8:11], v[208:211]
    ds_read_b128 a[0:3], v4 offset:40960
    v_mov_b32_dpp v18, v13 row_newbcast:8 row_mask:0x4 bank_mask:0xf
    v_mfma_f32_16x16x32_bf16 v[212:215], v[164:167], a[8:11], v[212:215]
    v_mov_b32_dpp v18, v13 row_newbcast:12 row_mask:0x8 bank_mask:0xf
    v_mfma_f32_16x16x32_bf16 v[216:219], v[160:163], a[12:15], v[216:219]
    ds_read_b128 a[4:7], v4 offset:41984
    v_mov_b32_dpp v19, v13 row_newbcast:1 row_mask:0x1 bank_mask:0xf
    v_mfma_f32_16x16x32_bf16 v[220:223], v[164:167], a[12:15], v[220:223]
    s_add_u32 s100, s100, 4096
    s_add_u32 m0, s101, 55296
    s_nop 0
    buffer_load_dwordx4 v4, s[40:43], s100 offen offset:0 lds
    s_waitcnt lgkmcnt(6)
    v_mfma_f32_16x16x32_bf16 v[224:227], v[160:163], a[16:19], v[224:227]
    ds_read_b128 a[8:11], v4 offset:43008
    v_mov_b32_dpp v19, v13 row_newbcast:5 row_mask:0x2 bank_mask:0xf
    v_mfma_f32_16x16x32_bf16 v[228:231], v[164:167], a[16:19], v[228:231]
    buffer_load_dwordx4 v4, s[40:43], s100 offen offset:1024 lds
    s_waitcnt vmcnt(10)
    v_mfma_f32_16x16x32_bf16 v[192:195], v[168:171], a[20:23], v[192:195]
    ds_read_b128 a[12:15], v4 offset:44032
    v_mov_b32_dpp v19, v13 row_newbcast:9 row_mask:0x4 bank_mask:0xf
    v_mfma_f32_16x16x32_bf16 v[196:199], v[172:175], a[20:23], v[196:199]
    v_mov_b32_dpp v19, v13 row_newbcast:13 row_mask:0x8 bank_mask:0xf
    s_waitcnt lgkmcnt(6)
    v_mfma_f32_16x16x32_bf16 v[200:203], v[168:171], a[24:27], v[200:203]
    ds_read_b128 a[16:19], v4 offset:45056
    v_mov_b32_dpp v20, v13 row_newbcast:2 row_mask:0x1 bank_mask:0xf
    v_mfma_f32_16x16x32_bf16 v[204:207], v[172:175], a[24:27], v[204:207]
    buffer_load_dwordx4 v4, s[40:43], s100 offen offset:2048 lds
    v_mfma_f32_16x16x32_bf16 v[208:211], v[168:171], a[28:31], v[208:211]
    ds_read_b128 a[20:23], v4 offset:46080
    v_mov_b32_dpp v20, v13 row_newbcast:6 row_mask:0x2 bank_mask:0xf
    v_mfma_f32_16x16x32_bf16 v[212:215], v[172:175], a[28:31], v[212:215]
    s_waitcnt lgkmcnt(6)
    v_mfma_f32_16x16x32_bf16 v[216:219], v[168:171], a[32:35], v[216:219]
    ds_read_b128 a[24:27], v4 offset:47104
    v_mov_b32_dpp v20, v13 row_newbcast:10 row_mask:0x4 bank_mask:0xf
    v_mfma_f32_16x16x32_bf16 v[220:223], v[172:175], a[32:35], v[220:223]
    v_mov_b32_dpp v20, v13 row_newbcast:14 row_mask:0x8 bank_mask:0xf
    buffer_load_dwordx4 v4, s[40:43], s100 offen offset:3072 lds
    v_mfma_f32_16x16x32_bf16 v[224:227], v[168:171], a[36:39], v[224:227]
    ds_read_b128 a[28:31], v4 offset:48128
    v_mov_b32_dpp v21, v13 row_newbcast:3 row_mask:0x1 bank_mask:0xf
    v_mfma_f32_16x16x32_bf16 v[228:231], v[172:175], a[36:39], v[228:231]
    s_waitcnt lgkmcnt(6)
    s_waitcnt vmcnt(10)
    v_mfma_f32_16x16x32_bf16 v[192:195], v[176:179], a[0:3], v[192:195]
    ds_read_b128 a[32:35], v4 offset:49152
    v_mov_b32_dpp v21, v13 row_newbcast:7 row_mask:0x2 bank_mask:0xf
    v_mfma_f32_16x16x32_bf16 v[196:199], v[180:183], a[0:3], v[196:199]
    s_add_u32 s100, s100, 4096
    s_add_u32 m0, s101, 59392
    s_nop 0
    buffer_load_dwordx4 v4, s[40:43], s100 offen offset:0 lds
    v_mfma_f32_16x16x32_bf16 v[200:203], v[176:179], a[4:7], v[200:203]
    ds_read_b128 a[36:39], v4 offset:50176
    v_mov_b32_dpp v21, v13 row_newbcast:11 row_mask:0x4 bank_mask:0xf
    v_mfma_f32_16x16x32_bf16 v[204:207], v[180:183], a[4:7], v[204:207]
    v_mov_b32_dpp v21, v13 row_newbcast:15 row_mask:0x8 bank_mask:0xf
    buffer_load_dwordx4 v4, s[40:43], s100 offen offset:1024 lds
    s_waitcnt lgkmcnt(6)
    v_mfma_f32_16x16x32_bf16 v[208:211], v[176:179], a[8:11], v[208:211]
    s_mul_i32 s52, s71, 10240
    v_mfma_f32_16x16x32_bf16 v[212:215], v[180:183], a[8:11], v[212:215]
    v_mfma_f32_16x16x32_bf16 v[216:219], v[176:179], a[12:15], v[216:219]
    v_add_u32 v23, s52, v6
    buffer_load_dwordx4 v4, s[40:43], s100 offen offset:2048 lds
    v_mfma_f32_16x16x32_bf16 v[220:223], v[180:183], a[12:15], v[220:223]
    s_waitcnt lgkmcnt(4)
    v_mfma_f32_16x16x32_bf16 v[224:227], v[176:179], a[16:19], v[224:227]
    v_mfma_f32_16x16x32_bf16 v[228:231], v[180:183], a[16:19], v[228:231]
    s_waitcnt vmcnt(11)
    v_mfma_f32_16x16x32_bf16 v[192:195], v[184:187], a[20:23], v[192:195]
    buffer_load_dwordx4 v4, s[40:43], s100 offen offset:3072 lds
    v_mfma_f32_16x16x32_bf16 v[196:199], v[188:191], a[20:23], v[196:199]
    s_waitcnt lgkmcnt(2)
    v_mfma_f32_16x16x32_bf16 v[200:203], v[184:187], a[24:27], v[200:203]
    v_mfma_f32_16x16x32_bf16 v[204:207], v[188:191], a[24:27], v[204:207]
    v_mfma_f32_16x16x32_bf16 v[208:211], v[184:187], a[28:31], v[208:211]
    s_add_u32 s100, s100, 4096
    s_add_u32 m0, s101, 63488
    s_mov_b32 exec_hi, 0
    buffer_load_dwordx4 v4, s[40:43], s100 offen offset:0 lds
    s_mov_b32 exec_hi, -1
    v_mfma_f32_16x16x32_bf16 v[212:215], v[188:191], a[28:31], v[212:215]
    s_waitcnt lgkmcnt(0)
    v_mfma_f32_16x16x32_bf16 v[216:219], v[184:187], a[32:35], v[216:219]
    v_mfma_f32_16x16x32_bf16 v[220:223], v[188:191], a[32:35], v[220:223]
    v_mfma_f32_16x16x32_bf16 v[224:227], v[184:187], a[36:39], v[224:227]
    v_mfma_f32_16x16x32_bf16 v[228:231], v[188:191], a[36:39], v[228:231]
L_kvdone:
    v_mfma_f32_16x16x32_bf16 v[208:211], a[40:43], a[52:55], v[208:211]
    v_mfma_f32_16x16x32_bf16 v[212:215], a[44:47], a[52:55], v[212:215]
    v_mfma_f32_16x16x32_bf16 v[216:219], a[40:43], a[54:57], v[216:219]
    v_mfma_f32_16x16x32_bf16 v[220:223], a[44:47], a[54:57], v[220:223]
    v_mfma_f32_16x16x32_bf16 v[224:227], a[40:43], a[56:59], v[224:227]
    v_mfma_f32_16x16x32_bf16 v[228:231], a[44:47], a[56:59], v[228:231]
    v_mfma_f32_16x16x32_bf16 v[192:195], a[40:43], a[48:51], v[192:195]
    v_mfma_f32_16x16x32_bf16 v[196:199], a[44:47], a[48:51], v[196:199]
    v_mfma_f32_16x16x32_bf16 v[200:203], a[40:43], a[50:53], v[200:203]
    v_mfma_f32_16x16x32_bf16 v[204:207], a[44:47], a[50:53], v[204:207]
    s_mov_b32 exec_lo, 0xff00ff
    s_mov_b32 exec_hi, 0xff00ff
    v_pk_fma_f32 v[24:25], v[208:209], v[14:15], 1.0 op_sel_hi:[1,1,0]
    v_pk_fma_f32 v[26:27], v[210:211], v[16:17], 1.0 op_sel_hi:[1,1,0]
    v_pk_fma_f32 v[28:29], v[24:25], s[86:87], s[86:87] neg_lo:[0,0,1] neg_hi:[0,0,1]
    v_pk_fma_f32 v[30:31], v[26:27], s[86:87], s[86:87] neg_lo:[0,0,1] neg_hi:[0,0,1]
    v_exp_f32 v28, v28
    v_exp_f32 v29, v29
    v_exp_f32 v30, v30
    v_exp_f32 v31, v31
    v_med3_f32 v24, v24, v28, 1.0
    v_med3_f32 v25, v25, v29, 1.0
    v_med3_f32 v26, v26, v30, 1.0
    v_med3_f32 v27, v27, v31, 1.0
    v_pk_add_f32 v[208:209], v[24:25], s[88:89]
    v_pk_add_f32 v[210:211], v[26:27], s[88:89]
    v_pk_fma_f32 v[24:25], v[212:213], v[18:19], 1.0 op_sel_hi:[1,1,0]
    v_pk_fma_f32 v[26:27], v[214:215], v[20:21], 1.0 op_sel_hi:[1,1,0]
    v_pk_fma_f32 v[28:29], v[24:25], s[86:87], s[86:87] neg_lo:[0,0,1] neg_hi:[0,0,1]
    v_pk_fma_f32 v[30:31], v[26:27], s[86:87], s[86:87] neg_lo:[0,0,1] neg_hi:[0,0,1]
    v_exp_f32 v28, v28
    v_exp_f32 v29, v29
    v_exp_f32 v30, v30
    v_exp_f32 v31, v31
    v_med3_f32 v24, v24, v28, 1.0
    v_med3_f32 v25, v25, v29, 1.0
    v_med3_f32 v26, v26, v30, 1.0
    v_med3_f32 v27, v27, v31, 1.0
    v_pk_add_f32 v[212:213], v[24:25], s[88:89]
    v_pk_add_f32 v[214:215], v[26:27], s[88:89]
    s_mov_b32 exec_lo, 0xff00ff00
    s_mov_b32 exec_hi, 0xff00ff00
    v_pk_mul_f32 v[208:209], v[208:209], v[14:15]
    v_pk_mul_f32 v[210:211], v[210:211], v[16:17]
    v_pk_mul_f32 v[212:213], v[212:213], v[18:19]
    v_pk_mul_f32 v[214:215], v[214:215], v[20:21]
    s_mov_b64 exec, -1
    v_cvt_pk_bf16_f32 v208, v208, v209
    v_cvt_pk_bf16_f32 v209, v210, v211
    v_cvt_pk_bf16_f32 v210, v212, v213
    v_cvt_pk_bf16_f32 v211, v214, v215
    v_pk_mul_f32 v[216:217], v[216:217], v[14:15]
    v_pk_mul_f32 v[218:219], v[218:219], v[16:17]
    v_pk_mul_f32 v[220:221], v[220:221], v[18:19]
    v_pk_mul_f32 v[222:223], v[222:223], v[20:21]
    v_cvt_pk_bf16_f32 v216, v216, v217
    v_cvt_pk_bf16_f32 v217, v218, v219
    v_cvt_pk_bf16_f32 v218, v220, v221
    v_cvt_pk_bf16_f32 v219, v222, v223
    v_pk_mul_f32 v[224:225], v[224:225], v[14:15]
    v_pk_mul_f32 v[226:227], v[226:227], v[16:17]
    v_pk_mul_f32 v[228:229], v[228:229], v[18:19]
    v_pk_mul_f32 v[230:231], v[230:231], v[20:21]
    v_cvt_pk_bf16_f32 v224, v224, v225
    v_cvt_pk_bf16_f32 v225, v226, v227
    v_cvt_pk_bf16_f32 v226, v228, v229
    v_cvt_pk_bf16_f32 v227, v230, v231
    v_mfma_f32_16x16x32_bf16 a[68:71], v[208:211], v[216:219], 0
    s_nop 0
    v_mfma_f32_16x16x32_bf16 a[72:75], v[208:211], v[224:227], 0
    v_mfma_f32_16x16x32_bf16 a[104:107], v[208:211], a[240:243], 0
    v_pk_fma_f32 v[24:25], v[192:193], v[14:15], 1.0 op_sel_hi:[1,1,0]
    v_pk_fma_f32 v[26:27], v[194:195], v[16:17], 1.0 op_sel_hi:[1,1,0]
    v_pk_fma_f32 v[28:29], v[24:25], s[86:87], s[86:87] neg_lo:[0,0,1] neg_hi:[0,0,1]
    v_pk_fma_f32 v[30:31], v[26:27], s[86:87], s[86:87] neg_lo:[0,0,1] neg_hi:[0,0,1]
    v_exp_f32 v28, v28
    v_exp_f32 v29, v29
    v_exp_f32 v30, v30
    v_exp_f32 v31, v31
    v_med3_f32 v24, v24, v28, 1.0
    v_med3_f32 v25, v25, v29, 1.0
    v_med3_f32 v26, v26, v30, 1.0
    v_med3_f32 v27, v27, v31, 1.0
    v_pk_add_f32 v[192:193], v[24:25], s[88:89]
    v_pk_add_f32 v[194:195], v[26:27], s[88:89]
    v_pk_fma_f32 v[24:25], v[196:197], v[18:19], 1.0 op_sel_hi:[1,1,0]
    v_pk_fma_f32 v[26:27], v[198:199], v[20:21], 1.0 op_sel_hi:[1,1,0]
    v_pk_fma_f32 v[28:29], v[24:25], s[86:87], s[86:87] neg_lo:[0,0,1] neg_hi:[0,0,1]
    v_pk_fma_f32 v[30:31], v[26:27], s[86:87], s[86:87] neg_lo:[0,0,1] neg_hi:[0,0,1]
    v_exp_f32 v28, v28
    v_exp_f32 v29, v29
    v_exp_f32 v30, v30
    v_exp_f32 v31, v31
    v_med3_f32 v24, v24, v28, 1.0
    v_med3_f32 v25, v25, v29, 1.0
    v_med3_f32 v26, v26, v30, 1.0
    v_med3_f32 v27, v27, v31, 1.0
    v_pk_add_f32 v[196:197], v[24:25], s[88:89]
    v_pk_add_f32 v[198:199], v[26:27], s[88:89]
    v_cvt_pk_bf16_f32 v192, v192, v193
    v_cvt_pk_bf16_f32 v193, v194, v195
    v_cvt_pk_bf16_f32 v194, v196, v197
    v_cvt_pk_bf16_f32 v195, v198, v199
    s_mov_b32 exec_lo, 0xf000f000
    s_mov_b32 exec_hi, 0x0
    ds_write_b128 v23, a[68:71] offset:0
    s_mov_b32 exec_lo, 0xffffffff
    s_mov_b32 exec_hi, 0x0
    ds_write_b128 v23, a[72:75] offset:1024
    s_mov_b32 exec_lo, 0x10011001
    s_mov_b32 exec_hi, 0x10011001
    ds_write_b128 v23, a[104:107] offset:9216
    s_mov_b64 exec, -1
    v_mfma_f32_16x16x32_bf16 a[76:79], v[192:195], v[208:211], 0
    v_mfma_f32_16x16x32_bf16 a[80:83], v[192:195], v[216:219], 0
    v_mfma_f32_16x16x32_bf16 a[96:99], v[192:195], a[240:243], 0
    v_pk_fma_f32 v[24:25], v[200:201], v[14:15], 1.0 op_sel_hi:[1,1,0]
    v_pk_fma_f32 v[26:27], v[202:203], v[16:17], 1.0 op_sel_hi:[1,1,0]
    v_pk_fma_f32 v[28:29], v[24:25], s[86:87], s[86:87] neg_lo:[0,0,1] neg_hi:[0,0,1]
    v_pk_fma_f32 v[30:31], v[26:27], s[86:87], s[86:87] neg_lo:[0,0,1] neg_hi:[0,0,1]
    v_exp_f32 v28, v28
    v_exp_f32 v29, v29
    v_exp_f32 v30, v30
    v_exp_f32 v31, v31
    v_med3_f32 v24, v24, v28, 1.0
    v_med3_f32 v25, v25, v29, 1.0
    v_med3_f32 v26, v26, v30, 1.0
    v_med3_f32 v27, v27, v31, 1.0
    v_pk_add_f32 v[200:201], v[24:25], s[88:89]
    v_pk_add_f32 v[202:203], v[26:27], s[88:89]
    v_pk_fma_f32 v[24:25], v[204:205], v[18:19], 1.0 op_sel_hi:[1,1,0]
    v_pk_fma_f32 v[26:27], v[206:207], v[20:21], 1.0 op_sel_hi:[1,1,0]
    v_pk_fma_f32 v[28:29], v[24:25], s[86:87], s[86:87] neg_lo:[0,0,1] neg_hi:[0,0,1]
    v_pk_fma_f32 v[30:31], v[26:27], s[86:87], s[86:87] neg_lo:[0,0,1] neg_hi:[0,0,1]
    v_exp_f32 v28, v28
    v_exp_f32 v29, v29
    v_exp_f32 v30, v30
    v_exp_f32 v31, v31
    v_med3_f32 v24, v24, v28, 1.0
    v_med3_f32 v25, v25, v29, 1.0
    v_med3_f32 v26, v26, v30, 1.0
    v_med3_f32 v27, v27, v31, 1.0
    v_pk_add_f32 v[204:205], v[24:25], s[88:89]
    v_pk_add_f32 v[206:207], v[26:27], s[88:89]
    v_cvt_pk_bf16_f32 v200, v200, v201
    v_cvt_pk_bf16_f32 v201, v202, v203
    v_cvt_pk_bf16_f32 v202, v204, v205
    v_cvt_pk_bf16_f32 v203, v206, v207
    s_nop 1
    v_mfma_f32_16x16x32_bf16 a[84:87], v[200:203], v[208:211], 0
    v_mfma_f32_16x16x32_bf16 a[88:91], v[200:203], v[216:219], 0
    v_mfma_f32_16x16x32_bf16 a[92:95], v[200:203], v[224:227], 0
    v_mfma_f32_16x16x32_bf16 a[100:103], v[200:203], a[240:243], 0
    s_mov_b32 exec_lo, 0xff00ff00
    s_mov_b32 exec_hi, 0xff00ff00
    ds_write_b128 v23, a[76:79] offset:2048
    s_mov_b32 exec_lo, 0xfff0fff
    s_mov_b32 exec_hi, 0xfff0fff
    ds_write_b128 v23, a[80:83] offset:3072
    s_mov_b32 exec_lo, 0x10011001
    s_mov_b32 exec_hi, 0x10011001
    ds_write_b128 v23, a[96:99] offset:7168
    s_mov_b64 exec, -1
    v_lshlrev_b32 v25, 2, v0
    v_accvgpr_read_b32 v27, a206
    v_mov_b32 v26, 224
    v_cmp_gt_u32 s[84:85], v26, v0
    s_mov_b64 exec, 0xff00
    ds_write_b128 v23, a[84:87] offset:4096
    s_mov_b32 exec_lo, 0xf0000fff
    s_mov_b32 exec_hi, 0xf000f000
    ds_write_b128 v23, a[88:91] offset:5120
    s_mov_b32 exec_lo, 0xffff0000
    s_mov_b32 exec_hi, 0xffffffff
    ds_write_b128 v23, a[92:95] offset:6144
    s_mov_b32 exec_lo, 0x10011001
    s_mov_b32 exec_hi, 0x10011001
    ds_write_b128 v23, a[100:103] offset:8192
    s_mov_b64 exec, -1
    s_waitcnt vmcnt(0) lgkmcnt(0)
    s_barrier
    ds_read_b128 v[192:195], v27 offset:0
    ds_read_b128 v[196:199], v27 offset:10240
    ds_read_b128 v[200:203], v27 offset:20480
    ds_read_b128 v[204:207], v27 offset:30720
    s_waitcnt lgkmcnt(0)
    v_pk_add_f32 v[192:193], v[192:193], v[196:197]
    v_pk_add_f32 v[200:201], v[200:201], v[204:205]
    v_pk_add_f32 v[194:195], v[194:195], v[198:199]
    v_pk_add_f32 v[202:203], v[202:203], v[206:207]
    v_pk_add_f32 v[192:193], v[192:193], v[200:201]
    v_pk_add_f32 v[194:195], v[194:195], v[202:203]
    s_mov_b32 exec_lo, 0x80008000
    s_mov_b32 exec_hi, 0x80008000
    v_mov_b32 v192, 1.0
    v_mov_b32 v193, 1.0
    v_mov_b32 v194, 1.0
    v_mov_b32 v195, 1.0
    s_mov_b64 exec, s[84:85]
    buffer_atomic_add_f32 v192, v25, s[40:43], s11 offen offset:0
    buffer_atomic_add_f32 v193, v25, s[40:43], s11 offen offset:1024
    buffer_atomic_add_f32 v194, v25, s[40:43], s11 offen offset:2048
    buffer_atomic_add_f32 v195, v25, s[40:43], s11 offen offset:3072
    s_mov_b64 exec, -1
    ds_read_b128 a[0:3], v5 offset:0
    ds_read_b128 a[4:7], v5 offset:1024
    ds_read_b128 a[8:11], v7 offset:2048
    ds_read_b128 a[12:15], v5 offset:2560
    ds_read_b128 a[16:19], v5 offset:3584
    ds_read_b128 a[20:23], v7 offset:4608
    ds_read_b128 a[24:27], v5 offset:5120
    ds_read_b128 a[28:31], v5 offset:6144
    s_cmp_lg_u32 s77, 0
    s_cbranch_scc1 L_wf2
    s_mov_b32 s48, 0
L_chk1:
    v_cmp_ne_u32 vcc, s78, v250
    v_cmp_ne_u32 s[52:53], s78, v252
    s_nop 0
    s_or_b64 vcc, vcc, s[52:53]
    s_cbranch_vccz L_chk2
    s_sleep 8
    buffer_load_dword v250, v248, s[40:43], 0 offen sc1
    buffer_load_dwordx2 v[252:253], v249, s[40:43], 0 offen sc1
    s_add_u32 s48, s48, 1
    s_waitcnt vmcnt(0)
    s_cmp_lt_u32 s48, 0x20000
    s_cbranch_scc1 L_chk1
L_chk2:
    v_cmp_ne_u32 s[52:53], s3, v253
    s_nop 0
    s_or_b64 vcc, vcc, s[52:53]
    s_cmp_eq_u64 vcc, 0
    s_cselect_b32 s79, 1, 0
L_wf2:
    s_waitcnt lgkmcnt(6)
    v_mfma_f32_16x16x32_bf16 v[232:235], a[0:3], v[32:35], 0
    ds_read_b128 a[32:35], v7 offset:7168
    s_mul_i32 s101, s71, 12800
    s_add_u32 s100, s101, s33
    s_add_u32 s100, s100, 6703104
    s_add_u32 m0, s101, 0
    s_nop 0
    buffer_load_dwordx4 v4, s[40:43], s100 offen offset:0 lds
    v_mfma_f32_16x16x32_bf16 v[244:247], a[0:3], v[36:39], 0
    v_mfma_f32_16x16x32_bf16 v[236:239], a[4:7], v[32:35], 0
    ds_read_b128 a[36:39], v5 offset:7680
    buffer_load_dwordx4 v4, s[40:43], s100 offen offset:1024 lds
    v_mfma_f32_16x16x32_bf16 v[248:251], a[4:7], v[36:39], 0
    s_waitcnt lgkmcnt(6)
    v_mfma_f32_16x16x32_bf16 v[240:243], a[8:11], v[32:35], 0
    ds_read_b128 a[0:3], v5 offset:8704
    s_mov_b32 s52, 0x80008000
    v_mfma_f32_16x16x32_bf16 v[252:255], a[8:11], v[36:39], 0
    v_mfma_f32_16x16x32_bf16 v[232:235], a[12:15], v[40:43], v[232:235]
    ds_read_b128 a[4:7], v7 offset:9728
    buffer_load_dwordx4 v4, s[40:43], s100 offen offset:2048 lds
    v_mfma_f32_16x16x32_bf16 v[244:247], a[12:15], v[44:47], v[244:247]
    s_mov_b32 s53, 0x80008000
    s_waitcnt lgkmcnt(6)
    v_mfma_f32_16x16x32_bf16 v[236:239], a[16:19], v[40:43], v[236:239]
    ds_read_b128 a[8:11], v5 offset:10240
    buffer_load_dwordx4 v4, s[40:43], s100 offen offset:3072 lds
    v_mfma_f32_16x16x32_bf16 v[248:251], a[16:19], v[44:47], v[248:251]
    s_and_b64 s[52:53], s[52:53], s[84:85]
    v_mfma_f32_16x16x32_bf16 v[240:243], a[20:23], v[40:43], v[240:243]
    ds_read_b128 a[12:15], v5 offset:11264
    s_andn2_b64 s[54:55], s[84:85], s[52:53]
    v_mfma_f32_16x16x32_bf16 v[252:255], a[20:23], v[44:47], v[252:255]
    s_waitcnt lgkmcnt(6)
    v_mfma_f32_16x16x32_bf16 v[232:235], a[24:27], v[48:51], v[232:235]
    ds_read_b128 a[16:19], v7 offset:12288
    s_add_u32 s100, s100, 4096
    s_add_u32 m0, s101, 4096
    s_nop 0
    buffer_load_dwordx4 v4, s[40:43], s100 offen offset:0 lds
    v_mfma_f32_16x16x32_bf16 v[244:247], a[24:27], v[52:55], v[244:247]
    v_accvgpr_write_b32 a68, 0
    v_mfma_f32_16x16x32_bf16 v[236:239], a[28:31], v[48:51], v[236:239]
    ds_read_b128 a[20:23], v5 offset:12800
    buffer_load_dwordx4 v4, s[40:43], s100 offen offset:1024 lds
    v_mfma_f32_16x16x32_bf16 v[248:251], a[28:31], v[52:55], v[248:251]
    v_accvgpr_write_b32 a69, 0
    s_waitcnt lgkmcnt(6)
    s_barrier
    v_mfma_f32_16x16x32_bf16 v[240:243], a[32:35], v[48:51], v[240:243]
    ds_read_b128 a[24:27], v5 offset:13824
    v_accvgpr_write_b32 a70, 0
    v_mfma_f32_16x16x32_bf16 v[252:255], a[32:35], v[52:55], v[252:255]
    v_mfma_f32_16x16x32_bf16 v[232:235], a[36:39], v[56:59], v[232:235]
    ds_read_b128 a[28:31], v7 offset:14848
    buffer_load_dwordx4 v4, s[40:43], s100 offen offset:2048 lds
    v_mfma_f32_16x16x32_bf16 v[244:247], a[36:39], v[60:63], v[244:247]
    v_accvgpr_write_b32 a71, 0
    s_waitcnt lgkmcnt(6)
    v_mfma_f32_16x16x32_bf16 v[236:239], a[0:3], v[56:59], v[236:239]
    ds_read_b128 a[32:35], v5 offset:15360
    buffer_load_dwordx4 v4, s[40:43], s100 offen offset:3072 lds
    v_mfma_f32_16x16x32_bf16 v[248:251], a[0:3], v[60:63], v[248:251]
    v_accvgpr_write_b32 a72, 0
    v_mfma_f32_16x16x32_bf16 v[240:243], a[4:7], v[56:59], v[240:243]
    ds_read_b128 a[36:39], v5 offset:16384
    v_accvgpr_write_b32 a73, 0
    v_mfma_f32_16x16x32_bf16 v[252:255], a[4:7], v[60:63], v[252:255]
    s_waitcnt lgkmcnt(6)
    v_mfma_f32_16x16x32_bf16 v[232:235], a[8:11], v[64:67], v[232:235]
    ds_read_b128 a[0:3], v7 offset:17408
    s_add_u32 s100, s100, 4096
    s_add_u32 m0, s101, 8192
    s_nop 0
    buffer_load_dwordx4 v4, s[40:43], s100 offen offset:0 lds
    v_mfma_f32_16x16x32_bf16 v[244:247], a[8:11], v[68:71], v[244:247]
    v_accvgpr_write_b32 a74, 0
    v_mfma_f32_16x16x32_bf16 v[236:239], a[12:15], v[64:67], v[236:239]
    ds_read_b128 a[4:7], v5 offset:17920
    buffer_load_dwordx4 v4, s[40:43], s100 offen offset:1024 lds
    v_mfma_f32_16x16x32_bf16 v[248:251], a[12:15], v[68:71], v[248:251]
    v_accvgpr_write_b32 a75, 0
    s_waitcnt lgkmcnt(6)
    v_mfma_f32_16x16x32_bf16 v[240:243], a[16:19], v[64:67], v[240:243]
    ds_read_b128 a[8:11], v5 offset:18944
    v_accvgpr_write_b32 a76, 0
    v_mfma_f32_16x16x32_bf16 v[252:255], a[16:19], v[68:71], v[252:255]
    v_mfma_f32_16x16x32_bf16 v[232:235], a[20:23], v[72:75], v[232:235]
    ds_read_b128 a[12:15], v7 offset:19968
    buffer_load_dwordx4 v4, s[40:43], s100 offen offset:2048 lds
    v_mfma_f32_16x16x32_bf16 v[244:247], a[20:23], v[76:79], v[244:247]
    v_accvgpr_write_b32 a77, 0
    s_waitcnt lgkmcnt(6)
    v_mfma_f32_16x16x32_bf16 v[236:239], a[24:27], v[72:75], v[236:239]
    ds_read_b128 a[16:19], v5 offset:20480
    buffer_load_dwordx4 v4, s[40:43], s100 offen offset:3072 lds
    v_mfma_f32_16x16x32_bf16 v[248:251], a[24:27], v[76:79], v[248:251]
    v_accvgpr_write_b32 a78, 0
    v_mfma_f32_16x16x32_bf16 v[240:243], a[28:31], v[72:75], v[240:243]
    ds_read_b128 a[20:23], v5 offset:21504
    v_accvgpr_write_b32 a79, 0
    v_mfma_f32_16x16x32_bf16 v[252:255], a[28:31], v[76:79], v[252:255]
    s_waitcnt lgkmcnt(6)
    v_mfma_f32_16x16x32_bf16 v[232:235], a[32:35], v[80:83], v[232:235]
    ds_read_b128 a[24:27], v7 offset:22528
    s_add_u32 s100, s100, 4096
    s_add_u32 m0, s101, 12288
    s_mov_b32 exec_hi, 0
    buffer_load_dwordx4 v4, s[40:43], s100 offen offset:0 lds
    s_mov_b32 exec_hi, -1
    v_mfma_f32_16x16x32_bf16 v[244:247], a[32:35], v[84:87], v[244:247]
    v_accvgpr_write_b32 a80, 0
    v_mfma_f32_16x16x32_bf16 v[236:239], a[36:39], v[80:83], v[236:239]
    ds_read_b128 a[28:31], v5 offset:23040
    v_accvgpr_write_b32 a81, 0
    v_mfma_f32_16x16x32_bf16 v[248:251], a[36:39], v[84:87], v[248:251]
    s_waitcnt lgkmcnt(6)
    v_mfma_f32_16x16x32_bf16 v[240:243], a[0:3], v[80:83], v[240:243]
    ds_read_b128 a[32:35], v5 offset:24064
    s_mul_i32 s101, s71, 12800
    s_add_u32 s100, s101, s33
    s_add_u32 s100, s100, 6651904
    s_add_u32 m0, s101, 102400
    s_nop 0
    buffer_load_dwordx4 v4, s[40:43], s100 offen offset:0 lds
    v_mfma_f32_16x16x32_bf16 v[252:255], a[0:3], v[84:87], v[252:255]
    v_mfma_f32_16x16x32_bf16 v[232:235], a[4:7], v[88:91], v[232:235]
    ds_read_b128 a[36:39], v7 offset:25088
    buffer_load_dwordx4 v4, s[40:43], s100 offen offset:1024 lds
    v_mfma_f32_16x16x32_bf16 v[244:247], a[4:7], v[92:95], v[244:247]
    v_accvgpr_write_b32 a82, 0
    s_waitcnt lgkmcnt(6)
    v_mfma_f32_16x16x32_bf16 v[236:239], a[8:11], v[88:91], v[236:239]
    ds_read_b128 a[0:3], v5 offset:25600
    v_accvgpr_write_b32 a83, 0
    v_mfma_f32_16x16x32_bf16 v[248:251], a[8:11], v[92:95], v[248:251]
    v_mfma_f32_16x16x32_bf16 v[240:243], a[12:15], v[88:91], v[240:243]
    ds_read_b128 a[4:7], v5 offset:26624
    buffer_load_dwordx4 v4, s[40:43], s100 offen offset:2048 lds
    v_mfma_f32_16x16x32_bf16 v[252:255], a[12:15], v[92:95], v[252:255]
    v_accvgpr_write_b32 a84, 0
    s_waitcnt lgkmcnt(6)
    v_mfma_f32_16x16x32_bf16 v[232:235], a[16:19], v[96:99], v[232:235]
    ds_read_b128 a[8:11], v7 offset:27648
    buffer_load_dwordx4 v4, s[40:43], s100 offen offset:3072 lds
    v_mfma_f32_16x16x32_bf16 v[244:247], a[16:19], v[100:103], v[244:247]
    v_accvgpr_write_b32 a85, 0
    v_mfma_f32_16x16x32_bf16 v[236:239], a[20:23], v[96:99], v[236:239]
    ds_read_b128 a[12:15], v5 offset:28160
    v_accvgpr_write_b32 a86, 0
    v_mfma_f32_16x16x32_bf16 v[248:251], a[20:23], v[100:103], v[248:251]
    s_waitcnt lgkmcnt(6)
    v_mfma_f32_16x16x32_bf16 v[240:243], a[24:27], v[96:99], v[240:243]
    ds_read_b128 a[16:19], v5 offset:29184
    s_add_u32 s100, s100, 4096
    s_add_u32 m0, s101, 106496
    s_nop 0
    buffer_load_dwordx4 v4, s[40:43], s100 offen offset:0 lds
    v_mfma_f32_16x16x32_bf16 v[252:255], a[24:27], v[100:103], v[252:255]
    v_accvgpr_write_b32 a87, 0
    v_mfma_f32_16x16x32_bf16 v[232:235], a[28:31], v[104:107], v[232:235]
    ds_read_b128 a[20:23], v7 offset:30208
    buffer_load_dwordx4 v4, s[40:43], s100 offen offset:1024 lds
    v_mfma_f32_16x16x32_bf16 v[244:247], a[28:31], v[108:111], v[244:247]
    v_accvgpr_write_b32 a88, 0
    s_waitcnt lgkmcnt(6)
    v_mfma_f32_16x16x32_bf16 v[236:239], a[32:35], v[104:107], v[236:239]
    ds_read_b128 a[24:27], v5 offset:30720
    v_accvgpr_write_b32 a89, 0
    v_mfma_f32_16x16x32_bf16 v[248:251], a[32:35], v[108:111], v[248:251]
    v_mfma_f32_16x16x32_bf16 v[240:243], a[36:39], v[104:107], v[240:243]
    ds_read_b128 a[28:31], v5 offset:31744
    buffer_load_dwordx4 v4, s[40:43], s100 offen offset:2048 lds
    v_mfma_f32_16x16x32_bf16 v[252:255], a[36:39], v[108:111], v[252:255]
    v_accvgpr_write_b32 a90, 0
    s_waitcnt lgkmcnt(6)
    v_mfma_f32_16x16x32_bf16 v[232:235], a[0:3], v[112:115], v[232:235]
    ds_read_b128 a[32:35], v7 offset:32768
    buffer_load_dwordx4 v4, s[40:43], s100 offen offset:3072 lds
    v_mfma_f32_16x16x32_bf16 v[244:247], a[0:3], v[116:119], v[244:247]
    v_accvgpr_write_b32 a91, 0
    v_mfma_f32_16x16x32_bf16 v[236:239], a[4:7], v[112:115], v[236:239]
    ds_read_b128 a[36:39], v5 offset:33280
    v_lshlrev_b32 v14, 2, v0
    v_mfma_f32_16x16x32_bf16 v[248:251], a[4:7], v[116:119], v[248:251]
    s_waitcnt lgkmcnt(6)
    v_mfma_f32_16x16x32_bf16 v[240:243], a[8:11], v[112:115], v[240:243]
    ds_read_b128 a[0:3], v5 offset:34304
    s_add_u32 s100, s100, 4096
    s_add_u32 m0, s101, 110592
    s_nop 0
    buffer_load_dwordx4 v4, s[40:43], s100 offen offset:0 lds
    v_mfma_f32_16x16x32_bf16 v[252:255], a[8:11], v[116:119], v[252:255]
    s_mov_b32 s95, s11
    v_mfma_f32_16x16x32_bf16 v[232:235], a[12:15], v[120:123], v[232:235]
    ds_read_b128 a[4:7], v7 offset:35328
    buffer_load_dwordx4 v4, s[40:43], s100 offen offset:1024 lds
    v_mfma_f32_16x16x32_bf16 v[244:247], a[12:15], v[124:127], v[244:247]
    v_lshlrev_b32 v16, 3, v3
    s_waitcnt lgkmcnt(6)
    v_mfma_f32_16x16x32_bf16 v[236:239], a[16:19], v[120:123], v[236:239]
    ds_read_b128 a[8:11], v5 offset:35840
    v_add_u32 v16, 157696, v16
    v_mfma_f32_16x16x32_bf16 v[248:251], a[16:19], v[124:127], v[248:251]
    v_mfma_f32_16x16x32_bf16 v[240:243], a[20:23], v[120:123], v[240:243]
    ds_read_b128 a[12:15], v5 offset:36864
    buffer_load_dwordx4 v4, s[40:43], s100 offen offset:2048 lds
    v_mfma_f32_16x16x32_bf16 v[252:255], a[20:23], v[124:127], v[252:255]
    v_mad_u32_u24 v15, v2, 40, v16
    s_waitcnt lgkmcnt(6)
    v_mfma_f32_16x16x32_bf16 v[232:235], a[24:27], v[128:131], v[232:235]
    ds_read_b128 a[16:19], v7 offset:37888
    buffer_load_dwordx4 v4, s[40:43], s100 offen offset:3072 lds
    v_mfma_f32_16x16x32_bf16 v[244:247], a[24:27], v[132:135], v[244:247]
    v_accvgpr_read_b32 v17, a244
    v_mfma_f32_16x16x32_bf16 v[236:239], a[28:31], v[128:131], v[236:239]
    ds_read_b128 a[20:23], v5 offset:38400
    v_accvgpr_read_b32 v18, a200
    v_mfma_f32_16x16x32_bf16 v[248:251], a[28:31], v[132:135], v[248:251]
    s_waitcnt lgkmcnt(6)
    v_mfma_f32_16x16x32_bf16 v[240:243], a[32:35], v[128:131], v[240:243]
    ds_read_b128 a[24:27], v5 offset:39424
    s_add_u32 s100, s100, 4096
    s_add_u32 m0, s101, 114688
    s_mov_b32 exec_hi, 0
    buffer_load_dwordx4 v4, s[40:43], s100 offen offset:0 lds
    s_mov_b32 exec_hi, -1
    v_mfma_f32_16x16x32_bf16 v[252:255], a[32:35], v[132:135], v[252:255]
    v_add_u32 v19, 20480, v18
    v_mfma_f32_16x16x32_bf16 v[232:235], a[36:39], v[136:139], v[232:235]
    ds_read_b128 a[28:31], v7 offset:40448
    v_mfma_f32_16x16x32_bf16 v[244:247], a[36:39], v[140:143], v[244:247]
    s_waitcnt lgkmcnt(6)
    v_mfma_f32_16x16x32_bf16 v[236:239], a[0:3], v[136:139], v[236:239]
    ds_read_b128 a[32:35], v5 offset:40960
    v_mfma_f32_16x16x32_bf16 v[248:251], a[0:3], v[140:143], v[248:251]
    v_mfma_f32_16x16x32_bf16 v[240:243], a[4:7], v[136:139], v[240:243]
    ds_read_b128 a[36:39], v5 offset:41984
    v_mfma_f32_16x16x32_bf16 v[252:255], a[4:7], v[140:143], v[252:255]
    s_waitcnt lgkmcnt(6)
    v_mfma_f32_16x16x32_bf16 v[232:235], a[8:11], v[144:147], v[232:235]
    ds_read_b128 a[0:3], v7 offset:43008
    v_mfma_f32_16x16x32_bf16 v[244:247], a[8:11], v[148:151], v[244:247]
    v_mfma_f32_16x16x32_bf16 v[236:239], a[12:15], v[144:147], v[236:239]
    ds_read_b128 a[4:7], v5 offset:43520
    v_mfma_f32_16x16x32_bf16 v[248:251], a[12:15], v[148:151], v[248:251]
    s_waitcnt lgkmcnt(6)
    v_mfma_f32_16x16x32_bf16 v[240:243], a[16:19], v[144:147], v[240:243]
    ds_read_b128 a[8:11], v5 offset:44544
    v_mfma_f32_16x16x32_bf16 v[252:255], a[16:19], v[148:151], v[252:255]
    v_mfma_f32_16x16x32_bf16 v[232:235], a[20:23], v[152:155], v[232:235]
    ds_read_b128 a[12:15], v7 offset:45568
    v_mfma_f32_16x16x32_bf16 v[244:247], a[20:23], v[156:159], v[244:247]
    s_waitcnt lgkmcnt(6)
    v_mfma_f32_16x16x32_bf16 v[236:239], a[24:27], v[152:155], v[236:239]
    ds_read_b128 a[16:19], v5 offset:46080
    v_mfma_f32_16x16x32_bf16 v[248:251], a[24:27], v[156:159], v[248:251]
    v_mfma_f32_16x16x32_bf16 v[240:243], a[28:31], v[152:155], v[240:243]
    ds_read_b128 a[20:23], v5 offset:47104
    v_mfma_f32_16x16x32_bf16 v[252:255], a[28:31], v[156:159], v[252:255]
    s_waitcnt lgkmcnt(6)
    v_mfma_f32_16x16x32_bf16 v[232:235], a[32:35], v[160:163], v[232:235]
    ds_read_b128 a[24:27], v7 offset:48128
    v_mfma_f32_16x16x32_bf16 v[244:247], a[32:35], v[164:167], v[244:247]
    v_mfma_f32_16x16x32_bf16 v[236:239], a[36:39], v[160:163], v[236:239]
    ds_read_b128 a[28:31], v5 offset:48640
    v_mfma_f32_16x16x32_bf16 v[248:251], a[36:39], v[164:167], v[248:251]
    s_waitcnt lgkmcnt(6)
    v_mfma_f32_16x16x32_bf16 v[240:243], a[0:3], v[160:163], v[240:243]
    ds_read_b128 a[32:35], v5 offset:49664
    v_mfma_f32_16x16x32_bf16 v[252:255], a[0:3], v[164:167], v[252:255]
    v_mfma_f32_16x16x32_bf16 v[232:235], a[4:7], v[168:171], v[232:235]
    ds_read_b128 a[36:39], v7 offset:50688
    v_mfma_f32_16x16x32_bf16 v[244:247], a[4:7], v[172:175], v[244:247]
    s_waitcnt lgkmcnt(6)
    v_mfma_f32_16x16x32_bf16 v[236:239], a[8:11], v[168:171], v[236:239]
    v_mfma_f32_16x16x32_bf16 v[248:251], a[8:11], v[172:175], v[248:251]
    v_mfma_f32_16x16x32_bf16 v[240:243], a[12:15], v[168:171], v[240:243]
    v_mfma_f32_16x16x32_bf16 v[252:255], a[12:15], v[172:175], v[252:255]
    s_waitcnt lgkmcnt(4)
    v_mfma_f32_16x16x32_bf16 v[232:235], a[16:19], v[176:179], v[232:235]
    v_mfma_f32_16x16x32_bf16 v[244:247], a[16:19], v[180:183], v[244:247]
    v_mfma_f32_16x16x32_bf16 v[236:239], a[20:23], v[176:179], v[236:239]
    v_mfma_f32_16x16x32_bf16 v[248:251], a[20:23], v[180:183], v[248:251]
    s_waitcnt lgkmcnt(2)
    v_mfma_f32_16x16x32_bf16 v[240:243], a[24:27], v[176:179], v[240:243]
    v_mfma_f32_16x16x32_bf16 v[252:255], a[24:27], v[180:183], v[252:255]
    v_mfma_f32_16x16x32_bf16 v[232:235], a[28:31], v[184:187], v[232:235]
    v_mfma_f32_16x16x32_bf16 v[244:247], a[28:31], v[188:191], v[244:247]
    s_waitcnt lgkmcnt(0)
    v_mfma_f32_16x16x32_bf16 v[236:239], a[32:35], v[184:187], v[236:239]
    s_mov_b64 exec, s[84:85]
    buffer_load_dword v208, v14, s[40:43], s11 offen offset:0 sc1
    buffer_load_dword v209, v14, s[40:43], s11 offen offset:1024 sc1
    buffer_load_dword v210, v14, s[40:43], s11 offen offset:2048 sc1
    buffer_load_dword v211, v14, s[40:43], s11 offen offset:3072 sc1
    s_mov_b64 exec, -1
    v_mfma_f32_16x16x32_bf16 v[248:251], a[32:35], v[188:191], v[248:251]
    v_mfma_f32_16x16x32_bf16 v[240:243], a[36:39], v[184:187], v[240:243]
    v_mfma_f32_16x16x32_bf16 v[252:255], a[36:39], v[188:191], v[252:255]
    v_mfma_f32_16x16x32_bf16 v[232:235], a[58:61], a[40:43], v[232:235]
    v_mfma_f32_16x16x32_bf16 v[236:239], a[60:63], a[40:43], v[236:239]
    v_mfma_f32_16x16x32_bf16 v[240:243], a[62:65], a[40:43], v[240:243]
    v_mfma_f32_16x16x32_bf16 v[244:247], a[58:61], a[44:47], v[244:247]
    v_mfma_f32_16x16x32_bf16 v[248:251], a[60:63], a[44:47], v[248:251]
    v_mfma_f32_16x16x32_bf16 v[252:255], a[62:65], a[44:47], v[252:255]
    s_nop 2
    v_pk_fma_f32 v[24:25], v[232:233], v[12:13], 1.0 op_sel_hi:[1,0,0]
    v_pk_fma_f32 v[26:27], v[234:235], v[12:13], 1.0 op_sel_hi:[1,0,0]
    v_pk_fma_f32 v[28:29], v[24:25], s[86:87], s[86:87] neg_lo:[0,0,1] neg_hi:[0,0,1]
    v_pk_fma_f32 v[30:31], v[26:27], s[86:87], s[86:87] neg_lo:[0,0,1] neg_hi:[0,0,1]
    v_exp_f32 v28, v28
    v_exp_f32 v29, v29
    v_exp_f32 v30, v30
    v_exp_f32 v31, v31
    v_med3_f32 v24, v24, v28, 1.0
    v_med3_f32 v25, v25, v29, 1.0
    v_med3_f32 v26, v26, v30, 1.0
    v_med3_f32 v27, v27, v31, 1.0
    v_pk_add_f32 v[232:233], v[24:25], s[88:89]
    v_pk_add_f32 v[234:235], v[26:27], s[88:89]
    v_pk_fma_f32 v[24:25], v[236:237], v[12:13], 1.0 op_sel_hi:[1,0,0]
    v_pk_fma_f32 v[26:27], v[238:239], v[12:13], 1.0 op_sel_hi:[1,0,0]
    v_pk_fma_f32 v[28:29], v[24:25], s[86:87], s[86:87] neg_lo:[0,0,1] neg_hi:[0,0,1]
    v_pk_fma_f32 v[30:31], v[26:27], s[86:87], s[86:87] neg_lo:[0,0,1] neg_hi:[0,0,1]
    v_exp_f32 v28, v28
    v_exp_f32 v29, v29
    v_exp_f32 v30, v30
    v_exp_f32 v31, v31
    v_med3_f32 v24, v24, v28, 1.0
    v_med3_f32 v25, v25, v29, 1.0
    v_med3_f32 v26, v26, v30, 1.0
    v_med3_f32 v27, v27, v31, 1.0
    v_pk_add_f32 v[236:237], v[24:25], s[88:89]
    v_pk_add_f32 v[238:239], v[26:27], s[88:89]
    v_pk_fma_f32 v[24:25], v[240:241], v[12:13], 1.0 op_sel_hi:[1,0,0]
    v_pk_fma_f32 v[26:27], v[242:243], v[12:13], 1.0 op_sel_hi:[1,0,0]
    v_pk_fma_f32 v[28:29], v[24:25], s[86:87], s[86:87] neg_lo:[0,0,1] neg_hi:[0,0,1]
    v_pk_fma_f32 v[30:31], v[26:27], s[86:87], s[86:87] neg_lo:[0,0,1] neg_hi:[0,0,1]
    v_exp_f32 v28, v28
    v_exp_f32 v29, v29
    v_exp_f32 v30, v30
    v_exp_f32 v31, v31
    v_med3_f32 v24, v24, v28, 1.0
    v_med3_f32 v25, v25, v29, 1.0
    v_med3_f32 v26, v26, v30, 1.0
    v_med3_f32 v27, v27, v31, 1.0
    v_pk_add_f32 v[240:241], v[24:25], s[88:89]
    v_pk_add_f32 v[242:243], v[26:27], s[88:89]
    v_cvt_pk_bf16_f32 v232, v232, v233
    v_cvt_pk_bf16_f32 v233, v234, v235
    v_cvt_pk_bf16_f32 v234, v236, v237
    v_cvt_pk_bf16_f32 v235, v238, v239
    v_cvt_pk_bf16_f32 v236, v240, v241
    v_cvt_pk_bf16_f32 v237, v242, v243
    v_pk_fma_f32 v[24:25], v[244:245], v[12:13], 1.0 op_sel:[0,1,0] op_sel_hi:[1,1,0]
    v_pk_fma_f32 v[26:27], v[246:247], v[12:13], 1.0 op_sel:[0,1,0] op_sel_hi:[1,1,0]
    v_pk_fma_f32 v[28:29], v[24:25], s[86:87], s[86:87] neg_lo:[0,0,1] neg_hi:[0,0,1]
    v_pk_fma_f32 v[30:31], v[26:27], s[86:87], s[86:87] neg_lo:[0,0,1] neg_hi:[0,0,1]
    v_exp_f32 v28, v28
    v_exp_f32 v29, v29
    v_exp_f32 v30, v30
    v_exp_f32 v31, v31
    v_med3_f32 v24, v24, v28, 1.0
    v_med3_f32 v25, v25, v29, 1.0
    v_med3_f32 v26, v26, v30, 1.0
    v_med3_f32 v27, v27, v31, 1.0
    v_pk_add_f32 v[244:245], v[24:25], s[88:89]
    v_pk_add_f32 v[246:247], v[26:27], s[88:89]
    v_pk_fma_f32 v[24:25], v[248:249], v[12:13], 1.0 op_sel:[0,1,0] op_sel_hi:[1,1,0]
    v_pk_fma_f32 v[26:27], v[250:251], v[12:13], 1.0 op_sel:[0,1,0] op_sel_hi:[1,1,0]
    v_pk_fma_f32 v[28:29], v[24:25], s[86:87], s[86:87] neg_lo:[0,0,1] neg_hi:[0,0,1]
    v_pk_fma_f32 v[30:31], v[26:27], s[86:87], s[86:87] neg_lo:[0,0,1] neg_hi:[0,0,1]
    v_exp_f32 v28, v28
    v_exp_f32 v29, v29
    v_exp_f32 v30, v30
    v_exp_f32 v31, v31
    v_med3_f32 v24, v24, v28, 1.0
    v_med3_f32 v25, v25, v29, 1.0
    v_med3_f32 v26, v26, v30, 1.0
    v_med3_f32 v27, v27, v31, 1.0
    v_pk_add_f32 v[248:249], v[24:25], s[88:89]
    v_pk_add_f32 v[250:251], v[26:27], s[88:89]
    v_pk_fma_f32 v[24:25], v[252:253], v[12:13], 1.0 op_sel:[0,1,0] op_sel_hi:[1,1,0]
    v_pk_fma_f32 v[26:27], v[254:255], v[12:13], 1.0 op_sel:[0,1,0] op_sel_hi:[1,1,0]
    v_pk_fma_f32 v[28:29], v[24:25], s[86:87], s[86:87] neg_lo:[0,0,1] neg_hi:[0,0,1]
    v_pk_fma_f32 v[30:31], v[26:27], s[86:87], s[86:87] neg_lo:[0,0,1] neg_hi:[0,0,1]
    v_exp_f32 v28, v28
    v_exp_f32 v29, v29
    v_exp_f32 v30, v30
    v_exp_f32 v31, v31
    v_med3_f32 v24, v24, v28, 1.0
    v_med3_f32 v25, v25, v29, 1.0
    v_med3_f32 v26, v26, v30, 1.0
    v_med3_f32 v27, v27, v31, 1.0
    v_pk_add_f32 v[252:253], v[24:25], s[88:89]
    v_pk_add_f32 v[254:255], v[26:27], s[88:89]
    v_cvt_pk_bf16_f32 v244, v244, v245
    v_cvt_pk_bf16_f32 v245, v246, v247
    v_cvt_pk_bf16_f32 v246, v248, v249
    v_cvt_pk_bf16_f32 v247, v250, v251
    v_cvt_pk_bf16_f32 v248, v252, v253
    v_cvt_pk_bf16_f32 v249, v254, v255
    s_mov_b32 s48, 0
L_g1:
    s_waitcnt vmcnt(0)
    v_min_f32 v24, v208, v209
    v_min3_f32 v24, v24, v210, v211
    v_cmp_neq_f32 vcc, 0x41800000, v24
    s_nop 0
    s_and_b64 vcc, vcc, s[52:53]
    s_cbranch_scc0 L_g1d
    s_sleep 4
    s_mov_b64 exec, s[84:85]
    buffer_load_dword v208, v14, s[40:43], s11 offen offset:0 sc1
    buffer_load_dword v209, v14, s[40:43], s11 offen offset:1024 sc1
    buffer_load_dword v210, v14, s[40:43], s11 offen offset:2048 sc1
    buffer_load_dword v211, v14, s[40:43], s11 offen offset:3072 sc1
    s_mov_b64 exec, -1
    s_add_u32 s48, s48, 1
    s_cmp_lt_u32 s48, 0x20000
    s_cbranch_scc1 L_g1
L_g1d:
    s_add_u32 s11, s11, 4096
    v_cvt_pk_bf16_f32 v208, v208, v209
    v_cvt_pk_bf16_f32 v209, v210, v211
    s_mov_b64 exec, s[54:55]
    ds_write_b64 v17, v[208:209]
    s_mov_b64 exec, -1
    s_waitcnt lgkmcnt(0)
    s_barrier
    s_lshr_b32 s50, s76, 2
    s_mul_i32 s50, s50, 40960
    s_mov_b32 exec_lo, 0x11111111
    s_mov_b32 exec_hi, 0x11111111
    ds_read_b64 a[84:85], v16 offset:800
    s_mov_b64 exec, 0x1111
    ds_read_b64 a[86:87], v16 offset:832
    s_mov_b32 exec_lo, 0x22220000
    s_mov_b32 exec_hi, 0x22222222
    ds_read_b64 a[88:89], v16 offset:1632
    s_mov_b64 exec, 0x22222222
    ds_read_b64 a[90:91], v16 offset:1664
    s_mov_b64 exec, -1
    ds_read_b64 a[68:69], v15 offset:0
    s_mov_b64 exec, 0xffff
    ds_read_b64 a[70:71], v15 offset:32
    s_mov_b32 exec_lo, 0xffff0000
    s_mov_b32 exec_hi, 0xffffffff
    ds_read_b64 a[72:73], v15 offset:832
    s_mov_b32 exec_lo, 0xffffffff
    s_mov_b32 exec_hi, 0x0
    ds_read_b64 a[74:75], v15 offset:864
    s_mov_b32 exec_lo, 0xf000f
    s_mov_b32 exec_hi, 0xf000f
    ds_read_b64 a[76:77], v15 offset:640
    s_mov_b64 exec, 0xf
    ds_read_b64 a[78:79], v15 offset:672
    s_mov_b32 exec_lo, 0xf00000
    s_mov_b32 exec_hi, 0xf000f0
    ds_read_b64 a[80:81], v15 offset:1312
    s_mov_b64 exec, 0xf000f0
    ds_read_b64 a[82:83], v15 offset:1344
    s_mov_b64 exec, -1
    s_mov_b32 exec_lo, 0x0
    s_mov_b32 exec_hi, 0xffffffff
    v_mov_b32 v236, 0
    v_mov_b32 v237, 0
    v_mov_b32 v248, 0
    v_mov_b32 v249, 0
    s_mov_b64 exec, -1
    s_waitcnt lgkmcnt(8)
    v_mfma_f32_16x16x32_bf16 v[124:127], a[84:87], v[232:235], 0
    v_mfma_f32_16x16x32_bf16 v[140:143], a[84:87], v[244:247], 0
    v_mfma_f32_16x16x32_bf16 v[124:127], a[88:91], v[234:237], v[124:127]
    v_mfma_f32_16x16x32_bf16 v[140:143], a[88:91], v[246:249], v[140:143]
    s_waitcnt lgkmcnt(4)
    v_mfma_f32_16x16x32_bf16 v[112:115], a[68:71], v[232:235], 0
    v_mfma_f32_16x16x32_bf16 v[116:119], a[72:75], v[234:237], 0
    v_mfma_f32_16x16x32_bf16 v[128:131], a[68:71], v[244:247], 0
    v_mfma_f32_16x16x32_bf16 v[132:135], a[72:75], v[246:249], 0
    s_waitcnt lgkmcnt(0)
    v_mfma_f32_16x16x32_bf16 v[120:123], a[76:79], v[232:235], 0
    v_mfma_f32_16x16x32_bf16 v[136:139], a[76:79], v[244:247], 0
    v_mfma_f32_16x16x32_bf16 v[120:123], a[80:83], v[234:237], v[120:123]
    v_mfma_f32_16x16x32_bf16 v[136:139], a[80:83], v[246:249], v[136:139]
    v_pk_add_f32 v[124:125], v[124:125], s[88:89]
    v_pk_add_f32 v[140:141], v[140:141], s[88:89]
    v_rcp_f32 v124, v124
    v_rcp_f32 v125, v125
    v_rcp_f32 v140, v140
    v_rcp_f32 v141, v141
    v_cndmask_b32 v126, v125, v124, s[82:83]
    v_pk_mul_f32 v[112:113], v[112:113], v[124:125] op_sel_hi:[1,0]
    v_pk_mul_f32 v[114:115], v[114:115], v[124:125] op_sel_hi:[1,0]
    v_pk_mul_f32 v[116:117], v[116:117], v[124:125] op_sel:[0,1] op_sel_hi:[1,1]
    v_pk_mul_f32 v[118:119], v[118:119], v[124:125] op_sel:[0,1] op_sel_hi:[1,1]
    v_cvt_pk_bf16_f32 v112, v112, v113
    v_cvt_pk_bf16_f32 v113, v114, v115
    v_cvt_pk_bf16_f32 v114, v116, v117
    v_cvt_pk_bf16_f32 v115, v118, v119
    v_cndmask_b32 v142, v141, v140, s[82:83]
    v_pk_mul_f32 v[128:129], v[128:129], v[140:141] op_sel_hi:[1,0]
    v_pk_mul_f32 v[130:131], v[130:131], v[140:141] op_sel_hi:[1,0]
    v_pk_mul_f32 v[132:133], v[132:133], v[140:141] op_sel:[0,1] op_sel_hi:[1,1]
    v_pk_mul_f32 v[134:135], v[134:135], v[140:141] op_sel:[0,1] op_sel_hi:[1,1]
    v_cvt_pk_bf16_f32 v128, v128, v129
    v_cvt_pk_bf16_f32 v129, v130, v131
    v_cvt_pk_bf16_f32 v130, v132, v133
    v_cvt_pk_bf16_f32 v131, v134, v135
    v_pk_mul_f32 v[120:121], v[120:121], v[126:127] op_sel_hi:[1,0]
    v_pk_mul_f32 v[122:123], v[122:123], v[126:127] op_sel_hi:[1,0]
    v_cvt_pk_bf16_f32 v120, v120, v121
    v_cvt_pk_bf16_f32 v121, v122, v123
    v_pk_mul_f32 v[136:137], v[136:137], v[142:143] op_sel_hi:[1,0]
    v_pk_mul_f32 v[138:139], v[138:139], v[142:143] op_sel_hi:[1,0]
    v_cvt_pk_bf16_f32 v136, v136, v137
    v_cvt_pk_bf16_f32 v137, v138, v139
    s_cmp_eq_u32 s79, 0
    s_cbranch_scc1 Lsg_13
    buffer_store_dwordx4 v[112:115], v4, s[40:43], s14 offen
    buffer_store_dwordx4 v[128:131], v9, s[40:43], s14 offen
    s_mov_b32 exec_hi, 0
    buffer_store_dwordx2 v[120:121], v18, s[40:43], s15 offen
    buffer_store_dwordx2 v[136:137], v19, s[40:43], s15 offen
    s_mov_b32 exec_hi, -1
    s_branch Lse_14
Lsg_13:
    buffer_store_dwordx4 v[112:115], v4, s[40:43], s14 offen sc1
    buffer_store_dwordx4 v[128:131], v9, s[40:43], s14 offen sc1
    s_mov_b32 exec_hi, 0
    buffer_store_dwordx2 v[120:121], v18, s[40:43], s15 offen sc1
    buffer_store_dwordx2 v[136:137], v19, s[40:43], s15 offen sc1
    s_mov_b32 exec_hi, -1
Lse_14:
    s_waitcnt vmcnt(0)
    s_barrier
    s_cmp_lg_u32 s71, 0
    s_cbranch_scc1 Lfl_15
    v_mov_b32 v22, s78
    s_mov_b64 exec, 1
    s_cmp_eq_u32 s79, 0
    s_cbranch_scc1 Lsg_16
    buffer_store_dword v22, off, s[40:43], s16
    s_branch Lse_17
Lsg_16:
    buffer_store_dword v22, off, s[40:43], s16 sc1
Lse_17:
    s_mov_b64 exec, -1
Lfl_15:
    s_mul_i32 s101, s71, 10240
    s_add_u32 s100, s101, s50
    s_add_u32 s100, s100, 9109504
    s_add_u32 m0, s101, 51200
    s_nop 0
    buffer_load_dwordx4 v4, s[40:43], s100 offen offset:0 lds
    buffer_load_dwordx4 v4, s[40:43], s100 offen offset:1024 lds
    buffer_load_dwordx4 v4, s[40:43], s100 offen offset:2048 lds
    buffer_load_dwordx4 v4, s[40:43], s100 offen offset:3072 lds
    s_add_u32 s100, s100, 4096
    s_add_u32 m0, s101, 55296
    s_nop 0
    buffer_load_dwordx4 v4, s[40:43], s100 offen offset:0 lds
    buffer_load_dwordx4 v4, s[40:43], s100 offen offset:1024 lds
    buffer_load_dwordx4 v4, s[40:43], s100 offen offset:2048 lds
    buffer_load_dwordx4 v4, s[40:43], s100 offen offset:3072 lds
    s_add_u32 s100, s100, 4096
    s_add_u32 m0, s101, 59392
    s_nop 0
    buffer_load_dwordx4 v4, s[40:43], s100 offen offset:0 lds
    buffer_load_dwordx4 v4, s[40:43], s100 offen offset:1024 lds
    s_mul_i32 s101, s71, 2560
    s_add_u32 s100, s101, s33
    s_add_u32 s100, s100, 7471104
    s_add_u32 m0, s101, 92160
    s_nop 0
    buffer_load_dwordx4 v4, s[40:43], s100 offen offset:0 lds
    buffer_load_dwordx4 v4, s[40:43], s100 offen offset:1024 lds
    s_mov_b32 exec_hi, 0
    buffer_load_dwordx4 v4, s[40:43], s100 offen offset:2048 lds
    s_mov_b32 exec_hi, -1
    s_mov_b32 s95, s18
    s_cmp_lg_u32 s71, 0
    s_cbranch_scc1 Lpd_19
    s_mov_b32 s48, 0
Lpoll_18:
    buffer_load_dword v22, v8, s[40:43], s17 offen sc1
    s_add_u32 s48, s48, 1
    s_waitcnt vmcnt(0)
    v_cmp_ne_u32 vcc, s78, v22
    s_cbranch_vccz Lpd_19
    s_cmp_lt_u32 s48, 0x20000
    s_cbranch_scc1 Lpoll_18
Lpd_19:
    s_waitcnt vmcnt(0)
    s_barrier
    buffer_load_dwordx4 v[32:35], v4, s[40:43], s95 offen offset:0 sc1
    buffer_load_dwordx4 v[36:39], v4, s[40:43], s95 offen offset:1024 sc1
    buffer_load_dwordx4 v[40:43], v4, s[40:43], s95 offen offset:2048 sc1
    buffer_load_dwordx4 v[44:47], v4, s[40:43], s95 offen offset:3072 sc1
    s_add_u32 s95, s95, 4096
    buffer_load_dwordx4 v[48:51], v4, s[40:43], s95 offen offset:0 sc1
    buffer_load_dwordx4 v[52:55], v4, s[40:43], s95 offen offset:1024 sc1
    buffer_load_dwordx4 v[56:59], v4, s[40:43], s95 offen offset:2048 sc1
    buffer_load_dwordx4 v[60:63], v4, s[40:43], s95 offen offset:3072 sc1
    s_add_u32 s95, s95, 4096
    ds_read_b128 a[0:3], v6 offset:0
    ds_read_b128 a[4:7], v6 offset:1024
    ds_read_b128 a[8:11], v6 offset:2048
    ds_read_b128 a[12:15], v6 offset:3072
    ds_read_b128 a[16:19], v6 offset:4096
    ds_read_b128 a[20:23], v6 offset:5120
    ds_read_b128 a[24:27], v6 offset:6144
    ds_read_b128 a[28:31], v6 offset:7168
    s_waitcnt lgkmcnt(6)
    s_waitcnt vmcnt(7)
    v_mfma_f32_16x16x32_bf16 v[112:115], a[0:3], v[32:35], 0
    ds_read_b128 a[32:35], v6 offset:8192
    buffer_load_dwordx4 v[64:67], v4, s[40:43], s95 offen offset:0 sc1
    v_mfma_f32_16x16x32_bf16 v[116:119], a[4:7], v[32:35], 0
    ds_read_b128 a[36:39], v6 offset:9216
    s_waitcnt lgkmcnt(6)
    v_mfma_f32_16x16x32_bf16 v[120:123], a[8:11], v[32:35], 0
    ds_read_b128 a[0:3], v6 offset:10240
    v_mfma_f32_16x16x32_bf16 v[124:127], a[12:15], v[32:35], 0
    ds_read_b128 a[4:7], v6 offset:11264
    s_waitcnt lgkmcnt(6)
    v_mfma_f32_16x16x32_bf16 v[128:131], a[16:19], v[32:35], 0
    ds_read_b128 a[8:11], v6 offset:12288
    s_waitcnt vmcnt(7)
    v_mfma_f32_16x16x32_bf16 v[112:115], a[20:23], v[36:39], v[112:115]
    ds_read_b128 a[12:15], v6 offset:13312
    buffer_load_dwordx4 v[68:71], v4, s[40:43], s95 offen offset:1024 sc1
    s_waitcnt lgkmcnt(6)
    v_mfma_f32_16x16x32_bf16 v[116:119], a[24:27], v[36:39], v[116:119]
    ds_read_b128 a[16:19], v6 offset:14336
    v_mfma_f32_16x16x32_bf16 v[120:123], a[28:31], v[36:39], v[120:123]
    ds_read_b128 a[20:23], v6 offset:15360
    s_waitcnt lgkmcnt(6)
    v_mfma_f32_16x16x32_bf16 v[124:127], a[32:35], v[36:39], v[124:127]
    ds_read_b128 a[24:27], v6 offset:16384
    v_mfma_f32_16x16x32_bf16 v[128:131], a[36:39], v[36:39], v[128:131]
    ds_read_b128 a[28:31], v6 offset:17408
    s_waitcnt lgkmcnt(6)
    s_waitcnt vmcnt(7)
    v_mfma_f32_16x16x32_bf16 v[112:115], a[0:3], v[40:43], v[112:115]
    ds_read_b128 a[32:35], v6 offset:18432
    buffer_load_dwordx4 v[72:75], v4, s[40:43], s95 offen offset:2048 sc1
    v_mfma_f32_16x16x32_bf16 v[116:119], a[4:7], v[40:43], v[116:119]
    ds_read_b128 a[36:39], v6 offset:19456
    s_waitcnt lgkmcnt(6)
    v_mfma_f32_16x16x32_bf16 v[120:123], a[8:11], v[40:43], v[120:123]
    ds_read_b128 a[0:3], v6 offset:20480
    v_mfma_f32_16x16x32_bf16 v[124:127], a[12:15], v[40:43], v[124:127]
    ds_read_b128 a[4:7], v6 offset:21504
    s_waitcnt lgkmcnt(6)
    v_mfma_f32_16x16x32_bf16 v[128:131], a[16:19], v[40:43], v[128:131]
    ds_read_b128 a[8:11], v6 offset:22528
    s_waitcnt vmcnt(7)
    v_mfma_f32_16x16x32_bf16 v[112:115], a[20:23], v[44:47], v[112:115]
    ds_read_b128 a[12:15], v6 offset:23552
    buffer_load_dwordx4 v[76:79], v4, s[40:43], s95 offen offset:3072 sc1
    s_add_u32 s95, s95, 4096
    s_waitcnt lgkmcnt(6)
    v_mfma_f32_16x16x32_bf16 v[116:119], a[24:27], v[44:47], v[116:119]
    ds_read_b128 a[16:19], v6 offset:24576
    v_mfma_f32_16x16x32_bf16 v[120:123], a[28:31], v[44:47], v[120:123]
    ds_read_b128 a[20:23], v6 offset:25600
    s_waitcnt lgkmcnt(6)
    v_mfma_f32_16x16x32_bf16 v[124:127], a[32:35], v[44:47], v[124:127]
    ds_read_b128 a[24:27], v6 offset:26624
    v_mfma_f32_16x16x32_bf16 v[128:131], a[36:39], v[44:47], v[128:131]
    ds_read_b128 a[28:31], v6 offset:27648
    s_waitcnt lgkmcnt(6)
    s_waitcnt vmcnt(7)
    v_mfma_f32_16x16x32_bf16 v[112:115], a[0:3], v[48:51], v[112:115]
    ds_read_b128 a[32:35], v6 offset:28672
    buffer_load_dwordx4 v[80:83], v4, s[40:43], s95 offen offset:0 sc1
    v_mfma_f32_16x16x32_bf16 v[116:119], a[4:7], v[48:51], v[116:119]
    ds_read_b128 a[36:39], v6 offset:29696
    s_waitcnt lgkmcnt(6)
    v_mfma_f32_16x16x32_bf16 v[120:123], a[8:11], v[48:51], v[120:123]
    ds_read_b128 a[0:3], v6 offset:30720
    v_mfma_f32_16x16x32_bf16 v[124:127], a[12:15], v[48:51], v[124:127]
    ds_read_b128 a[4:7], v6 offset:31744
    s_waitcnt lgkmcnt(6)
    v_mfma_f32_16x16x32_bf16 v[128:131], a[16:19], v[48:51], v[128:131]
    ds_read_b128 a[8:11], v6 offset:32768
    s_waitcnt vmcnt(7)
    v_mfma_f32_16x16x32_bf16 v[112:115], a[20:23], v[52:55], v[112:115]
    ds_read_b128 a[12:15], v6 offset:33792
    buffer_load_dwordx4 v[84:87], v4, s[40:43], s95 offen offset:1024 sc1
    s_waitcnt lgkmcnt(6)
    v_mfma_f32_16x16x32_bf16 v[116:119], a[24:27], v[52:55], v[116:119]
    ds_read_b128 a[16:19], v6 offset:34816
    v_mfma_f32_16x16x32_bf16 v[120:123], a[28:31], v[52:55], v[120:123]
    ds_read_b128 a[20:23], v6 offset:35840
    s_waitcnt lgkmcnt(6)
    v_mfma_f32_16x16x32_bf16 v[124:127], a[32:35], v[52:55], v[124:127]
    ds_read_b128 a[24:27], v6 offset:36864
    v_mfma_f32_16x16x32_bf16 v[128:131], a[36:39], v[52:55], v[128:131]
    ds_read_b128 a[28:31], v6 offset:37888
    s_waitcnt lgkmcnt(6)
    s_waitcnt vmcnt(7)
    v_mfma_f32_16x16x32_bf16 v[112:115], a[0:3], v[56:59], v[112:115]
    ds_read_b128 a[32:35], v6 offset:38912
    buffer_load_dwordx4 v[88:91], v4, s[40:43], s95 offen offset:2048 sc1
    v_mfma_f32_16x16x32_bf16 v[116:119], a[4:7], v[56:59], v[116:119]
    ds_read_b128 a[36:39], v6 offset:39936
    s_waitcnt lgkmcnt(6)
    v_mfma_f32_16x16x32_bf16 v[120:123], a[8:11], v[56:59], v[120:123]
    ds_read_b128 a[0:3], v6 offset:40960
    v_mfma_f32_16x16x32_bf16 v[124:127], a[12:15], v[56:59], v[124:127]
    ds_read_b128 a[4:7], v6 offset:41984
    s_waitcnt lgkmcnt(6)
    v_mfma_f32_16x16x32_bf16 v[128:131], a[16:19], v[56:59], v[128:131]
    ds_read_b128 a[8:11], v6 offset:43008
    s_waitcnt vmcnt(7)
    v_mfma_f32_16x16x32_bf16 v[112:115], a[20:23], v[60:63], v[112:115]
    ds_read_b128 a[12:15], v6 offset:44032
    buffer_load_dwordx4 v[92:95], v4, s[40:43], s95 offen offset:3072 sc1
    s_add_u32 s95, s95, 4096
    s_waitcnt lgkmcnt(6)
    v_mfma_f32_16x16x32_bf16 v[116:119], a[24:27], v[60:63], v[116:119]
    ds_read_b128 a[16:19], v6 offset:45056
    v_mfma_f32_16x16x32_bf16 v[120:123], a[28:31], v[60:63], v[120:123]
    ds_read_b128 a[20:23], v6 offset:46080
    s_waitcnt lgkmcnt(6)
    v_mfma_f32_16x16x32_bf16 v[124:127], a[32:35], v[60:63], v[124:127]
    ds_read_b128 a[24:27], v6 offset:47104
    v_mfma_f32_16x16x32_bf16 v[128:131], a[36:39], v[60:63], v[128:131]
    ds_read_b128 a[28:31], v6 offset:48128
    s_waitcnt lgkmcnt(6)
    s_waitcnt vmcnt(7)
    v_mfma_f32_16x16x32_bf16 v[112:115], a[0:3], v[64:67], v[112:115]
    ds_read_b128 a[32:35], v6 offset:49152
    buffer_load_dwordx4 v[96:99], v4, s[40:43], s95 offen offset:0 sc1
    v_mfma_f32_16x16x32_bf16 v[116:119], a[4:7], v[64:67], v[116:119]
    ds_read_b128 a[36:39], v6 offset:50176
    s_waitcnt lgkmcnt(6)
    v_mfma_f32_16x16x32_bf16 v[120:123], a[8:11], v[64:67], v[120:123]
    ds_read_b128 a[0:3], v4 offset:0
    v_mfma_f32_16x16x32_bf16 v[124:127], a[12:15], v[64:67], v[124:127]
    ds_read_b128 a[4:7], v4 offset:1024
    s_waitcnt lgkmcnt(6)
    v_mfma_f32_16x16x32_bf16 v[128:131], a[16:19], v[64:67], v[128:131]
    ds_read_b128 a[8:11], v4 offset:2048
    s_waitcnt vmcnt(7)
    v_mfma_f32_16x16x32_bf16 v[112:115], a[20:23], v[68:71], v[112:115]
    ds_read_b128 a[12:15], v4 offset:3072
    buffer_load_dwordx4 v[100:103], v4, s[40:43], s95 offen offset:1024 sc1
    s_waitcnt lgkmcnt(6)
    v_mfma_f32_16x16x32_bf16 v[116:119], a[24:27], v[68:71], v[116:119]
    ds_read_b128 a[16:19], v4 offset:4096
    v_mfma_f32_16x16x32_bf16 v[120:123], a[28:31], v[68:71], v[120:123]
    ds_read_b128 a[20:23], v4 offset:5120
    s_waitcnt lgkmcnt(6)
    v_mfma_f32_16x16x32_bf16 v[124:127], a[32:35], v[68:71], v[124:127]
    ds_read_b128 a[24:27], v4 offset:6144
    v_mfma_f32_16x16x32_bf16 v[128:131], a[36:39], v[68:71], v[128:131]
    ds_read_b128 a[28:31], v4 offset:7168
    s_waitcnt lgkmcnt(6)
    s_waitcnt vmcnt(7)
    v_mfma_f32_16x16x32_bf16 v[112:115], a[0:3], v[72:75], v[112:115]
    ds_read_b128 a[32:35], v4 offset:8192
    buffer_load_dwordx4 v[104:107], v4, s[40:43], s95 offen offset:2048 sc1
    v_mfma_f32_16x16x32_bf16 v[116:119], a[4:7], v[72:75], v[116:119]
    ds_read_b128 a[36:39], v4 offset:9216
    s_waitcnt lgkmcnt(6)
    v_mfma_f32_16x16x32_bf16 v[120:123], a[8:11], v[72:75], v[120:123]
    ds_read_b128 a[0:3], v4 offset:10240
    v_mfma_f32_16x16x32_bf16 v[124:127], a[12:15], v[72:75], v[124:127]
    ds_read_b128 a[4:7], v4 offset:11264
    s_waitcnt lgkmcnt(6)
    v_mfma_f32_16x16x32_bf16 v[128:131], a[16:19], v[72:75], v[128:131]
    ds_read_b128 a[8:11], v4 offset:12288
    s_waitcnt vmcnt(7)
    v_mfma_f32_16x16x32_bf16 v[112:115], a[20:23], v[76:79], v[112:115]
    ds_read_b128 a[12:15], v4 offset:13312
    buffer_load_dwordx4 v[108:111], v4, s[40:43], s95 offen offset:3072 sc1
    s_waitcnt lgkmcnt(6)
    v_mfma_f32_16x16x32_bf16 v[116:119], a[24:27], v[76:79], v[116:119]
    ds_read_b128 a[16:19], v4 offset:14336
    v_mfma_f32_16x16x32_bf16 v[120:123], a[28:31], v[76:79], v[120:123]
    ds_read_b128 a[20:23], v4 offset:15360
    s_waitcnt lgkmcnt(6)
    v_mfma_f32_16x16x32_bf16 v[124:127], a[32:35], v[76:79], v[124:127]
    ds_read_b128 a[24:27], v4 offset:16384
    s_barrier
    v_mfma_f32_16x16x32_bf16 v[128:131], a[36:39], v[76:79], v[128:131]
    ds_read_b128 a[28:31], v4 offset:17408
    s_waitcnt lgkmcnt(6)
    s_waitcnt vmcnt(7)
    v_mfma_f32_16x16x32_bf16 v[112:115], a[0:3], v[80:83], v[112:115]
    ds_read_b128 a[32:35], v4 offset:18432
    v_mfma_f32_16x16x32_bf16 v[116:119], a[4:7], v[80:83], v[116:119]
    ds_read_b128 a[36:39], v4 offset:19456
    s_waitcnt lgkmcnt(6)
    v_mfma_f32_16x16x32_bf16 v[120:123], a[8:11], v[80:83], v[120:123]
    ds_read_b128 a[0:3], v4 offset:20480
    s_mul_i32 s101, s71, 12800
    s_add_u32 s100, s101, s33
    s_add_u32 s100, s100, 7481344
    s_add_u32 m0, s101, 102400
    s_nop 0
    buffer_load_dwordx4 v4, s[40:43], s100 offen offset:0 lds
    v_mfma_f32_16x16x32_bf16 v[124:127], a[12:15], v[80:83], v[124:127]
    ds_read_b128 a[4:7], v4 offset:21504
    s_waitcnt lgkmcnt(6)
    v_mfma_f32_16x16x32_bf16 v[128:131], a[16:19], v[80:83], v[128:131]
    ds_read_b128 a[8:11], v4 offset:22528
    buffer_load_dwordx4 v4, s[40:43], s100 offen offset:1024 lds
    s_waitcnt vmcnt(8)
    v_mfma_f32_16x16x32_bf16 v[112:115], a[20:23], v[84:87], v[112:115]
    ds_read_b128 a[12:15], v4 offset:23552
    s_waitcnt lgkmcnt(6)
    v_mfma_f32_16x16x32_bf16 v[116:119], a[24:27], v[84:87], v[116:119]
    ds_read_b128 a[16:19], v4 offset:24576
    v_mfma_f32_16x16x32_bf16 v[120:123], a[28:31], v[84:87], v[120:123]
    ds_read_b128 a[20:23], v4 offset:25600
    buffer_load_dwordx4 v4, s[40:43], s100 offen offset:2048 lds
    s_waitcnt lgkmcnt(6)
    v_mfma_f32_16x16x32_bf16 v[124:127], a[32:35], v[84:87], v[124:127]
    ds_read_b128 a[24:27], v4 offset:26624
    v_mfma_f32_16x16x32_bf16 v[128:131], a[36:39], v[84:87], v[128:131]
    ds_read_b128 a[28:31], v4 offset:27648
    s_waitcnt lgkmcnt(6)
    s_waitcnt vmcnt(8)
    v_mfma_f32_16x16x32_bf16 v[112:115], a[0:3], v[88:91], v[112:115]
    ds_read_b128 a[32:35], v4 offset:28672
    buffer_load_dwordx4 v4, s[40:43], s100 offen offset:3072 lds
    v_mfma_f32_16x16x32_bf16 v[116:119], a[4:7], v[88:91], v[116:119]
    ds_read_b128 a[36:39], v4 offset:29696
    s_waitcnt lgkmcnt(6)
    v_mfma_f32_16x16x32_bf16 v[120:123], a[8:11], v[88:91], v[120:123]
    ds_read_b128 a[0:3], v4 offset:30720
    v_mfma_f32_16x16x32_bf16 v[124:127], a[12:15], v[88:91], v[124:127]
    ds_read_b128 a[4:7], v4 offset:31744
    s_add_u32 s100, s100, 4096
    s_add_u32 m0, s101, 106496
    s_nop 0
    buffer_load_dwordx4 v4, s[40:43], s100 offen offset:0 lds
    s_waitcnt lgkmcnt(6)
    v_mfma_f32_16x16x32_bf16 v[128:131], a[16:19], v[88:91], v[128:131]
    ds_read_b128 a[8:11], v4 offset:32768
    s_waitcnt vmcnt(9)
    v_mfma_f32_16x16x32_bf16 v[112:115], a[20:23], v[92:95], v[112:115]
    ds_read_b128 a[12:15], v4 offset:33792
    s_waitcnt lgkmcnt(6)
    v_mfma_f32_16x16x32_bf16 v[116:119], a[24:27], v[92:95], v[116:119]
    ds_read_b128 a[16:19], v4 offset:34816
    buffer_load_dwordx4 v4, s[40:43], s100 offen offset:1024 lds
    v_mfma_f32_16x16x32_bf16 v[120:123], a[28:31], v[92:95], v[120:123]
    ds_read_b128 a[20:23], v4 offset:35840
    s_waitcnt lgkmcnt(6)
    v_mfma_f32_16x16x32_bf16 v[124:127], a[32:35], v[92:95], v[124:127]
    ds_read_b128 a[24:27], v4 offset:36864
    v_mfma_f32_16x16x32_bf16 v[128:131], a[36:39], v[92:95], v[128:131]
    ds_read_b128 a[28:31], v4 offset:37888
    buffer_load_dwordx4 v4, s[40:43], s100 offen offset:2048 lds
    s_waitcnt lgkmcnt(6)
    s_waitcnt vmcnt(10)
    v_mfma_f32_16x16x32_bf16 v[112:115], a[0:3], v[96:99], v[112:115]
    ds_read_b128 a[32:35], v4 offset:38912
    v_mfma_f32_16x16x32_bf16 v[116:119], a[4:7], v[96:99], v[116:119]
    ds_read_b128 a[36:39], v4 offset:39936
    buffer_load_dwordx4 v4, s[40:43], s100 offen offset:3072 lds
    s_waitcnt lgkmcnt(6)
    v_mfma_f32_16x16x32_bf16 v[120:123], a[8:11], v[96:99], v[120:123]
    ds_read_b128 a[0:3], v4 offset:40960
    v_mfma_f32_16x16x32_bf16 v[124:127], a[12:15], v[96:99], v[124:127]
    ds_read_b128 a[4:7], v4 offset:41984
    s_waitcnt lgkmcnt(6)
    v_mfma_f32_16x16x32_bf16 v[128:131], a[16:19], v[96:99], v[128:131]
    ds_read_b128 a[8:11], v4 offset:43008
    s_add_u32 s100, s100, 4096
    s_add_u32 m0, s101, 110592
    s_nop 0
    buffer_load_dwordx4 v4, s[40:43], s100 offen offset:0 lds
    s_waitcnt vmcnt(11)
    v_mfma_f32_16x16x32_bf16 v[112:115], a[20:23], v[100:103], v[112:115]
    ds_read_b128 a[12:15], v4 offset:44032
    s_waitcnt lgkmcnt(6)
    v_mfma_f32_16x16x32_bf16 v[116:119], a[24:27], v[100:103], v[116:119]
    ds_read_b128 a[16:19], v4 offset:45056
    v_mfma_f32_16x16x32_bf16 v[120:123], a[28:31], v[100:103], v[120:123]
    ds_read_b128 a[20:23], v4 offset:46080
    buffer_load_dwordx4 v4, s[40:43], s100 offen offset:1024 lds
    s_waitcnt lgkmcnt(6)
    v_mfma_f32_16x16x32_bf16 v[124:127], a[32:35], v[100:103], v[124:127]
    ds_read_b128 a[24:27], v4 offset:47104
    v_mfma_f32_16x16x32_bf16 v[128:131], a[36:39], v[100:103], v[128:131]
    ds_read_b128 a[28:31], v4 offset:48128
    s_waitcnt lgkmcnt(6)
    s_waitcnt vmcnt(11)
    v_mfma_f32_16x16x32_bf16 v[112:115], a[0:3], v[104:107], v[112:115]
    ds_read_b128 a[32:35], v4 offset:49152
    buffer_load_dwordx4 v4, s[40:43], s100 offen offset:2048 lds
    v_mfma_f32_16x16x32_bf16 v[116:119], a[4:7], v[104:107], v[116:119]
    ds_read_b128 a[36:39], v4 offset:50176
    s_waitcnt lgkmcnt(6)
    v_mfma_f32_16x16x32_bf16 v[120:123], a[8:11], v[104:107], v[120:123]
    v_mfma_f32_16x16x32_bf16 v[124:127], a[12:15], v[104:107], v[124:127]
    buffer_load_dwordx4 v4, s[40:43], s100 offen offset:3072 lds
    s_waitcnt lgkmcnt(4)
    v_mfma_f32_16x16x32_bf16 v[128:131], a[16:19], v[104:107], v[128:131]
    s_waitcnt vmcnt(12)
    v_mfma_f32_16x16x32_bf16 v[112:115], a[20:23], v[108:111], v[112:115]
    s_waitcnt lgkmcnt(2)
    v_mfma_f32_16x16x32_bf16 v[116:119], a[24:27], v[108:111], v[116:119]
    s_add_u32 s100, s100, 4096
    s_add_u32 m0, s101, 114688
    s_mov_b32 exec_hi, 0
    buffer_load_dwordx4 v4, s[40:43], s100 offen offset:0 lds
    s_mov_b32 exec_hi, -1
    v_mfma_f32_16x16x32_bf16 v[120:123], a[28:31], v[108:111], v[120:123]
    s_waitcnt lgkmcnt(0)
    v_mfma_f32_16x16x32_bf16 v[124:127], a[32:35], v[108:111], v[124:127]
    v_mfma_f32_16x16x32_bf16 v[128:131], a[36:39], v[108:111], v[128:131]
    v_accvgpr_read_b32 v30, a201
    v_accvgpr_read_b32 v31, a202
    v_accvgpr_read_b32 v150, a246
    v_accvgpr_read_b32 v151, a247
    v_accvgpr_read_b32 v152, a248
    v_accvgpr_read_b32 v153, a249
    v_accvgpr_read_b32 v154, a250
    v_accvgpr_read_b32 v155, a251
    v_accvgpr_read_b32 v156, a252
    v_accvgpr_read_b32 v157, a253
    v_accvgpr_read_b32 v158, a254
    v_accvgpr_read_b32 v159, a255
    v_lshlrev_b32 v24, 16, v150
    v_and_b32 v25, 0xffff0000, v150
    v_pk_add_f32 v[112:113], v[112:113], v[24:25]
    v_cvt_pk_bf16_f32 v150, v112, v113
    v_lshlrev_b32 v26, 16, v151
    v_and_b32 v27, 0xffff0000, v151
    v_pk_add_f32 v[114:115], v[114:115], v[26:27]
    v_cvt_pk_bf16_f32 v151, v114, v115
    v_lshlrev_b32 v24, 16, v152
    v_and_b32 v25, 0xffff0000, v152
    v_pk_add_f32 v[116:117], v[116:117], v[24:25]
    v_cvt_pk_bf16_f32 v152, v116, v117
    v_lshlrev_b32 v26, 16, v153
    v_and_b32 v27, 0xffff0000, v153
    v_pk_add_f32 v[118:119], v[118:119], v[26:27]
    v_cvt_pk_bf16_f32 v153, v118, v119
    v_lshlrev_b32 v24, 16, v154
    v_and_b32 v25, 0xffff0000, v154
    v_pk_add_f32 v[120:121], v[120:121], v[24:25]
    v_cvt_pk_bf16_f32 v154, v120, v121
    v_lshlrev_b32 v26, 16, v155
    v_and_b32 v27, 0xffff0000, v155
    v_pk_add_f32 v[122:123], v[122:123], v[26:27]
    v_cvt_pk_bf16_f32 v155, v122, v123
    v_lshlrev_b32 v24, 16, v156
    v_and_b32 v25, 0xffff0000, v156
    v_pk_add_f32 v[124:125], v[124:125], v[24:25]
    v_cvt_pk_bf16_f32 v156, v124, v125
    v_lshlrev_b32 v26, 16, v157
    v_and_b32 v27, 0xffff0000, v157
    v_pk_add_f32 v[126:127], v[126:127], v[26:27]
    v_cvt_pk_bf16_f32 v157, v126, v127
    v_lshlrev_b32 v24, 16, v158
    v_and_b32 v25, 0xffff0000, v158
    v_pk_add_f32 v[128:129], v[128:129], v[24:25]
    v_cvt_pk_bf16_f32 v158, v128, v129
    v_lshlrev_b32 v26, 16, v159
    v_and_b32 v27, 0xffff0000, v159
    v_pk_add_f32 v[130:131], v[130:131], v[26:27]
    v_cvt_pk_bf16_f32 v159, v130, v131
    s_cmp_eq_u32 s79, 0
    s_cbranch_scc1 Lsg_20
    buffer_store_dwordx4 v[150:153], v4, s[40:43], s20 offen
    buffer_store_dwordx4 v[154:157], v4, s[40:43], s20 offen offset:1024
    buffer_store_dwordx2 v[158:159], v30, s[40:43], s21 offen
    s_branch Lse_21
Lsg_20:
    buffer_store_dwordx4 v[150:153], v4, s[40:43], s20 offen sc1
    buffer_store_dwordx4 v[154:157], v4, s[40:43], s20 offen offset:1024 sc1
    buffer_store_dwordx2 v[158:159], v30, s[40:43], s21 offen sc1
Lse_21:
    v_pk_add_f32 v[24:25], v[112:113], v[114:115]
    v_pk_mul_f32 v[26:27], v[112:113], v[112:113]
    v_pk_fma_f32 v[26:27], v[114:115], v[114:115], v[26:27]
    v_pk_add_f32 v[24:25], v[24:25], v[116:117]
    v_pk_fma_f32 v[26:27], v[116:117], v[116:117], v[26:27]
    v_pk_add_f32 v[24:25], v[24:25], v[118:119]
    v_pk_fma_f32 v[26:27], v[118:119], v[118:119], v[26:27]
    v_pk_add_f32 v[24:25], v[24:25], v[120:121]
    v_pk_fma_f32 v[26:27], v[120:121], v[120:121], v[26:27]
    v_pk_add_f32 v[24:25], v[24:25], v[122:123]
    v_pk_fma_f32 v[26:27], v[122:123], v[122:123], v[26:27]
    v_pk_add_f32 v[24:25], v[24:25], v[124:125]
    v_pk_fma_f32 v[26:27], v[124:125], v[124:125], v[26:27]
    v_pk_add_f32 v[24:25], v[24:25], v[126:127]
    v_pk_fma_f32 v[26:27], v[126:127], v[126:127], v[26:27]
    v_pk_add_f32 v[24:25], v[24:25], v[128:129]
    v_pk_fma_f32 v[26:27], v[128:129], v[128:129], v[26:27]
    v_pk_add_f32 v[24:25], v[24:25], v[130:131]
    v_pk_fma_f32 v[26:27], v[130:131], v[130:131], v[26:27]
    v_add_f32 v28, v24, v25
    v_add_f32 v29, v26, v27
    v_mov_b32 v24, v28
    v_mov_b32 v25, v29
    s_nop 0
    v_permlane16_swap_b32 v28, v24
    v_permlane16_swap_b32 v29, v25
    v_add_f32 v28, v28, v24
    v_add_f32 v29, v29, v25
    v_mov_b32 v24, v28
    v_mov_b32 v25, v29
    s_nop 0
    v_permlane32_swap_b32 v28, v24
    v_permlane32_swap_b32 v29, v25
    v_add_f32 v28, v28, v24
    v_add_f32 v29, v29, v25
    s_cmp_eq_u32 s79, 0
    s_cbranch_scc1 Lsg_22
    s_mov_b64 exec, 0xffff
    buffer_store_dwordx2 v[28:29], v31, s[40:43], s22 offen
    s_mov_b64 exec, -1
    s_branch Lse_23
Lsg_22:
    s_mov_b64 exec, 0xffff
    buffer_store_dwordx2 v[28:29], v31, s[40:43], s22 offen sc1
    s_mov_b64 exec, -1
Lse_23:
    v_accvgpr_write_b32 a246, v150
    v_accvgpr_write_b32 a247, v151
    v_accvgpr_write_b32 a248, v152
    v_accvgpr_write_b32 a249, v153
    v_accvgpr_write_b32 a250, v154
    v_accvgpr_write_b32 a251, v155
    v_accvgpr_write_b32 a252, v156
    v_accvgpr_write_b32 a253, v157
    v_accvgpr_write_b32 a254, v158
    v_accvgpr_write_b32 a255, v159
    s_waitcnt vmcnt(0)
    s_barrier
    s_cmp_lg_u32 s71, 0
    s_cbranch_scc1 Lfl_24
    v_mov_b32 v22, s78
    s_mov_b64 exec, 1
    s_cmp_eq_u32 s79, 0
    s_cbranch_scc1 Lsg_25
    buffer_store_dword v22, off, s[40:43], s24
    s_branch Lse_26
Lsg_25:
    buffer_store_dword v22, off, s[40:43], s24 sc1
Lse_26:
    s_mov_b64 exec, -1
Lfl_24:
    s_mul_i32 s101, s71, 10240
    s_add_u32 s100, s101, s33
    s_add_u32 s100, s100, 7532544
    s_add_u32 m0, s101, 0
    s_nop 0
    buffer_load_dwordx4 v4, s[40:43], s100 offen offset:0 lds
    buffer_load_dwordx4 v4, s[40:43], s100 offen offset:1024 lds
    buffer_load_dwordx4 v4, s[40:43], s100 offen offset:2048 lds
    buffer_load_dwordx4 v4, s[40:43], s100 offen offset:3072 lds
    s_add_u32 s100, s100, 4096
    s_add_u32 m0, s101, 4096
    s_nop 0
    buffer_load_dwordx4 v4, s[40:43], s100 offen offset:0 lds
    buffer_load_dwordx4 v4, s[40:43], s100 offen offset:1024 lds
    buffer_load_dwordx4 v4, s[40:43], s100 offen offset:2048 lds
    buffer_load_dwordx4 v4, s[40:43], s100 offen offset:3072 lds
    s_add_u32 s100, s100, 4096
    s_add_u32 m0, s101, 8192
    s_nop 0
    buffer_load_dwordx4 v4, s[40:43], s100 offen offset:0 lds
    buffer_load_dwordx4 v4, s[40:43], s100 offen offset:1024 lds
    v_lshlrev_b32 v24, 3, v1
    s_mul_i32 s50, s76, 2560
    s_add_u32 s50, s50, 1265664
    buffer_load_dwordx2 a[184:185], v24, s[40:43], s50 offen offset:0 sc1
    buffer_load_dwordx2 a[186:187], v24, s[40:43], s50 offen offset:512 sc1
    buffer_load_dwordx2 a[188:189], v24, s[40:43], s50 offen offset:1024 sc1
    buffer_load_dwordx2 a[190:191], v24, s[40:43], s50 offen offset:1536 sc1
    buffer_load_dwordx2 a[192:193], v24, s[40:43], s50 offen offset:2048 sc1
    s_lshr_b32 s49, s76, 2
    s_lshl_b32 s50, s49, 10
    s_add_u32 s50, s50, 1306624
    buffer_load_dwordx2 a[194:195], v24, s[40:43], s50 offen offset:0 sc1
    buffer_load_dwordx2 a[196:197], v24, s[40:43], s50 offen offset:512 sc1
    v_accvgpr_write_b32 a198, 0
    v_accvgpr_write_b32 a199, 0
    v_accvgpr_read_b32 v147, a207
    v_accvgpr_read_b32 v143, a215
    v_accvgpr_read_b32 v25, a203
    v_and_b32 v24, 28, v8
    s_mov_b32 s95, s19
    s_add_u32 s67, s35, s92
    s_add_u32 s68, s97, s92
    s_add_u32 s54, s35, 3407872
    s_add_u32 s55, s97, 3407872
    s_andn2_b32 s56, s10, 127
    s_and_b32 s49, s76, 3
    s_cmp_lg_u32 s49, s71
    s_cbranch_scc1 L_su1
    v_pk_mul_f32 v[176:177], 0, 0
    v_pk_mul_f32 v[178:179], 0, 0
    v_pk_mul_f32 v[180:181], 0, 0
    v_pk_mul_f32 v[182:183], 0, 0
    v_pk_mul_f32 v[184:185], 0, 0
    v_pk_mul_f32 v[186:187], 0, 0
    v_pk_mul_f32 v[188:189], 0, 0
    v_pk_mul_f32 v[190:191], 0, 0
    v_mfma_f32_32x32x16_bf16 a[0:15], v[176:179], v[176:179], 0
    v_mfma_f32_32x32x16_bf16 a[16:31], v[176:179], v[176:179], 0
    v_mfma_f32_32x32x16_bf16 a[32:47], v[176:179], v[176:179], 0
    v_mfma_f32_32x32x16_bf16 a[48:63], v[176:179], v[176:179], 0
    v_accvgpr_read_b32 v18, a208
    v_accvgpr_read_b32 v19, a209
    v_accvgpr_read_b32 v20, a210
    v_accvgpr_read_b32 v144, a211
    v_accvgpr_read_b32 v145, a212
    v_accvgpr_read_b32 v146, a213
    s_mul_i32 s66, s71, 25600
    s_mov_b32 s65, s33
    s_add_u32 s65, s65, s66
    s_add_u32 s65, s65, 8290304
    s_mov_b32 s91, 0
    s_mul_i32 s50, s71, 12800
    s_add_u32 s50, s50, s34
    s_add_u32 s50, s50, 4194304
    s_cmp_eq_u32 s77, 0
    s_cselect_b32 s52, 2, 0
    v_lshrrev_b32 v21, 1, v1
    v_mul_u32_u24 v21, 96, v21
    v_add_u32 v21, v21, v4
    v_add_u32 v21, 1081344, v21
    v_and_b32 v142, 31, v1
    v_lshlrev_b32 v142, 2, v142
    s_max_u32 s53, s52, 1
L_su1:
    s_cmp_lg_u32 s71, 0
    s_cbranch_scc1 Lpd_28
    s_mov_b32 s48, 0
Lpoll_27:
    buffer_load_dword v22, v24, s[40:43], s25 offen sc1
    s_add_u32 s48, s48, 1
    s_waitcnt vmcnt(0)
    v_cmp_ne_u32 vcc, s78, v22
    s_cbranch_vccz Lpd_28
    s_cmp_lt_u32 s48, 0x20000
    s_cbranch_scc1 Lpoll_27
Lpd_28:
    s_waitcnt vmcnt(0)
    s_barrier
    s_cmp_lg_u32 s49, s71
    s_cbranch_scc1 L_q_only
    buffer_load_dwordx2 v[14:15], v25, s[40:43], s23 offen offset:0 sc1
    buffer_load_dwordx2 v[16:17], v25, s[40:43], s23 offen offset:128 sc1
    buffer_load_dwordx4 v[32:35], v4, s[40:43], s95 offen offset:0 sc1
    buffer_load_dwordx4 v[36:39], v4, s[40:43], s95 offen offset:1024 sc1
    buffer_load_dwordx4 v[40:43], v4, s[40:43], s95 offen offset:2048 sc1
    buffer_load_dwordx4 v[44:47], v4, s[40:43], s95 offen offset:3072 sc1
    s_add_u32 s95, s95, 4096
    buffer_load_dwordx4 v[48:51], v4, s[40:43], s95 offen offset:0 sc1
    buffer_load_dwordx4 v[52:55], v4, s[40:43], s95 offen offset:1024 sc1
    buffer_load_dwordx4 v[56:59], v4, s[40:43], s95 offen offset:2048 sc1
    buffer_load_dwordx4 v[60:63], v4, s[40:43], s95 offen offset:3072 sc1
    s_add_u32 s95, s95, 4096
    buffer_load_dwordx4 v[64:67], v4, s[40:43], s95 offen offset:0 sc1
    buffer_load_dwordx4 v[68:71], v4, s[40:43], s95 offen offset:1024 sc1
    buffer_load_dwordx4 v[72:75], v4, s[40:43], s95 offen offset:2048 sc1
    buffer_load_dwordx4 v[76:79], v4, s[40:43], s95 offen offset:3072 sc1
    s_add_u32 s95, s95, 4096
    buffer_load_dwordx4 v[80:83], v4, s[40:43], s95 offen offset:0 sc1
    buffer_load_dwordx4 v[84:87], v4, s[40:43], s95 offen offset:1024 sc1
    buffer_load_dwordx4 v[88:91], v4, s[40:43], s95 offen offset:2048 sc1
    buffer_load_dwordx4 v[92:95], v4, s[40:43], s95 offen offset:3072 sc1
    s_add_u32 s95, s95, 4096
    buffer_load_dwordx4 v[96:99], v4, s[40:43], s95 offen offset:0 sc1
    buffer_load_dwordx4 v[100:103], v4, s[40:43], s95 offen offset:1024 sc1
    buffer_load_dwordx4 v[104:107], v4, s[40:43], s95 offen offset:2048 sc1
    buffer_load_dwordx4 v[108:111], v4, s[40:43], s95 offen offset:3072 sc1
    ds_read_b128 a[140:143], v5 offset:0
    ds_read_b128 a[144:147], v5 offset:20480
    ds_read_b128 a[148:151], v5 offset:40960
    ds_read_b128 a[152:155], v5 offset:1024
    ds_read_b128 a[156:159], v5 offset:21504
    ds_read_b128 a[160:163], v5 offset:46080
    ds_read_b128 a[164:167], v5 offset:2048
    ds_read_b128 a[168:171], v5 offset:22528
    s_cmp_ge_u32 s76, 4
    s_cbranch_scc1 L_unit_v
    s_waitcnt vmcnt(20)
    v_add_f32 v14, v14, v16
    v_add_f32 v15, v15, v17
    v_mov_b32 v24, v14
    v_mov_b32 v25, v15
    s_nop 0
    v_permlane16_swap_b32 v14, v24
    v_permlane16_swap_b32 v15, v25
    v_add_f32 v14, v14, v24
    v_add_f32 v15, v15, v25
    v_mov_b32 v24, v14
    v_mov_b32 v25, v15
    s_nop 0
    v_permlane32_swap_b32 v14, v24
    v_permlane32_swap_b32 v15, v25
    v_add_f32 v14, v14, v24
    v_add_f32 v15, v15, v25
    v_mul_f32 v24, 0xbacccccd, v14
    v_mul_f32 v15, 0x3acccccd, v15
    v_fma_f32 v15, -v24, v24, v15
    v_max_f32 v15, 0, v15
    v_add_f32 v15, 0x3727c5ac, v15
    v_cvt_pk_bf16_f32 v25, v24, v24
    v_rsq_f32 v12, v15
    v_and_b32 v25, 0xffff0000, v25
    v_sub_f32 v26, v24, v25
    v_cvt_pk_bf16_f32 v27, v25, v26
    v_lshrrev_b32 v25, 16, v25
    v_accvgpr_write_b32 a180, v27
    v_accvgpr_write_b32 a181, v25
    v_accvgpr_write_b32 a182, 0
    v_accvgpr_write_b32 a183, 0
    s_waitcnt lgkmcnt(6)
    s_waitcnt vmcnt(19)
    v_mfma_f32_16x16x32_bf16 v[132:135], a[140:143], v[32:35], 0
    ds_read_b128 a[172:175], v6 offset:0
    v_mfma_f32_16x16x32_bf16 v[136:139], a[144:147], v[32:35], 0
    ds_read_b128 a[176:179], v5 offset:3072
    s_waitcnt lgkmcnt(6)
    v_mfma_f32_16x16x32_bf16 v[112:115], a[148:151], v[32:35], 0
    ds_read_b128 a[140:143], v5 offset:23552
    s_waitcnt vmcnt(18)
    v_mfma_f32_16x16x32_bf16 v[132:135], a[152:155], v[36:39], v[132:135]
    ds_read_b128 a[144:147], v6 offset:5120
    s_waitcnt lgkmcnt(6)
    v_mfma_f32_16x16x32_bf16 v[136:139], a[156:159], v[36:39], v[136:139]
    ds_read_b128 a[148:151], v5 offset:4096
    v_mfma_f32_16x16x32_bf16 v[112:115], a[160:163], v[36:39], v[112:115]
    ds_read_b128 a[152:155], v5 offset:24576
    s_waitcnt lgkmcnt(6)
    s_waitcnt vmcnt(17)
    v_mfma_f32_16x16x32_bf16 v[132:135], a[164:167], v[40:43], v[132:135]
    ds_read_b128 a[156:159], v6 offset:10240
    v_mfma_f32_16x16x32_bf16 v[136:139], a[168:171], v[40:43], v[136:139]
    ds_read_b128 a[160:163], v5 offset:5120
    s_waitcnt lgkmcnt(6)
    v_mfma_f32_16x16x32_bf16 v[112:115], a[172:175], v[40:43], v[112:115]
    ds_read_b128 a[164:167], v5 offset:25600
    s_waitcnt vmcnt(16)
    v_mfma_f32_16x16x32_bf16 v[132:135], a[176:179], v[44:47], v[132:135]
    ds_read_b128 a[168:171], v6 offset:15360
    s_waitcnt lgkmcnt(6)
    v_mfma_f32_16x16x32_bf16 v[136:139], a[140:143], v[44:47], v[136:139]
    ds_read_b128 a[172:175], v5 offset:6144
    v_mfma_f32_16x16x32_bf16 v[112:115], a[144:147], v[44:47], v[112:115]
    ds_read_b128 a[176:179], v5 offset:26624
    s_waitcnt lgkmcnt(6)
    s_waitcnt vmcnt(15)
    v_mfma_f32_16x16x32_bf16 v[132:135], a[148:151], v[48:51], v[132:135]
    ds_read_b128 a[140:143], v6 offset:20480
    v_mfma_f32_16x16x32_bf16 v[136:139], a[152:155], v[48:51], v[136:139]
    ds_read_b128 a[144:147], v5 offset:7168
    s_waitcnt lgkmcnt(6)
    v_mfma_f32_16x16x32_bf16 v[112:115], a[156:159], v[48:51], v[112:115]
    ds_read_b128 a[148:151], v5 offset:27648
    s_waitcnt vmcnt(14)
    v_mfma_f32_16x16x32_bf16 v[132:135], a[160:163], v[52:55], v[132:135]
    ds_read_b128 a[152:155], v6 offset:25600
    s_waitcnt lgkmcnt(6)
    v_mfma_f32_16x16x32_bf16 v[136:139], a[164:167], v[52:55], v[136:139]
    ds_read_b128 a[156:159], v5 offset:8192
    v_mfma_f32_16x16x32_bf16 v[112:115], a[168:171], v[52:55], v[112:115]
    ds_read_b128 a[160:163], v5 offset:28672
    s_waitcnt lgkmcnt(6)
    s_waitcnt vmcnt(13)
    v_mfma_f32_16x16x32_bf16 v[132:135], a[172:175], v[56:59], v[132:135]
    ds_read_b128 a[164:167], v6 offset:30720
    v_mfma_f32_16x16x32_bf16 v[136:139], a[176:179], v[56:59], v[136:139]
    ds_read_b128 a[168:171], v5 offset:9216
    s_waitcnt lgkmcnt(6)
    v_mfma_f32_16x16x32_bf16 v[112:115], a[140:143], v[56:59], v[112:115]
    ds_read_b128 a[172:175], v5 offset:29696
    s_waitcnt vmcnt(12)
    v_mfma_f32_16x16x32_bf16 v[132:135], a[144:147], v[60:63], v[132:135]
    ds_read_b128 a[176:179], v6 offset:35840
    s_waitcnt lgkmcnt(6)
    v_mfma_f32_16x16x32_bf16 v[136:139], a[148:151], v[60:63], v[136:139]
    ds_read_b128 a[140:143], v5 offset:10240
    v_mfma_f32_16x16x32_bf16 v[112:115], a[152:155], v[60:63], v[112:115]
    ds_read_b128 a[144:147], v5 offset:30720
    s_waitcnt lgkmcnt(6)
    s_waitcnt vmcnt(11)
    v_mfma_f32_16x16x32_bf16 v[132:135], a[156:159], v[64:67], v[132:135]
    ds_read_b128 a[148:151], v6 offset:40960
    v_mfma_f32_16x16x32_bf16 v[136:139], a[160:163], v[64:67], v[136:139]
    ds_read_b128 a[152:155], v5 offset:11264
    s_waitcnt lgkmcnt(6)
    v_mfma_f32_16x16x32_bf16 v[112:115], a[164:167], v[64:67], v[112:115]
    ds_read_b128 a[156:159], v5 offset:31744
    s_waitcnt vmcnt(10)
    v_mfma_f32_16x16x32_bf16 v[132:135], a[168:171], v[68:71], v[132:135]
    ds_read_b128 a[160:163], v6 offset:46080
    s_waitcnt lgkmcnt(6)
    v_mfma_f32_16x16x32_bf16 v[136:139], a[172:175], v[68:71], v[136:139]
    ds_read_b128 a[164:167], v5 offset:12288
    v_mfma_f32_16x16x32_bf16 v[112:115], a[176:179], v[68:71], v[112:115]
    ds_read_b128 a[168:171], v5 offset:32768
    s_waitcnt lgkmcnt(6)
    s_waitcnt vmcnt(9)
    v_mfma_f32_16x16x32_bf16 v[132:135], a[140:143], v[72:75], v[132:135]
    ds_read_b128 a[172:175], v4 offset:0
    v_mfma_f32_16x16x32_bf16 v[136:139], a[144:147], v[72:75], v[136:139]
    ds_read_b128 a[176:179], v5 offset:13312
    s_waitcnt lgkmcnt(6)
    v_mfma_f32_16x16x32_bf16 v[112:115], a[148:151], v[72:75], v[112:115]
    ds_read_b128 a[140:143], v5 offset:33792
    s_waitcnt vmcnt(8)
    v_mfma_f32_16x16x32_bf16 v[132:135], a[152:155], v[76:79], v[132:135]
    ds_read_b128 a[144:147], v4 offset:5120
    s_waitcnt lgkmcnt(6)
    v_mfma_f32_16x16x32_bf16 v[136:139], a[156:159], v[76:79], v[136:139]
    ds_read_b128 a[148:151], v5 offset:14336
    v_mfma_f32_16x16x32_bf16 v[112:115], a[160:163], v[76:79], v[112:115]
    ds_read_b128 a[152:155], v5 offset:34816
    s_waitcnt lgkmcnt(6)
    s_waitcnt vmcnt(7)
    v_mfma_f32_16x16x32_bf16 v[132:135], a[164:167], v[80:83], v[132:135]
    ds_read_b128 a[156:159], v4 offset:10240
    v_mfma_f32_16x16x32_bf16 v[136:139], a[168:171], v[80:83], v[136:139]
    ds_read_b128 a[160:163], v5 offset:15360
    s_waitcnt lgkmcnt(6)
    v_mfma_f32_16x16x32_bf16 v[112:115], a[172:175], v[80:83], v[112:115]
    ds_read_b128 a[164:167], v5 offset:35840
    s_waitcnt vmcnt(6)
    v_mfma_f32_16x16x32_bf16 v[132:135], a[176:179], v[84:87], v[132:135]
    ds_read_b128 a[168:171], v4 offset:15360
    s_waitcnt lgkmcnt(6)
    v_mfma_f32_16x16x32_bf16 v[136:139], a[140:143], v[84:87], v[136:139]
    ds_read_b128 a[172:175], v5 offset:16384
    v_mfma_f32_16x16x32_bf16 v[112:115], a[144:147], v[84:87], v[112:115]
    ds_read_b128 a[176:179], v5 offset:36864
    s_waitcnt lgkmcnt(6)
    s_waitcnt vmcnt(5)
    v_mfma_f32_16x16x32_bf16 v[132:135], a[148:151], v[88:91], v[132:135]
    ds_read_b128 a[140:143], v4 offset:20480
    v_mfma_f32_16x16x32_bf16 v[136:139], a[152:155], v[88:91], v[136:139]
    ds_read_b128 a[144:147], v5 offset:17408
    s_waitcnt lgkmcnt(6)
    v_mfma_f32_16x16x32_bf16 v[112:115], a[156:159], v[88:91], v[112:115]
    ds_read_b128 a[148:151], v5 offset:37888
    s_waitcnt vmcnt(4)
    v_mfma_f32_16x16x32_bf16 v[132:135], a[160:163], v[92:95], v[132:135]
    ds_read_b128 a[152:155], v4 offset:25600
    s_waitcnt lgkmcnt(6)
    v_mfma_f32_16x16x32_bf16 v[136:139], a[164:167], v[92:95], v[136:139]
    ds_read_b128 a[156:159], v5 offset:18432
    v_mfma_f32_16x16x32_bf16 v[112:115], a[168:171], v[92:95], v[112:115]
    ds_read_b128 a[160:163], v5 offset:38912
    s_waitcnt lgkmcnt(6)
    s_waitcnt vmcnt(3)
    v_mfma_f32_16x16x32_bf16 v[132:135], a[172:175], v[96:99], v[132:135]
    ds_read_b128 a[164:167], v4 offset:30720
    v_mfma_f32_16x16x32_bf16 v[136:139], a[176:179], v[96:99], v[136:139]
    ds_read_b128 a[168:171], v5 offset:19456
    s_waitcnt lgkmcnt(6)
    v_mfma_f32_16x16x32_bf16 v[112:115], a[140:143], v[96:99], v[112:115]
    ds_read_b128 a[172:175], v5 offset:39936
    s_waitcnt vmcnt(2)
    v_mfma_f32_16x16x32_bf16 v[132:135], a[144:147], v[100:103], v[132:135]
    ds_read_b128 a[176:179], v4 offset:35840
    s_waitcnt lgkmcnt(6)
    v_mfma_f32_16x16x32_bf16 v[136:139], a[148:151], v[100:103], v[136:139]
    v_mfma_f32_16x16x32_bf16 v[112:115], a[152:155], v[100:103], v[112:115]
    s_waitcnt lgkmcnt(4)
    s_waitcnt vmcnt(1)
    v_mfma_f32_16x16x32_bf16 v[132:135], a[156:159], v[104:107], v[132:135]
    v_mfma_f32_16x16x32_bf16 v[136:139], a[160:163], v[104:107], v[136:139]
    s_waitcnt lgkmcnt(2)
    v_mfma_f32_16x16x32_bf16 v[112:115], a[164:167], v[104:107], v[112:115]
    s_waitcnt vmcnt(0)
    v_mfma_f32_16x16x32_bf16 v[132:135], a[168:171], v[108:111], v[132:135]
    s_waitcnt lgkmcnt(0)
    v_mfma_f32_16x16x32_bf16 v[136:139], a[172:175], v[108:111], v[136:139]
    v_mfma_f32_16x16x32_bf16 v[112:115], a[176:179], v[108:111], v[112:115]
    v_mfma_f32_16x16x32_bf16 v[132:135], a[194:197], a[180:183], v[132:135]
    v_mfma_f32_16x16x32_bf16 v[136:139], a[196:199], a[180:183], v[136:139]
    s_nop 6
    v_pk_mul_f32 v[132:133], v[132:133], v[12:13] op_sel_hi:[1,0]
    v_pk_mul_f32 v[134:135], v[134:135], v[12:13] op_sel_hi:[1,0]
    v_cvt_pk_bf16_f32 v132, v132, v133
    v_cvt_pk_bf16_f32 v133, v134, v135
    v_pk_mul_f32 v[136:137], v[136:137], v[12:13] op_sel_hi:[1,0]
    v_pk_mul_f32 v[138:139], v[138:139], v[12:13] op_sel_hi:[1,0]
    v_cvt_pk_bf16_f32 v136, v136, v137
    v_cvt_pk_bf16_f32 v137, v138, v139
    s_mov_b64 s[84:85], 0xffff
    s_branch L_unit_pub
L_unit_v:
    s_waitcnt vmcnt(20)
    v_add_f32 v14, v14, v16
    v_add_f32 v15, v15, v17
    v_mov_b32 v24, v14
    v_mov_b32 v25, v15
    s_nop 0
    v_permlane16_swap_b32 v14, v24
    v_permlane16_swap_b32 v15, v25
    v_add_f32 v14, v14, v24
    v_add_f32 v15, v15, v25
    v_mov_b32 v24, v14
    v_mov_b32 v25, v15
    s_nop 0
    v_permlane32_swap_b32 v14, v24
    v_permlane32_swap_b32 v15, v25
    v_add_f32 v14, v14, v24
    v_add_f32 v15, v15, v25
    v_mul_f32 v24, 0xbacccccd, v14
    v_mul_f32 v15, 0x3acccccd, v15
    v_fma_f32 v15, -v24, v24, v15
    v_max_f32 v15, 0, v15
    v_add_f32 v15, 0x3727c5ac, v15
    v_cvt_pk_bf16_f32 v25, v24, v24
    v_rsq_f32 v12, v15
    v_and_b32 v25, 0xffff0000, v25
    v_sub_f32 v26, v24, v25
    v_cvt_pk_bf16_f32 v27, v25, v26
    v_lshrrev_b32 v25, 16, v25
    v_accvgpr_write_b32 a180, v27
    v_accvgpr_write_b32 a181, v25
    v_accvgpr_write_b32 a182, 0
    v_accvgpr_write_b32 a183, 0
    v_mov_b32_dpp v14, v12 row_newbcast:0 row_mask:0x1 bank_mask:0xf
    v_mov_b32_dpp v14, v12 row_newbcast:4 row_mask:0x2 bank_mask:0xf
    v_mov_b32_dpp v14, v12 row_newbcast:8 row_mask:0x4 bank_mask:0xf
    v_mov_b32_dpp v14, v12 row_newbcast:12 row_mask:0x8 bank_mask:0xf
    v_mov_b32_dpp v15, v12 row_newbcast:1 row_mask:0x1 bank_mask:0xf
    v_mov_b32_dpp v15, v12 row_newbcast:5 row_mask:0x2 bank_mask:0xf
    v_mov_b32_dpp v15, v12 row_newbcast:9 row_mask:0x4 bank_mask:0xf
    v_mov_b32_dpp v15, v12 row_newbcast:13 row_mask:0x8 bank_mask:0xf
    v_mov_b32_dpp v16, v12 row_newbcast:2 row_mask:0x1 bank_mask:0xf
    v_mov_b32_dpp v16, v12 row_newbcast:6 row_mask:0x2 bank_mask:0xf
    v_mov_b32_dpp v16, v12 row_newbcast:10 row_mask:0x4 bank_mask:0xf
    v_mov_b32_dpp v16, v12 row_newbcast:14 row_mask:0x8 bank_mask:0xf
    v_mov_b32_dpp v17, v12 row_newbcast:3 row_mask:0x1 bank_mask:0xf
    v_mov_b32_dpp v17, v12 row_newbcast:7 row_mask:0x2 bank_mask:0xf
    v_mov_b32_dpp v17, v12 row_newbcast:11 row_mask:0x4 bank_mask:0xf
    v_mov_b32_dpp v17, v12 row_newbcast:15 row_mask:0x8 bank_mask:0xf
    s_waitcnt lgkmcnt(6)
    s_waitcnt vmcnt(19)
    v_mfma_f32_16x16x32_bf16 v[132:135], v[32:35], a[140:143], 0
    ds_read_b128 a[172:175], v6 offset:0
    v_mfma_f32_16x16x32_bf16 v[136:139], v[32:35], a[144:147], 0
    ds_read_b128 a[176:179], v5 offset:3072
    s_waitcnt lgkmcnt(6)
    v_mfma_f32_16x16x32_bf16 v[112:115], a[148:151], v[32:35], 0
    ds_read_b128 a[140:143], v5 offset:23552
    s_waitcnt vmcnt(18)
    v_mfma_f32_16x16x32_bf16 v[132:135], v[36:39], a[152:155], v[132:135]
    ds_read_b128 a[144:147], v6 offset:5120
    s_waitcnt lgkmcnt(6)
    v_mfma_f32_16x16x32_bf16 v[136:139], v[36:39], a[156:159], v[136:139]
    ds_read_b128 a[148:151], v5 offset:4096
    v_mfma_f32_16x16x32_bf16 v[112:115], a[160:163], v[36:39], v[112:115]
    ds_read_b128 a[152:155], v5 offset:24576
    s_waitcnt lgkmcnt(6)
    s_waitcnt vmcnt(17)
    v_mfma_f32_16x16x32_bf16 v[132:135], v[40:43], a[164:167], v[132:135]
    ds_read_b128 a[156:159], v6 offset:10240
    v_mfma_f32_16x16x32_bf16 v[136:139], v[40:43], a[168:171], v[136:139]
    ds_read_b128 a[160:163], v5 offset:5120
    s_waitcnt lgkmcnt(6)
    v_mfma_f32_16x16x32_bf16 v[112:115], a[172:175], v[40:43], v[112:115]
    ds_read_b128 a[164:167], v5 offset:25600
    s_waitcnt vmcnt(16)
    v_mfma_f32_16x16x32_bf16 v[132:135], v[44:47], a[176:179], v[132:135]
    ds_read_b128 a[168:171], v6 offset:15360
    s_waitcnt lgkmcnt(6)
    v_mfma_f32_16x16x32_bf16 v[136:139], v[44:47], a[140:143], v[136:139]
    ds_read_b128 a[172:175], v5 offset:6144
    v_mfma_f32_16x16x32_bf16 v[112:115], a[144:147], v[44:47], v[112:115]
    ds_read_b128 a[176:179], v5 offset:26624
    s_waitcnt lgkmcnt(6)
    s_waitcnt vmcnt(15)
    v_mfma_f32_16x16x32_bf16 v[132:135], v[48:51], a[148:151], v[132:135]
    ds_read_b128 a[140:143], v6 offset:20480
    v_mfma_f32_16x16x32_bf16 v[136:139], v[48:51], a[152:155], v[136:139]
    ds_read_b128 a[144:147], v5 offset:7168
    s_waitcnt lgkmcnt(6)
    v_mfma_f32_16x16x32_bf16 v[112:115], a[156:159], v[48:51], v[112:115]
    ds_read_b128 a[148:151], v5 offset:27648
    s_waitcnt vmcnt(14)
    v_mfma_f32_16x16x32_bf16 v[132:135], v[52:55], a[160:163], v[132:135]
    ds_read_b128 a[152:155], v6 offset:25600
    s_waitcnt lgkmcnt(6)
    v_mfma_f32_16x16x32_bf16 v[136:139], v[52:55], a[164:167], v[136:139]
    ds_read_b128 a[156:159], v5 offset:8192
    v_mfma_f32_16x16x32_bf16 v[112:115], a[168:171], v[52:55], v[112:115]
    ds_read_b128 a[160:163], v5 offset:28672
    s_waitcnt lgkmcnt(6)
    s_waitcnt vmcnt(13)
    v_mfma_f32_16x16x32_bf16 v[132:135], v[56:59], a[172:175], v[132:135]
    ds_read_b128 a[164:167], v6 offset:30720
    v_mfma_f32_16x16x32_bf16 v[136:139], v[56:59], a[176:179], v[136:139]
    ds_read_b128 a[168:171], v5 offset:9216
    s_waitcnt lgkmcnt(6)
    v_mfma_f32_16x16x32_bf16 v[112:115], a[140:143], v[56:59], v[112:115]
    ds_read_b128 a[172:175], v5 offset:29696
    s_waitcnt vmcnt(12)
    v_mfma_f32_16x16x32_bf16 v[132:135], v[60:63], a[144:147], v[132:135]
    ds_read_b128 a[176:179], v6 offset:35840
    s_waitcnt lgkmcnt(6)
    v_mfma_f32_16x16x32_bf16 v[136:139], v[60:63], a[148:151], v[136:139]
    ds_read_b128 a[140:143], v5 offset:10240
    v_mfma_f32_16x16x32_bf16 v[112:115], a[152:155], v[60:63], v[112:115]
    ds_read_b128 a[144:147], v5 offset:30720
    s_waitcnt lgkmcnt(6)
    s_waitcnt vmcnt(11)
    v_mfma_f32_16x16x32_bf16 v[132:135], v[64:67], a[156:159], v[132:135]
    ds_read_b128 a[148:151], v6 offset:40960
    v_mfma_f32_16x16x32_bf16 v[136:139], v[64:67], a[160:163], v[136:139]
    ds_read_b128 a[152:155], v5 offset:11264
    s_waitcnt lgkmcnt(6)
    v_mfma_f32_16x16x32_bf16 v[112:115], a[164:167], v[64:67], v[112:115]
    ds_read_b128 a[156:159], v5 offset:31744
    s_waitcnt vmcnt(10)
    v_mfma_f32_16x16x32_bf16 v[132:135], v[68:71], a[168:171], v[132:135]
    ds_read_b128 a[160:163], v6 offset:46080
    s_waitcnt lgkmcnt(6)
    v_mfma_f32_16x16x32_bf16 v[136:139], v[68:71], a[172:175], v[136:139]
    ds_read_b128 a[164:167], v5 offset:12288
    v_mfma_f32_16x16x32_bf16 v[112:115], a[176:179], v[68:71], v[112:115]
    ds_read_b128 a[168:171], v5 offset:32768
    s_waitcnt lgkmcnt(6)
    s_waitcnt vmcnt(9)
    v_mfma_f32_16x16x32_bf16 v[132:135], v[72:75], a[140:143], v[132:135]
    ds_read_b128 a[172:175], v4 offset:0
    v_mfma_f32_16x16x32_bf16 v[136:139], v[72:75], a[144:147], v[136:139]
    ds_read_b128 a[176:179], v5 offset:13312
    s_waitcnt lgkmcnt(6)
    v_mfma_f32_16x16x32_bf16 v[112:115], a[148:151], v[72:75], v[112:115]
    ds_read_b128 a[140:143], v5 offset:33792
    s_waitcnt vmcnt(8)
    v_mfma_f32_16x16x32_bf16 v[132:135], v[76:79], a[152:155], v[132:135]
    ds_read_b128 a[144:147], v4 offset:5120
    s_waitcnt lgkmcnt(6)
    v_mfma_f32_16x16x32_bf16 v[136:139], v[76:79], a[156:159], v[136:139]
    ds_read_b128 a[148:151], v5 offset:14336
    v_mfma_f32_16x16x32_bf16 v[112:115], a[160:163], v[76:79], v[112:115]
    ds_read_b128 a[152:155], v5 offset:34816
    s_waitcnt lgkmcnt(6)
    s_waitcnt vmcnt(7)
    v_mfma_f32_16x16x32_bf16 v[132:135], v[80:83], a[164:167], v[132:135]
    ds_read_b128 a[156:159], v4 offset:10240
    v_mfma_f32_16x16x32_bf16 v[136:139], v[80:83], a[168:171], v[136:139]
    ds_read_b128 a[160:163], v5 offset:15360
    s_waitcnt lgkmcnt(6)
    v_mfma_f32_16x16x32_bf16 v[112:115], a[172:175], v[80:83], v[112:115]
    ds_read_b128 a[164:167], v5 offset:35840
    s_waitcnt vmcnt(6)
    v_mfma_f32_16x16x32_bf16 v[132:135], v[84:87], a[176:179], v[132:135]
    ds_read_b128 a[168:171], v4 offset:15360
    s_waitcnt lgkmcnt(6)
    v_mfma_f32_16x16x32_bf16 v[136:139], v[84:87], a[140:143], v[136:139]
    ds_read_b128 a[172:175], v5 offset:16384
    v_mfma_f32_16x16x32_bf16 v[112:115], a[144:147], v[84:87], v[112:115]
    ds_read_b128 a[176:179], v5 offset:36864
    s_waitcnt lgkmcnt(6)
    s_waitcnt vmcnt(5)
    v_mfma_f32_16x16x32_bf16 v[132:135], v[88:91], a[148:151], v[132:135]
    ds_read_b128 a[140:143], v4 offset:20480
    v_mfma_f32_16x16x32_bf16 v[136:139], v[88:91], a[152:155], v[136:139]
    ds_read_b128 a[144:147], v5 offset:17408
    s_waitcnt lgkmcnt(6)
    v_mfma_f32_16x16x32_bf16 v[112:115], a[156:159], v[88:91], v[112:115]
    ds_read_b128 a[148:151], v5 offset:37888
    s_waitcnt vmcnt(4)
    v_mfma_f32_16x16x32_bf16 v[132:135], v[92:95], a[160:163], v[132:135]
    ds_read_b128 a[152:155], v4 offset:25600
    s_waitcnt lgkmcnt(6)
    v_mfma_f32_16x16x32_bf16 v[136:139], v[92:95], a[164:167], v[136:139]
    ds_read_b128 a[156:159], v5 offset:18432
    v_mfma_f32_16x16x32_bf16 v[112:115], a[168:171], v[92:95], v[112:115]
    ds_read_b128 a[160:163], v5 offset:38912
    s_waitcnt lgkmcnt(6)
    s_waitcnt vmcnt(3)
    v_mfma_f32_16x16x32_bf16 v[132:135], v[96:99], a[172:175], v[132:135]
    ds_read_b128 a[164:167], v4 offset:30720
    v_mfma_f32_16x16x32_bf16 v[136:139], v[96:99], a[176:179], v[136:139]
    ds_read_b128 a[168:171], v5 offset:19456
    s_waitcnt lgkmcnt(6)
    v_mfma_f32_16x16x32_bf16 v[112:115], a[140:143], v[96:99], v[112:115]
    ds_read_b128 a[172:175], v5 offset:39936
    s_waitcnt vmcnt(2)
    v_mfma_f32_16x16x32_bf16 v[132:135], v[100:103], a[144:147], v[132:135]
    ds_read_b128 a[176:179], v4 offset:35840
    s_waitcnt lgkmcnt(6)
    v_mfma_f32_16x16x32_bf16 v[136:139], v[100:103], a[148:151], v[136:139]
    v_mfma_f32_16x16x32_bf16 v[112:115], a[152:155], v[100:103], v[112:115]
    s_waitcnt lgkmcnt(4)
    s_waitcnt vmcnt(1)
    v_mfma_f32_16x16x32_bf16 v[132:135], v[104:107], a[156:159], v[132:135]
    v_mfma_f32_16x16x32_bf16 v[136:139], v[104:107], a[160:163], v[136:139]
    s_waitcnt lgkmcnt(2)
    v_mfma_f32_16x16x32_bf16 v[112:115], a[164:167], v[104:107], v[112:115]
    s_waitcnt vmcnt(0)
    v_mfma_f32_16x16x32_bf16 v[132:135], v[108:111], a[168:171], v[132:135]
    s_waitcnt lgkmcnt(0)
    v_mfma_f32_16x16x32_bf16 v[136:139], v[108:111], a[172:175], v[136:139]
    v_mfma_f32_16x16x32_bf16 v[112:115], a[176:179], v[108:111], v[112:115]
    v_mfma_f32_16x16x32_bf16 v[132:135], a[180:183], a[194:197], v[132:135]
    v_mfma_f32_16x16x32_bf16 v[136:139], a[180:183], a[196:199], v[136:139]
    s_nop 6
    v_pk_mul_f32 v[132:133], v[132:133], v[14:15]
    v_pk_mul_f32 v[134:135], v[134:135], v[16:17]
    v_cvt_pk_bf16_f32 v132, v132, v133
    v_cvt_pk_bf16_f32 v133, v134, v135
    v_pk_mul_f32 v[136:137], v[136:137], v[14:15]
    v_pk_mul_f32 v[138:139], v[138:139], v[16:17]
    v_cvt_pk_bf16_f32 v136, v136, v137
    v_cvt_pk_bf16_f32 v137, v138, v139
    s_mov_b32 exec_lo, 0xfff0fff0
    s_mov_b32 exec_hi, 0xfff0fff0
    v_mov_b32 v136, 0
    v_mov_b32 v137, 0
    s_mov_b32 exec_lo, 0x300030
    s_mov_b32 exec_hi, 0x300030
    v_mov_b32 v136, 0x3f803f80
    v_mov_b32 v137, 0x3f803f80
    s_mov_b64 exec, -1
    s_mov_b64 s[84:85], -1
L_unit_pub:
    s_cmp_eq_u32 s79, 0
    s_cbranch_scc1 Lsg_29
    buffer_store_dwordx2 v[132:133], v147, s[40:43], s54 offen
    s_mov_b64 exec, s[84:85]
    buffer_store_dwordx2 v[136:137], v143, s[40:43], s55 offen
    s_mov_b64 exec, -1
    s_branch Lse_30
Lsg_29:
    buffer_store_dwordx2 v[132:133], v147, s[40:43], s54 offen sc1
    s_mov_b64 exec, s[84:85]
    buffer_store_dwordx2 v[136:137], v143, s[40:43], s55 offen sc1
    s_mov_b64 exec, -1
Lse_30:
    buffer_store_dwordx2 v[132:133], v147, s[40:43], s67 offen sc1
    s_mov_b64 exec, s[84:85]
    buffer_store_dwordx2 v[136:137], v143, s[40:43], s68 offen sc1
    s_mov_b64 exec, -1
    ds_read_b128 a[140:143], v5 offset:41984
    ds_read_b128 a[144:147], v5 offset:43008
    ds_read_b128 a[148:151], v5 offset:44032
    ds_read_b128 a[152:155], v5 offset:45056
    ds_read_b128 a[156:159], v5 offset:47104
    ds_read_b128 a[160:163], v5 offset:48128
    ds_read_b128 a[164:167], v5 offset:49152
    ds_read_b128 a[168:171], v5 offset:50176
    s_waitcnt lgkmcnt(6)
    v_mfma_f32_16x16x32_bf16 v[116:119], a[140:143], v[32:35], 0
    ds_read_b128 a[172:175], v6 offset:1024
    v_mfma_f32_16x16x32_bf16 v[120:123], a[144:147], v[32:35], 0
    ds_read_b128 a[176:179], v6 offset:2048
    s_waitcnt lgkmcnt(6)
    v_mfma_f32_16x16x32_bf16 v[124:127], a[148:151], v[32:35], 0
    ds_read_b128 a[140:143], v6 offset:3072
    v_mfma_f32_16x16x32_bf16 v[128:131], a[152:155], v[32:35], 0
    ds_read_b128 a[144:147], v6 offset:4096
    s_waitcnt lgkmcnt(6)
    v_mfma_f32_16x16x32_bf16 v[116:119], a[156:159], v[36:39], v[116:119]
    ds_read_b128 a[148:151], v6 offset:6144
    v_mfma_f32_16x16x32_bf16 v[120:123], a[160:163], v[36:39], v[120:123]
    ds_read_b128 a[152:155], v6 offset:7168
    s_waitcnt lgkmcnt(6)
    v_mfma_f32_16x16x32_bf16 v[124:127], a[164:167], v[36:39], v[124:127]
    ds_read_b128 a[156:159], v6 offset:8192
    v_mfma_f32_16x16x32_bf16 v[128:131], a[168:171], v[36:39], v[128:131]
    ds_read_b128 a[160:163], v6 offset:9216
    s_waitcnt lgkmcnt(6)
    v_mfma_f32_16x16x32_bf16 v[116:119], a[172:175], v[40:43], v[116:119]
    ds_read_b128 a[164:167], v6 offset:11264
    v_mfma_f32_16x16x32_bf16 v[120:123], a[176:179], v[40:43], v[120:123]
    ds_read_b128 a[168:171], v6 offset:12288
    s_waitcnt lgkmcnt(6)
    v_mfma_f32_16x16x32_bf16 v[124:127], a[140:143], v[40:43], v[124:127]
    ds_read_b128 a[172:175], v6 offset:13312
    v_mfma_f32_16x16x32_bf16 v[128:131], a[144:147], v[40:43], v[128:131]
    ds_read_b128 a[176:179], v6 offset:14336
    s_waitcnt lgkmcnt(6)
    v_mfma_f32_16x16x32_bf16 v[116:119], a[148:151], v[44:47], v[116:119]
    ds_read_b128 a[140:143], v6 offset:16384
    v_mfma_f32_16x16x32_bf16 v[120:123], a[152:155], v[44:47], v[120:123]
    ds_read_b128 a[144:147], v6 offset:17408
    s_waitcnt lgkmcnt(6)
    v_mfma_f32_16x16x32_bf16 v[124:127], a[156:159], v[44:47], v[124:127]
    ds_read_b128 a[148:151], v6 offset:18432
    v_mfma_f32_16x16x32_bf16 v[128:131], a[160:163], v[44:47], v[128:131]
    ds_read_b128 a[152:155], v6 offset:19456
    s_waitcnt lgkmcnt(6)
    v_mfma_f32_16x16x32_bf16 v[116:119], a[164:167], v[48:51], v[116:119]
    ds_read_b128 a[156:159], v6 offset:21504
    v_mfma_f32_16x16x32_bf16 v[120:123], a[168:171], v[48:51], v[120:123]
    ds_read_b128 a[160:163], v6 offset:22528
    s_waitcnt lgkmcnt(6)
    v_mfma_f32_16x16x32_bf16 v[124:127], a[172:175], v[48:51], v[124:127]
    ds_read_b128 a[164:167], v6 offset:23552
    v_mfma_f32_16x16x32_bf16 v[128:131], a[176:179], v[48:51], v[128:131]
    ds_read_b128 a[168:171], v6 offset:24576
    s_waitcnt lgkmcnt(6)
    v_mfma_f32_16x16x32_bf16 v[116:119], a[140:143], v[52:55], v[116:119]
    ds_read_b128 a[172:175], v6 offset:26624
    s_waitcnt vmcnt(2)
    v_mov_b32 v22, s78
    s_mov_b64 exec, 1
    s_cmp_eq_u32 s79, 0
    s_cbranch_scc1 Lsg_31
    buffer_store_dword v22, off, s[40:43], s10
    s_branch Lse_32
Lsg_31:
    buffer_store_dword v22, off, s[40:43], s10 sc1
Lse_32:
    s_mov_b64 exec, -1
    v_mfma_f32_16x16x32_bf16 v[120:123], a[144:147], v[52:55], v[120:123]
    ds_read_b128 a[176:179], v6 offset:27648
    s_waitcnt lgkmcnt(6)
    v_mfma_f32_16x16x32_bf16 v[124:127], a[148:151], v[52:55], v[124:127]
    ds_read_b128 a[140:143], v6 offset:28672
    v_mfma_f32_16x16x32_bf16 v[128:131], a[152:155], v[52:55], v[128:131]
    ds_read_b128 a[144:147], v6 offset:29696
    s_waitcnt lgkmcnt(6)
    v_mfma_f32_16x16x32_bf16 v[116:119], a[156:159], v[56:59], v[116:119]
    ds_read_b128 a[148:151], v6 offset:31744
    v_mfma_f32_16x16x32_bf16 v[120:123], a[160:163], v[56:59], v[120:123]
    ds_read_b128 a[152:155], v6 offset:32768
    s_waitcnt lgkmcnt(6)
    v_mfma_f32_16x16x32_bf16 v[124:127], a[164:167], v[56:59], v[124:127]
    ds_read_b128 a[156:159], v6 offset:33792
    v_mfma_f32_16x16x32_bf16 v[128:131], a[168:171], v[56:59], v[128:131]
    ds_read_b128 a[160:163], v6 offset:34816
    s_waitcnt lgkmcnt(6)
    v_mfma_f32_16x16x32_bf16 v[116:119], a[172:175], v[60:63], v[116:119]
    ds_read_b128 a[164:167], v6 offset:36864
    v_mfma_f32_16x16x32_bf16 v[120:123], a[176:179], v[60:63], v[120:123]
    ds_read_b128 a[168:171], v6 offset:37888
    s_waitcnt lgkmcnt(6)
    v_mfma_f32_16x16x32_bf16 v[124:127], a[140:143], v[60:63], v[124:127]
    ds_read_b128 a[172:175], v6 offset:38912
    v_mfma_f32_16x16x32_bf16 v[128:131], a[144:147], v[60:63], v[128:131]
    ds_read_b128 a[176:179], v6 offset:39936
    s_waitcnt lgkmcnt(6)
    v_mfma_f32_16x16x32_bf16 v[116:119], a[148:151], v[64:67], v[116:119]
    ds_read_b128 a[140:143], v6 offset:41984
    v_mfma_f32_16x16x32_bf16 v[120:123], a[152:155], v[64:67], v[120:123]
    ds_read_b128 a[144:147], v6 offset:43008
    s_waitcnt lgkmcnt(6)
    v_mfma_f32_16x16x32_bf16 v[124:127], a[156:159], v[64:67], v[124:127]
    ds_read_b128 a[148:151], v6 offset:44032
    v_mfma_f32_16x16x32_bf16 v[128:131], a[160:163], v[64:67], v[128:131]
    ds_read_b128 a[152:155], v6 offset:45056
    s_waitcnt lgkmcnt(6)
    v_mfma_f32_16x16x32_bf16 v[116:119], a[164:167], v[68:71], v[116:119]
    ds_read_b128 a[156:159], v6 offset:47104
    v_mfma_f32_16x16x32_bf16 v[120:123], a[168:171], v[68:71], v[120:123]
    ds_read_b128 a[160:163], v6 offset:48128
    s_waitcnt lgkmcnt(6)
    v_mfma_f32_16x16x32_bf16 v[124:127], a[172:175], v[68:71], v[124:127]
    ds_read_b128 a[164:167], v6 offset:49152
    s_waitcnt vmcnt(0)
    s_mov_b64 exec, 1
    buffer_store_dword v22, off, s[40:43], s26 sc1
    s_mov_b64 exec, -1
    v_mfma_f32_16x16x32_bf16 v[128:131], a[176:179], v[68:71], v[128:131]
    ds_read_b128 a[168:171], v6 offset:50176
    s_waitcnt lgkmcnt(6)
    v_mfma_f32_16x16x32_bf16 v[116:119], a[140:143], v[72:75], v[116:119]
    ds_read_b128 a[172:175], v4 offset:1024
    v_mfma_f32_16x16x32_bf16 v[120:123], a[144:147], v[72:75], v[120:123]
    ds_read_b128 a[176:179], v4 offset:2048
    s_waitcnt lgkmcnt(6)
    v_mfma_f32_16x16x32_bf16 v[124:127], a[148:151], v[72:75], v[124:127]
    ds_read_b128 a[140:143], v4 offset:3072
    v_mfma_f32_16x16x32_bf16 v[128:131], a[152:155], v[72:75], v[128:131]
    ds_read_b128 a[144:147], v4 offset:4096
    s_waitcnt lgkmcnt(6)
    v_mfma_f32_16x16x32_bf16 v[116:119], a[156:159], v[76:79], v[116:119]
    ds_read_b128 a[148:151], v4 offset:6144
    v_mfma_f32_16x16x32_bf16 v[120:123], a[160:163], v[76:79], v[120:123]
    ds_read_b128 a[152:155], v4 offset:7168
    s_waitcnt lgkmcnt(6)
    v_mfma_f32_16x16x32_bf16 v[124:127], a[164:167], v[76:79], v[124:127]
    ds_read_b128 a[156:159], v4 offset:8192
    v_mfma_f32_16x16x32_bf16 v[128:131], a[168:171], v[76:79], v[128:131]
    ds_read_b128 a[160:163], v4 offset:9216
    s_waitcnt lgkmcnt(6)
    v_mfma_f32_16x16x32_bf16 v[116:119], a[172:175], v[80:83], v[116:119]
    ds_read_b128 a[164:167], v4 offset:11264
    v_mfma_f32_16x16x32_bf16 v[120:123], a[176:179], v[80:83], v[120:123]
    ds_read_b128 a[168:171], v4 offset:12288
    s_waitcnt lgkmcnt(6)
    v_mfma_f32_16x16x32_bf16 v[124:127], a[140:143], v[80:83], v[124:127]
    ds_read_b128 a[172:175], v4 offset:13312
    v_mfma_f32_16x16x32_bf16 v[128:131], a[144:147], v[80:83], v[128:131]
    ds_read_b128 a[176:179], v4 offset:14336
    s_waitcnt lgkmcnt(6)
    v_mfma_f32_16x16x32_bf16 v[116:119], a[148:151], v[84:87], v[116:119]
    ds_read_b128 a[140:143], v4 offset:16384
    v_mfma_f32_16x16x32_bf16 v[120:123], a[152:155], v[84:87], v[120:123]
    ds_read_b128 a[144:147], v4 offset:17408
    s_waitcnt lgkmcnt(6)
    v_mfma_f32_16x16x32_bf16 v[124:127], a[156:159], v[84:87], v[124:127]
    ds_read_b128 a[148:151], v4 offset:18432
    v_mfma_f32_16x16x32_bf16 v[128:131], a[160:163], v[84:87], v[128:131]
    ds_read_b128 a[152:155], v4 offset:19456
    s_waitcnt lgkmcnt(6)
    v_mfma_f32_16x16x32_bf16 v[116:119], a[164:167], v[88:91], v[116:119]
    ds_read_b128 a[156:159], v4 offset:21504
    v_mfma_f32_16x16x32_bf16 v[120:123], a[168:171], v[88:91], v[120:123]
    ds_read_b128 a[160:163], v4 offset:22528
    s_waitcnt lgkmcnt(6)
    v_mfma_f32_16x16x32_bf16 v[124:127], a[172:175], v[88:91], v[124:127]
    ds_read_b128 a[164:167], v4 offset:23552
    v_mfma_f32_16x16x32_bf16 v[128:131], a[176:179], v[88:91], v[128:131]
    ds_read_b128 a[168:171], v4 offset:24576
    s_waitcnt lgkmcnt(6)
    v_mfma_f32_16x16x32_bf16 v[116:119], a[140:143], v[92:95], v[116:119]
    ds_read_b128 a[172:175], v4 offset:26624
    v_mfma_f32_16x16x32_bf16 v[120:123], a[144:147], v[92:95], v[120:123]
    ds_read_b128 a[176:179], v4 offset:27648
    s_waitcnt lgkmcnt(6)
    v_mfma_f32_16x16x32_bf16 v[124:127], a[148:151], v[92:95], v[124:127]
    ds_read_b128 a[140:143], v4 offset:28672
    v_mfma_f32_16x16x32_bf16 v[128:131], a[152:155], v[92:95], v[128:131]
    ds_read_b128 a[144:147], v4 offset:29696
    s_waitcnt lgkmcnt(6)
    v_mfma_f32_16x16x32_bf16 v[116:119], a[156:159], v[96:99], v[116:119]
    ds_read_b128 a[148:151], v4 offset:31744
    v_mfma_f32_16x16x32_bf16 v[120:123], a[160:163], v[96:99], v[120:123]
    ds_read_b128 a[152:155], v4 offset:32768
    s_waitcnt lgkmcnt(6)
    v_mfma_f32_16x16x32_bf16 v[124:127], a[164:167], v[96:99], v[124:127]
    ds_read_b128 a[156:159], v4 offset:33792
    v_mfma_f32_16x16x32_bf16 v[128:131], a[168:171], v[96:99], v[128:131]
    ds_read_b128 a[160:163], v4 offset:34816
    s_waitcnt lgkmcnt(6)
    v_mfma_f32_16x16x32_bf16 v[116:119], a[172:175], v[100:103], v[116:119]
    ds_read_b128 a[164:167], v4 offset:36864
    v_mfma_f32_16x16x32_bf16 v[120:123], a[176:179], v[100:103], v[120:123]
    ds_read_b128 a[168:171], v4 offset:37888
    s_waitcnt lgkmcnt(6)
    v_mfma_f32_16x16x32_bf16 v[124:127], a[140:143], v[100:103], v[124:127]
    ds_read_b128 a[172:175], v4 offset:38912
    buffer_load_dword v141, v142, s[40:43], s56 offen sc1
    v_mfma_f32_16x16x32_bf16 v[128:131], a[144:147], v[100:103], v[128:131]
    ds_read_b128 a[176:179], v4 offset:39936
    s_waitcnt lgkmcnt(6)
    v_mfma_f32_16x16x32_bf16 v[116:119], a[148:151], v[104:107], v[116:119]
    v_mfma_f32_16x16x32_bf16 v[120:123], a[152:155], v[104:107], v[120:123]
    s_waitcnt lgkmcnt(4)
    v_mfma_f32_16x16x32_bf16 v[124:127], a[156:159], v[104:107], v[124:127]
    v_mfma_f32_16x16x32_bf16 v[128:131], a[160:163], v[104:107], v[128:131]
    s_waitcnt lgkmcnt(2)
    v_mfma_f32_16x16x32_bf16 v[116:119], a[164:167], v[108:111], v[116:119]
    v_mfma_f32_16x16x32_bf16 v[120:123], a[168:171], v[108:111], v[120:123]
    s_waitcnt lgkmcnt(0)
    v_mfma_f32_16x16x32_bf16 v[124:127], a[172:175], v[108:111], v[124:127]
    v_mfma_f32_16x16x32_bf16 v[128:131], a[176:179], v[108:111], v[128:131]
    s_branch L_q_done
L_q_only:
    v_pk_mul_f32 v[176:177], 0, 0
    v_pk_mul_f32 v[178:179], 0, 0
    v_pk_mul_f32 v[180:181], 0, 0
    v_pk_mul_f32 v[182:183], 0, 0
    v_pk_mul_f32 v[184:185], 0, 0
    v_pk_mul_f32 v[186:187], 0, 0
    v_pk_mul_f32 v[188:189], 0, 0
    v_pk_mul_f32 v[190:191], 0, 0
    v_mfma_f32_32x32x16_bf16 a[0:15], v[176:179], v[176:179], 0
    v_mfma_f32_32x32x16_bf16 a[16:31], v[176:179], v[176:179], 0
    v_mfma_f32_32x32x16_bf16 a[32:47], v[176:179], v[176:179], 0
    v_mfma_f32_32x32x16_bf16 a[48:63], v[176:179], v[176:179], 0
    v_accvgpr_read_b32 v18, a208
    v_accvgpr_read_b32 v19, a209
    v_accvgpr_read_b32 v20, a210
    v_accvgpr_read_b32 v144, a211
    v_accvgpr_read_b32 v145, a212
    v_accvgpr_read_b32 v146, a213
    s_mul_i32 s66, s71, 25600
    s_mov_b32 s65, s33
    s_add_u32 s65, s65, s66
    s_add_u32 s65, s65, 8290304
    s_mov_b32 s91, 0
    s_mul_i32 s50, s71, 12800
    s_add_u32 s50, s50, s34
    s_add_u32 s50, s50, 4194304
    s_cmp_eq_u32 s77, 0
    s_cselect_b32 s52, 2, 0
    v_lshrrev_b32 v21, 1, v1
    v_mul_u32_u24 v21, 96, v21
    v_add_u32 v21, v21, v4
    v_add_u32 v21, 1081344, v21
    v_and_b32 v142, 31, v1
    v_lshlrev_b32 v142, 2, v142
    s_max_u32 s53, s52, 1
    buffer_load_dwordx2 v[14:15], v25, s[40:43], s23 offen offset:0 sc1
    buffer_load_dwordx2 v[16:17], v25, s[40:43], s23 offen offset:128 sc1
    buffer_load_dwordx4 v[32:35], v4, s[40:43], s95 offen offset:0 sc1
    buffer_load_dwordx4 v[36:39], v4, s[40:43], s95 offen offset:1024 sc1
    buffer_load_dwordx4 v[40:43], v4, s[40:43], s95 offen offset:2048 sc1
    buffer_load_dwordx4 v[44:47], v4, s[40:43], s95 offen offset:3072 sc1
    s_add_u32 s95, s95, 4096
    buffer_load_dwordx4 v[48:51], v4, s[40:43], s95 offen offset:0 sc1
    buffer_load_dwordx4 v[52:55], v4, s[40:43], s95 offen offset:1024 sc1
    buffer_load_dwordx4 v[56:59], v4, s[40:43], s95 offen offset:2048 sc1
    buffer_load_dwordx4 v[60:63], v4, s[40:43], s95 offen offset:3072 sc1
    s_add_u32 s95, s95, 4096
    ds_read_b128 a[140:143], v5 offset:40960
    ds_read_b128 a[144:147], v5 offset:41984
    ds_read_b128 a[148:151], v5 offset:43008
    ds_read_b128 a[152:155], v5 offset:44032
    ds_read_b128 a[156:159], v5 offset:45056
    ds_read_b128 a[160:163], v5 offset:46080
    ds_read_b128 a[164:167], v5 offset:47104
    ds_read_b128 a[168:171], v5 offset:48128
    s_waitcnt lgkmcnt(6)
    s_waitcnt vmcnt(7)
    v_mfma_f32_16x16x32_bf16 v[112:115], a[140:143], v[32:35], 0
    ds_read_b128 a[172:175], v5 offset:49152
    buffer_load_dwordx4 v[64:67], v4, s[40:43], s95 offen offset:0 sc1
    v_mfma_f32_16x16x32_bf16 v[116:119], a[144:147], v[32:35], 0
    ds_read_b128 a[176:179], v5 offset:50176
    s_waitcnt lgkmcnt(6)
    v_mfma_f32_16x16x32_bf16 v[120:123], a[148:151], v[32:35], 0
    ds_read_b128 a[140:143], v6 offset:0
    v_mfma_f32_16x16x32_bf16 v[124:127], a[152:155], v[32:35], 0
    ds_read_b128 a[144:147], v6 offset:1024
    s_waitcnt lgkmcnt(6)
    v_mfma_f32_16x16x32_bf16 v[128:131], a[156:159], v[32:35], 0
    ds_read_b128 a[148:151], v6 offset:2048
    s_waitcnt vmcnt(7)
    v_mfma_f32_16x16x32_bf16 v[112:115], a[160:163], v[36:39], v[112:115]
    ds_read_b128 a[152:155], v6 offset:3072
    buffer_load_dwordx4 v[68:71], v4, s[40:43], s95 offen offset:1024 sc1
    s_waitcnt lgkmcnt(6)
    v_mfma_f32_16x16x32_bf16 v[116:119], a[164:167], v[36:39], v[116:119]
    ds_read_b128 a[156:159], v6 offset:4096
    v_mfma_f32_16x16x32_bf16 v[120:123], a[168:171], v[36:39], v[120:123]
    ds_read_b128 a[160:163], v6 offset:5120
    s_waitcnt lgkmcnt(6)
    v_mfma_f32_16x16x32_bf16 v[124:127], a[172:175], v[36:39], v[124:127]
    ds_read_b128 a[164:167], v6 offset:6144
    v_mfma_f32_16x16x32_bf16 v[128:131], a[176:179], v[36:39], v[128:131]
    ds_read_b128 a[168:171], v6 offset:7168
    s_waitcnt lgkmcnt(6)
    s_waitcnt vmcnt(7)
    v_mfma_f32_16x16x32_bf16 v[112:115], a[140:143], v[40:43], v[112:115]
    ds_read_b128 a[172:175], v6 offset:8192
    buffer_load_dwordx4 v[72:75], v4, s[40:43], s95 offen offset:2048 sc1
    v_mfma_f32_16x16x32_bf16 v[116:119], a[144:147], v[40:43], v[116:119]
    ds_read_b128 a[176:179], v6 offset:9216
    s_waitcnt lgkmcnt(6)
    v_mfma_f32_16x16x32_bf16 v[120:123], a[148:151], v[40:43], v[120:123]
    ds_read_b128 a[140:143], v6 offset:10240
    v_mfma_f32_16x16x32_bf16 v[124:127], a[152:155], v[40:43], v[124:127]
    ds_read_b128 a[144:147], v6 offset:11264
    s_waitcnt lgkmcnt(6)
    v_mfma_f32_16x16x32_bf16 v[128:131], a[156:159], v[40:43], v[128:131]
    ds_read_b128 a[148:151], v6 offset:12288
    s_waitcnt vmcnt(7)
    v_mfma_f32_16x16x32_bf16 v[112:115], a[160:163], v[44:47], v[112:115]
    ds_read_b128 a[152:155], v6 offset:13312
    buffer_load_dwordx4 v[76:79], v4, s[40:43], s95 offen offset:3072 sc1
    s_add_u32 s95, s95, 4096
    s_waitcnt lgkmcnt(6)
    v_mfma_f32_16x16x32_bf16 v[116:119], a[164:167], v[44:47], v[116:119]
    ds_read_b128 a[156:159], v6 offset:14336
    v_mfma_f32_16x16x32_bf16 v[120:123], a[168:171], v[44:47], v[120:123]
    ds_read_b128 a[160:163], v6 offset:15360
    s_waitcnt lgkmcnt(6)
    v_mfma_f32_16x16x32_bf16 v[124:127], a[172:175], v[44:47], v[124:127]
    ds_read_b128 a[164:167], v6 offset:16384
    v_mfma_f32_16x16x32_bf16 v[128:131], a[176:179], v[44:47], v[128:131]
    ds_read_b128 a[168:171], v6 offset:17408
    s_waitcnt lgkmcnt(6)
    s_waitcnt vmcnt(7)
    v_mfma_f32_16x16x32_bf16 v[112:115], a[140:143], v[48:51], v[112:115]
    ds_read_b128 a[172:175], v6 offset:18432
    buffer_load_dwordx4 v[80:83], v4, s[40:43], s95 offen offset:0 sc1
    v_mfma_f32_16x16x32_bf16 v[116:119], a[144:147], v[48:51], v[116:119]
    ds_read_b128 a[176:179], v6 offset:19456
    s_waitcnt lgkmcnt(6)
    v_mfma_f32_16x16x32_bf16 v[120:123], a[148:151], v[48:51], v[120:123]
    ds_read_b128 a[140:143], v6 offset:20480
    v_mfma_f32_16x16x32_bf16 v[124:127], a[152:155], v[48:51], v[124:127]
    ds_read_b128 a[144:147], v6 offset:21504
    s_waitcnt lgkmcnt(6)
    v_mfma_f32_16x16x32_bf16 v[128:131], a[156:159], v[48:51], v[128:131]
    ds_read_b128 a[148:151], v6 offset:22528
    s_waitcnt vmcnt(7)
    v_mfma_f32_16x16x32_bf16 v[112:115], a[160:163], v[52:55], v[112:115]
    ds_read_b128 a[152:155], v6 offset:23552
    buffer_load_dwordx4 v[84:87], v4, s[40:43], s95 offen offset:1024 sc1
    s_waitcnt lgkmcnt(6)
    v_mfma_f32_16x16x32_bf16 v[116:119], a[164:167], v[52:55], v[116:119]
    ds_read_b128 a[156:159], v6 offset:24576
    v_mfma_f32_16x16x32_bf16 v[120:123], a[168:171], v[52:55], v[120:123]
    ds_read_b128 a[160:163], v6 offset:25600
    s_waitcnt lgkmcnt(6)
    v_mfma_f32_16x16x32_bf16 v[124:127], a[172:175], v[52:55], v[124:127]
    ds_read_b128 a[164:167], v6 offset:26624
    v_mfma_f32_16x16x32_bf16 v[128:131], a[176:179], v[52:55], v[128:131]
    ds_read_b128 a[168:171], v6 offset:27648
    s_waitcnt lgkmcnt(6)
    s_waitcnt vmcnt(7)
    v_mfma_f32_16x16x32_bf16 v[112:115], a[140:143], v[56:59], v[112:115]
    ds_read_b128 a[172:175], v6 offset:28672
    buffer_load_dwordx4 v[88:91], v4, s[40:43], s95 offen offset:2048 sc1
    v_mfma_f32_16x16x32_bf16 v[116:119], a[144:147], v[56:59], v[116:119]
    ds_read_b128 a[176:179], v6 offset:29696
    v_add_f32 v14, v14, v16
    s_waitcnt lgkmcnt(6)
    v_mfma_f32_16x16x32_bf16 v[120:123], a[148:151], v[56:59], v[120:123]
    ds_read_b128 a[140:143], v6 offset:30720
    v_add_f32 v15, v15, v17
    v_mfma_f32_16x16x32_bf16 v[124:127], a[152:155], v[56:59], v[124:127]
    ds_read_b128 a[144:147], v6 offset:31744
    s_waitcnt lgkmcnt(6)
    v_mfma_f32_16x16x32_bf16 v[128:131], a[156:159], v[56:59], v[128:131]
    ds_read_b128 a[148:151], v6 offset:32768
    v_mov_b32 v24, v14
    s_waitcnt vmcnt(7)
    v_mfma_f32_16x16x32_bf16 v[112:115], a[160:163], v[60:63], v[112:115]
    ds_read_b128 a[152:155], v6 offset:33792
    buffer_load_dwordx4 v[92:95], v4, s[40:43], s95 offen offset:3072 sc1
    s_add_u32 s95, s95, 4096
    s_waitcnt lgkmcnt(6)
    v_mfma_f32_16x16x32_bf16 v[116:119], a[164:167], v[60:63], v[116:119]
    ds_read_b128 a[156:159], v6 offset:34816
    v_mov_b32 v25, v15
    v_mfma_f32_16x16x32_bf16 v[120:123], a[168:171], v[60:63], v[120:123]
    ds_read_b128 a[160:163], v6 offset:35840
    s_waitcnt lgkmcnt(6)
    v_mfma_f32_16x16x32_bf16 v[124:127], a[172:175], v[60:63], v[124:127]
    ds_read_b128 a[164:167], v6 offset:36864
    v_permlane16_swap_b32 v14, v24
    v_mfma_f32_16x16x32_bf16 v[128:131], a[176:179], v[60:63], v[128:131]
    ds_read_b128 a[168:171], v6 offset:37888
    s_waitcnt lgkmcnt(6)
    s_waitcnt vmcnt(7)
    v_mfma_f32_16x16x32_bf16 v[112:115], a[140:143], v[64:67], v[112:115]
    ds_read_b128 a[172:175], v6 offset:38912
    buffer_load_dwordx4 v[96:99], v4, s[40:43], s95 offen offset:0 sc1
    v_mfma_f32_16x16x32_bf16 v[116:119], a[144:147], v[64:67], v[116:119]
    ds_read_b128 a[176:179], v6 offset:39936
    v_permlane16_swap_b32 v15, v25
    s_waitcnt lgkmcnt(6)
    v_mfma_f32_16x16x32_bf16 v[120:123], a[148:151], v[64:67], v[120:123]
    ds_read_b128 a[140:143], v6 offset:40960
    v_add_f32 v14, v14, v24
    v_mfma_f32_16x16x32_bf16 v[124:127], a[152:155], v[64:67], v[124:127]
    ds_read_b128 a[144:147], v6 offset:41984
    s_waitcnt lgkmcnt(6)
    v_mfma_f32_16x16x32_bf16 v[128:131], a[156:159], v[64:67], v[128:131]
    ds_read_b128 a[148:151], v6 offset:43008
    v_add_f32 v15, v15, v25
    s_waitcnt vmcnt(7)
    v_mfma_f32_16x16x32_bf16 v[112:115], a[160:163], v[68:71], v[112:115]
    ds_read_b128 a[152:155], v6 offset:44032
    buffer_load_dwordx4 v[100:103], v4, s[40:43], s95 offen offset:1024 sc1
    s_waitcnt lgkmcnt(6)
    v_mfma_f32_16x16x32_bf16 v[116:119], a[164:167], v[68:71], v[116:119]
    ds_read_b128 a[156:159], v6 offset:45056
    v_mov_b32 v24, v14
    v_mfma_f32_16x16x32_bf16 v[120:123], a[168:171], v[68:71], v[120:123]
    ds_read_b128 a[160:163], v6 offset:46080
    s_waitcnt lgkmcnt(6)
    v_mfma_f32_16x16x32_bf16 v[124:127], a[172:175], v[68:71], v[124:127]
    ds_read_b128 a[164:167], v6 offset:47104
    v_mov_b32 v25, v15
    v_mfma_f32_16x16x32_bf16 v[128:131], a[176:179], v[68:71], v[128:131]
    ds_read_b128 a[168:171], v6 offset:48128
    s_waitcnt lgkmcnt(6)
    s_waitcnt vmcnt(7)
    v_mfma_f32_16x16x32_bf16 v[112:115], a[140:143], v[72:75], v[112:115]
    ds_read_b128 a[172:175], v6 offset:49152
    buffer_load_dwordx4 v[104:107], v4, s[40:43], s95 offen offset:2048 sc1
    v_mfma_f32_16x16x32_bf16 v[116:119], a[144:147], v[72:75], v[116:119]
    ds_read_b128 a[176:179], v6 offset:50176
    v_permlane32_swap_b32 v14, v24
    s_waitcnt lgkmcnt(6)
    v_mfma_f32_16x16x32_bf16 v[120:123], a[148:151], v[72:75], v[120:123]
    ds_read_b128 a[140:143], v4 offset:0
    v_permlane32_swap_b32 v15, v25
    v_mfma_f32_16x16x32_bf16 v[124:127], a[152:155], v[72:75], v[124:127]
    ds_read_b128 a[144:147], v4 offset:1024
    s_waitcnt lgkmcnt(6)
    v_mfma_f32_16x16x32_bf16 v[128:131], a[156:159], v[72:75], v[128:131]
    ds_read_b128 a[148:151], v4 offset:2048
    v_add_f32 v14, v14, v24
    s_waitcnt vmcnt(7)
    v_mfma_f32_16x16x32_bf16 v[112:115], a[160:163], v[76:79], v[112:115]
    ds_read_b128 a[152:155], v4 offset:3072
    buffer_load_dwordx4 v[108:111], v4, s[40:43], s95 offen offset:3072 sc1
    s_waitcnt lgkmcnt(6)
    v_mfma_f32_16x16x32_bf16 v[116:119], a[164:167], v[76:79], v[116:119]
    ds_read_b128 a[156:159], v4 offset:4096
    v_add_f32 v15, v15, v25
    v_mfma_f32_16x16x32_bf16 v[120:123], a[168:171], v[76:79], v[120:123]
    ds_read_b128 a[160:163], v4 offset:5120
    s_waitcnt lgkmcnt(6)
    v_mfma_f32_16x16x32_bf16 v[124:127], a[172:175], v[76:79], v[124:127]
    ds_read_b128 a[164:167], v4 offset:6144
    v_mul_f32 v24, 0xbacccccd, v14
    v_mfma_f32_16x16x32_bf16 v[128:131], a[176:179], v[76:79], v[128:131]
    ds_read_b128 a[168:171], v4 offset:7168
    s_waitcnt lgkmcnt(6)
    s_waitcnt vmcnt(7)
    v_mfma_f32_16x16x32_bf16 v[112:115], a[140:143], v[80:83], v[112:115]
    ds_read_b128 a[172:175], v4 offset:8192
    v_mul_f32 v15, 0x3acccccd, v15
    v_mfma_f32_16x16x32_bf16 v[116:119], a[144:147], v[80:83], v[116:119]
    ds_read_b128 a[176:179], v4 offset:9216
    s_waitcnt lgkmcnt(6)
    v_mfma_f32_16x16x32_bf16 v[120:123], a[148:151], v[80:83], v[120:123]
    ds_read_b128 a[140:143], v4 offset:10240
    v_fma_f32 v15, -v24, v24, v15
    v_mfma_f32_16x16x32_bf16 v[124:127], a[152:155], v[80:83], v[124:127]
    ds_read_b128 a[144:147], v4 offset:11264
    s_waitcnt lgkmcnt(6)
    v_mfma_f32_16x16x32_bf16 v[128:131], a[156:159], v[80:83], v[128:131]
    ds_read_b128 a[148:151], v4 offset:12288
    v_max_f32 v15, 0, v15
    s_waitcnt vmcnt(6)
    v_mfma_f32_16x16x32_bf16 v[112:115], a[160:163], v[84:87], v[112:115]
    ds_read_b128 a[152:155], v4 offset:13312
    s_waitcnt lgkmcnt(6)
    v_mfma_f32_16x16x32_bf16 v[116:119], a[164:167], v[84:87], v[116:119]
    ds_read_b128 a[156:159], v4 offset:14336
    v_add_f32 v15, 0x3727c5ac, v15
    v_mfma_f32_16x16x32_bf16 v[120:123], a[168:171], v[84:87], v[120:123]
    ds_read_b128 a[160:163], v4 offset:15360
    s_waitcnt lgkmcnt(6)
    v_mfma_f32_16x16x32_bf16 v[124:127], a[172:175], v[84:87], v[124:127]
    ds_read_b128 a[164:167], v4 offset:16384
    v_cvt_pk_bf16_f32 v25, v24, v24
    v_mfma_f32_16x16x32_bf16 v[128:131], a[176:179], v[84:87], v[128:131]
    ds_read_b128 a[168:171], v4 offset:17408
    s_waitcnt lgkmcnt(6)
    s_waitcnt vmcnt(5)
    v_mfma_f32_16x16x32_bf16 v[112:115], a[140:143], v[88:91], v[112:115]
    ds_read_b128 a[172:175], v4 offset:18432
    v_rsq_f32 v12, v15
    v_mfma_f32_16x16x32_bf16 v[116:119], a[144:147], v[88:91], v[116:119]
    ds_read_b128 a[176:179], v4 offset:19456
    s_waitcnt lgkmcnt(6)
    v_mfma_f32_16x16x32_bf16 v[120:123], a[148:151], v[88:91], v[120:123]
    ds_read_b128 a[140:143], v4 offset:20480
    v_and_b32 v25, 0xffff0000, v25
    v_mfma_f32_16x16x32_bf16 v[124:127], a[152:155], v[88:91], v[124:127]
    ds_read_b128 a[144:147], v4 offset:21504
    s_waitcnt lgkmcnt(6)
    v_mfma_f32_16x16x32_bf16 v[128:131], a[156:159], v[88:91], v[128:131]
    ds_read_b128 a[148:151], v4 offset:22528
    v_sub_f32 v26, v24, v25
    s_waitcnt vmcnt(4)
    v_mfma_f32_16x16x32_bf16 v[112:115], a[160:163], v[92:95], v[112:115]
    ds_read_b128 a[152:155], v4 offset:23552
    s_waitcnt lgkmcnt(6)
    v_mfma_f32_16x16x32_bf16 v[116:119], a[164:167], v[92:95], v[116:119]
    ds_read_b128 a[156:159], v4 offset:24576
    v_cvt_pk_bf16_f32 v27, v25, v26
    v_mfma_f32_16x16x32_bf16 v[120:123], a[168:171], v[92:95], v[120:123]
    ds_read_b128 a[160:163], v4 offset:25600
    s_waitcnt lgkmcnt(6)
    v_mfma_f32_16x16x32_bf16 v[124:127], a[172:175], v[92:95], v[124:127]
    ds_read_b128 a[164:167], v4 offset:26624
    v_lshrrev_b32 v25, 16, v25
    v_mfma_f32_16x16x32_bf16 v[128:131], a[176:179], v[92:95], v[128:131]
    ds_read_b128 a[168:171], v4 offset:27648
    s_waitcnt lgkmcnt(6)
    s_waitcnt vmcnt(3)
    v_mfma_f32_16x16x32_bf16 v[112:115], a[140:143], v[96:99], v[112:115]
    ds_read_b128 a[172:175], v4 offset:28672
    v_accvgpr_write_b32 a180, v27
    v_mfma_f32_16x16x32_bf16 v[116:119], a[144:147], v[96:99], v[116:119]
    ds_read_b128 a[176:179], v4 offset:29696
    s_waitcnt lgkmcnt(6)
    v_mfma_f32_16x16x32_bf16 v[120:123], a[148:151], v[96:99], v[120:123]
    ds_read_b128 a[140:143], v4 offset:30720
    v_accvgpr_write_b32 a181, v25
    v_mfma_f32_16x16x32_bf16 v[124:127], a[152:155], v[96:99], v[124:127]
    ds_read_b128 a[144:147], v4 offset:31744
    s_waitcnt lgkmcnt(6)
    v_mfma_f32_16x16x32_bf16 v[128:131], a[156:159], v[96:99], v[128:131]
    ds_read_b128 a[148:151], v4 offset:32768
    v_accvgpr_write_b32 a182, 0
    s_waitcnt vmcnt(2)
    v_mfma_f32_16x16x32_bf16 v[112:115], a[160:163], v[100:103], v[112:115]
    ds_read_b128 a[152:155], v4 offset:33792
    s_waitcnt lgkmcnt(6)
    v_mfma_f32_16x16x32_bf16 v[116:119], a[164:167], v[100:103], v[116:119]
    ds_read_b128 a[156:159], v4 offset:34816
    v_accvgpr_write_b32 a183, 0
    v_mfma_f32_16x16x32_bf16 v[120:123], a[168:171], v[100:103], v[120:123]
    ds_read_b128 a[160:163], v4 offset:35840
    s_waitcnt lgkmcnt(6)
    v_mfma_f32_16x16x32_bf16 v[124:127], a[172:175], v[100:103], v[124:127]
    ds_read_b128 a[164:167], v4 offset:36864
    v_mfma_f32_16x16x32_bf16 v[128:131], a[176:179], v[100:103], v[128:131]
    ds_read_b128 a[168:171], v4 offset:37888
    s_waitcnt lgkmcnt(6)
    s_waitcnt vmcnt(1)
    v_mfma_f32_16x16x32_bf16 v[112:115], a[140:143], v[104:107], v[112:115]
    ds_read_b128 a[172:175], v4 offset:38912
    buffer_load_dword v141, v142, s[40:43], s56 offen sc1
    v_mfma_f32_16x16x32_bf16 v[116:119], a[144:147], v[104:107], v[116:119]
    ds_read_b128 a[176:179], v4 offset:39936
    s_waitcnt lgkmcnt(6)
    v_mfma_f32_16x16x32_bf16 v[120:123], a[148:151], v[104:107], v[120:123]
    v_mfma_f32_16x16x32_bf16 v[124:127], a[152:155], v[104:107], v[124:127]
    s_waitcnt lgkmcnt(4)
    v_mfma_f32_16x16x32_bf16 v[128:131], a[156:159], v[104:107], v[128:131]
    s_waitcnt vmcnt(1)
    v_mfma_f32_16x16x32_bf16 v[112:115], a[160:163], v[108:111], v[112:115]
    s_waitcnt lgkmcnt(2)
    v_mfma_f32_16x16x32_bf16 v[116:119], a[164:167], v[108:111], v[116:119]
    v_mfma_f32_16x16x32_bf16 v[120:123], a[168:171], v[108:111], v[120:123]
    s_waitcnt lgkmcnt(0)
    v_mfma_f32_16x16x32_bf16 v[124:127], a[172:175], v[108:111], v[124:127]
    v_mfma_f32_16x16x32_bf16 v[128:131], a[176:179], v[108:111], v[128:131]
L_q_done:
    v_mfma_f32_16x16x32_bf16 v[112:115], a[184:187], a[180:183], v[112:115]
    v_mfma_f32_16x16x32_bf16 v[116:119], a[186:189], a[180:183], v[116:119]
    v_mfma_f32_16x16x32_bf16 v[120:123], a[188:191], a[180:183], v[120:123]
    v_mfma_f32_16x16x32_bf16 v[124:127], a[190:193], a[180:183], v[124:127]
    v_mfma_f32_16x16x32_bf16 v[128:131], a[192:195], a[180:183], v[128:131]
    v_mul_f32 v24, 0x3ea52b5c, v12
    s_mov_b32 s96, s72
    s_lshl_b32 s58, s96, 13
    s_lshl_b32 s59, s96, 11
    s_lshl_b32 s60, s96, 14
    s_add_u32 s58, s58, 3407872
    s_add_u32 s59, s59, 3407872
    s_add_u32 s60, s60, 3407872
    s_add_u32 s61, s60, 4096
    s_add_u32 s96, s96, 1
    s_and_b32 s96, s96, 7
    s_mov_b32 s48, 0
L_l2:
    s_waitcnt vmcnt(0)
    v_cmp_ne_u32 vcc, s78, v141
    s_cbranch_vccz L_l2e
    s_sleep 1
    buffer_load_dword v141, v142, s[40:43], s56 offen sc1
    s_add_u32 s48, s48, 1
    s_cmp_lt_u32 s48, 0x20000
    s_cbranch_scc1 L_l2
L_l2e:
    buffer_load_dwordx4 a[100:103], v19, s[40:43], s59 offen offset:0 sc1
    buffer_load_dwordx4 a[104:107], v19, s[40:43], s59 offen offset:512 sc1
    buffer_load_dwordx4 a[84:87], v18, s[40:43], s58 offen offset:0 sc1
    buffer_load_dwordx4 a[88:91], v18, s[40:43], s58 offen offset:1024 sc1
    v_pk_mul_f32 v[112:113], v[112:113], v[24:25] op_sel_hi:[1,0]
    v_pk_mul_f32 v[114:115], v[114:115], v[24:25] op_sel_hi:[1,0]
    v_cvt_pk_bf16_f32 v112, v112, v113
    v_cvt_pk_bf16_f32 v113, v114, v115
    ds_write_b64 v146, v[112:113] offset:0
    buffer_load_dwordx4 a[92:95], v18, s[40:43], s58 offen offset:2048 sc1
    v_pk_mul_f32 v[116:117], v[116:117], v[24:25] op_sel_hi:[1,0]
    v_pk_mul_f32 v[118:119], v[118:119], v[24:25] op_sel_hi:[1,0]
    v_cvt_pk_bf16_f32 v116, v116, v117
    v_cvt_pk_bf16_f32 v117, v118, v119
    ds_write_b64 v146, v[116:117] offset:32
    buffer_load_dwordx4 a[96:99], v18, s[40:43], s58 offen offset:3072 sc1
    v_pk_mul_f32 v[120:121], v[120:121], v[24:25] op_sel_hi:[1,0]
    v_pk_mul_f32 v[122:123], v[122:123], v[24:25] op_sel_hi:[1,0]
    v_cvt_pk_bf16_f32 v120, v120, v121
    v_cvt_pk_bf16_f32 v121, v122, v123
    ds_write_b64 v146, v[120:121] offset:64
    buffer_load_dwordx4 a[108:111], v20, s[40:43], s60 offen offset:0 sc1
    v_pk_mul_f32 v[124:125], v[124:125], v[24:25] op_sel_hi:[1,0]
    v_pk_mul_f32 v[126:127], v[126:127], v[24:25] op_sel_hi:[1,0]
    v_cvt_pk_bf16_f32 v124, v124, v125
    v_cvt_pk_bf16_f32 v125, v126, v127
    ds_write_b64 v146, v[124:125] offset:96
    buffer_load_dwordx4 a[112:115], v20, s[40:43], s60 offen offset:1024 sc1
    v_pk_mul_f32 v[128:129], v[128:129], v[24:25] op_sel_hi:[1,0]
    v_pk_mul_f32 v[130:131], v[130:131], v[24:25] op_sel_hi:[1,0]
    v_cvt_pk_bf16_f32 v128, v128, v129
    v_cvt_pk_bf16_f32 v129, v130, v131
    ds_write_b64 v146, v[128:129] offset:128
    s_waitcnt lgkmcnt(0)
    s_barrier
    ds_read_b64 a[80:81], v145 offset:32
    ds_read_b64 a[82:83], v145 offset:112
    ds_read_b64 a[64:65], v144 offset:0
    ds_read_b64 a[66:67], v144 offset:8
    ds_read_b64 a[68:69], v144 offset:40
    ds_read_b64 a[70:71], v144 offset:48
    ds_read_b64 a[72:73], v144 offset:80
    ds_read_b64 a[74:75], v144 offset:88
    ds_read_b64 a[76:77], v144 offset:120
    ds_read_b64 a[78:79], v144 offset:128
    v_accvgpr_write_b32 a188, 0
    v_accvgpr_write_b32 a189, 0
    v_accvgpr_write_b32 a190, 0
    v_accvgpr_write_b32 a191, 0
    v_accvgpr_write_b32 a192, 0
    v_accvgpr_write_b32 a193, 0
    v_accvgpr_write_b32 a194, 0
    v_accvgpr_write_b32 a195, 0
    s_add_u32 m0, s66, 24576
    s_add_u32 s57, s65, 24576
    s_mov_b32 s95, 0
    s_waitcnt vmcnt(5) lgkmcnt(0)
    v_mfma_f32_32x32x4_2b_bf16 v[32:63], a[100:101], a[80:81], 0
    buffer_load_dwordx4 a[116:119], v20, s[40:43], s60 offen offset:2048 sc1
    buffer_load_dwordx4 a[120:123], v20, s[40:43], s60 offen offset:3072 sc1
    buffer_load_dwordx4 a[124:127], v20, s[40:43], s61 offen offset:0 sc1
    buffer_load_dwordx4 a[128:131], v20, s[40:43], s61 offen offset:1024 sc1
    buffer_load_dwordx4 a[132:135], v20, s[40:43], s61 offen offset:2048 sc1
    buffer_load_dwordx4 a[136:139], v20, s[40:43], s61 offen offset:3072 sc1
    buffer_load_dwordx4 v4, s[40:43], s57 offen lds
    s_nop 10
    v_mfma_f32_32x32x16_bf16 v[32:47], a[84:87], a[64:67], v[32:47]
    v_mfma_f32_32x32x16_bf16 v[48:63], a[84:87], a[68:71], v[48:63]
    s_waitcnt vmcnt(9)
    s_nop 9
.p2align 6
L_att_loop:
    v_mfma_f32_32x32x4_2b_bf16 v[64:95], a[100:101], a[82:83], 0
    s_lshl_b32 s58, s96, 13
    v_exp_f32 v32, v32
    v_exp_f32 v33, v33
    v_exp_f32 v34, v34
    v_exp_f32 v35, v35
    v_exp_f32 v36, v36
    v_exp_f32 v37, v37
    v_exp_f32 v38, v38
    v_exp_f32 v39, v39
    v_cvt_pk_bf16_f32 v96, v32, v33
    v_cvt_pk_bf16_f32 v97, v34, v35
    v_cvt_pk_bf16_f32 v98, v36, v37
    v_cvt_pk_bf16_f32 v99, v38, v39
    v_mfma_f32_32x32x16_bf16 a[32:47], a[188:191], v[176:179], a[32:47]
    s_lshl_b32 s59, s96, 11
    v_exp_f32 v40, v40
    v_exp_f32 v41, v41
    v_exp_f32 v42, v42
    v_exp_f32 v43, v43
    v_cvt_pk_bf16_f32 v100, v40, v41
    v_cvt_pk_bf16_f32 v101, v42, v43
    v_mfma_f32_32x32x16_bf16 a[48:63], a[188:191], v[184:187], a[48:63]
    s_lshl_b32 s60, s96, 14
    v_exp_f32 v44, v44
    v_exp_f32 v45, v45
    v_exp_f32 v46, v46
    v_exp_f32 v47, v47
    v_cvt_pk_bf16_f32 v102, v44, v45
    v_cvt_pk_bf16_f32 v103, v46, v47
    v_mfma_f32_32x32x16_bf16 v[64:79], a[84:87], a[72:75], v[64:79]
    s_add_u32 s58, s58, s92
    v_exp_f32 v48, v48
    v_exp_f32 v49, v49
    v_exp_f32 v50, v50
    v_exp_f32 v51, v51
    v_cvt_pk_bf16_f32 v104, v48, v49
    v_cvt_pk_bf16_f32 v105, v50, v51
    v_mfma_f32_32x32x16_bf16 a[32:47], a[192:195], v[180:183], a[32:47]
    s_add_u32 s59, s59, s92
    v_exp_f32 v52, v52
    v_exp_f32 v53, v53
    v_exp_f32 v54, v54
    v_exp_f32 v55, v55
    v_cvt_pk_bf16_f32 v106, v52, v53
    v_cvt_pk_bf16_f32 v107, v54, v55
    v_mfma_f32_32x32x16_bf16 v[80:95], a[84:87], a[76:79], v[80:95]
    s_add_u32 s60, s60, s92
    v_exp_f32 v56, v56
    v_exp_f32 v57, v57
    v_exp_f32 v58, v58
    v_exp_f32 v59, v59
    v_cvt_pk_bf16_f32 v108, v56, v57
    v_cvt_pk_bf16_f32 v109, v58, v59
    v_mfma_f32_32x32x16_bf16 a[48:63], a[192:195], v[188:191], a[48:63]
    s_add_u32 s61, s60, 4096
    s_cmp_lt_u32 s95, s53
    v_exp_f32 v60, v60
    v_exp_f32 v61, v61
    v_exp_f32 v62, v62
    v_exp_f32 v63, v63
    v_cvt_pk_bf16_f32 v110, v60, v61
    v_cvt_pk_bf16_f32 v111, v62, v63
    v_mfma_f32_32x32x4_2b_bf16 v[32:63], a[102:103], a[80:81], 0
    s_waitcnt vmcnt(0)
    s_cbranch_scc1 L_stg0
L_stgb0:
    v_exp_f32 v64, v64
    v_exp_f32 v65, v65
    v_exp_f32 v66, v66
    v_exp_f32 v67, v67
    v_exp_f32 v68, v68
    v_exp_f32 v69, v69
    v_exp_f32 v70, v70
    v_exp_f32 v71, v71
    v_cvt_pk_bf16_f32 v176, v64, v65
    v_cvt_pk_bf16_f32 v177, v66, v67
    v_cvt_pk_bf16_f32 v178, v68, v69
    v_cvt_pk_bf16_f32 v179, v70, v71
    v_mfma_f32_32x32x16_bf16 a[0:15], a[108:111], v[96:99], a[0:15]
    v_exp_f32 v72, v72
    v_exp_f32 v73, v73
    v_exp_f32 v74, v74
    v_exp_f32 v75, v75
    v_cvt_pk_bf16_f32 v180, v72, v73
    v_cvt_pk_bf16_f32 v181, v74, v75
    v_mfma_f32_32x32x16_bf16 a[16:31], a[108:111], v[104:107], a[16:31]
    s_mov_b32 m0, s66
    v_exp_f32 v76, v76
    v_exp_f32 v77, v77
    v_exp_f32 v78, v78
    v_exp_f32 v79, v79
    v_cvt_pk_bf16_f32 v182, v76, v77
    v_cvt_pk_bf16_f32 v183, v78, v79
    v_mfma_f32_32x32x16_bf16 v[32:47], a[88:91], a[64:67], v[32:47]
    v_exp_f32 v80, v80
    v_exp_f32 v81, v81
    v_exp_f32 v82, v82
    v_exp_f32 v83, v83
    v_cvt_pk_bf16_f32 v184, v80, v81
    v_cvt_pk_bf16_f32 v185, v82, v83
    v_mfma_f32_32x32x16_bf16 a[0:15], a[112:115], v[100:103], a[0:15]
    v_exp_f32 v84, v84
    v_exp_f32 v85, v85
    v_exp_f32 v86, v86
    v_exp_f32 v87, v87
    v_cvt_pk_bf16_f32 v186, v84, v85
    v_cvt_pk_bf16_f32 v187, v86, v87
    v_mfma_f32_32x32x16_bf16 v[48:63], a[88:91], a[68:71], v[48:63]
    v_exp_f32 v88, v88
    v_exp_f32 v89, v89
    v_exp_f32 v90, v90
    v_exp_f32 v91, v91
    v_cvt_pk_bf16_f32 v188, v88, v89
    v_cvt_pk_bf16_f32 v189, v90, v91
    v_mfma_f32_32x32x16_bf16 a[16:31], a[112:115], v[108:111], a[16:31]
    v_exp_f32 v92, v92
    v_exp_f32 v93, v93
    v_exp_f32 v94, v94
    v_exp_f32 v95, v95
    v_cvt_pk_bf16_f32 v190, v92, v93
    v_cvt_pk_bf16_f32 v191, v94, v95
    v_mfma_f32_32x32x4_2b_bf16 v[64:95], a[102:103], a[82:83], 0
    v_exp_f32 v32, v32
    v_exp_f32 v33, v33
    v_exp_f32 v34, v34
    v_exp_f32 v35, v35
    v_exp_f32 v36, v36
    v_exp_f32 v37, v37
    v_exp_f32 v38, v38
    v_exp_f32 v39, v39
    v_cvt_pk_bf16_f32 v96, v32, v33
    v_cvt_pk_bf16_f32 v97, v34, v35
    v_cvt_pk_bf16_f32 v98, v36, v37
    v_cvt_pk_bf16_f32 v99, v38, v39
    v_mfma_f32_32x32x16_bf16 a[32:47], a[108:111], v[176:179], a[32:47]
    v_exp_f32 v40, v40
    v_exp_f32 v41, v41
    v_exp_f32 v42, v42
    v_exp_f32 v43, v43
    v_cvt_pk_bf16_f32 v100, v40, v41
    v_cvt_pk_bf16_f32 v101, v42, v43
    v_mfma_f32_32x32x16_bf16 a[48:63], a[108:111], v[184:187], a[48:63]
    v_exp_f32 v44, v44
    v_exp_f32 v45, v45
    v_exp_f32 v46, v46
    v_exp_f32 v47, v47
    v_cvt_pk_bf16_f32 v102, v44, v45
    v_cvt_pk_bf16_f32 v103, v46, v47
    v_mfma_f32_32x32x16_bf16 v[64:79], a[88:91], a[72:75], v[64:79]
    v_exp_f32 v48, v48
    v_exp_f32 v49, v49
    v_exp_f32 v50, v50
    v_exp_f32 v51, v51
    v_cvt_pk_bf16_f32 v104, v48, v49
    v_cvt_pk_bf16_f32 v105, v50, v51
    v_mfma_f32_32x32x16_bf16 a[32:47], a[112:115], v[180:183], a[32:47]
    v_exp_f32 v52, v52
    v_exp_f32 v53, v53
    v_exp_f32 v54, v54
    v_exp_f32 v55, v55
    v_cvt_pk_bf16_f32 v106, v52, v53
    v_cvt_pk_bf16_f32 v107, v54, v55
    v_mfma_f32_32x32x16_bf16 v[80:95], a[88:91], a[76:79], v[80:95]
    v_exp_f32 v56, v56
    v_exp_f32 v57, v57
    v_exp_f32 v58, v58
    v_exp_f32 v59, v59
    v_cvt_pk_bf16_f32 v108, v56, v57
    v_cvt_pk_bf16_f32 v109, v58, v59
    v_mfma_f32_32x32x16_bf16 a[48:63], a[112:115], v[188:191], a[48:63]
    s_cmp_eq_u32 s95, 0
    v_exp_f32 v60, v60
    v_exp_f32 v61, v61
    v_exp_f32 v62, v62
    v_exp_f32 v63, v63
    v_cvt_pk_bf16_f32 v110, v60, v61
    v_cvt_pk_bf16_f32 v111, v62, v63
    v_mfma_f32_32x32x4_2b_bf16 v[32:63], a[104:105], a[80:81], 0
    s_cbranch_scc1 L_g2chk
L_g2back:
    v_exp_f32 v64, v64
    v_exp_f32 v65, v65
    v_exp_f32 v66, v66
    v_exp_f32 v67, v67
    v_exp_f32 v68, v68
    v_exp_f32 v69, v69
    v_exp_f32 v70, v70
    v_exp_f32 v71, v71
    v_cvt_pk_bf16_f32 v176, v64, v65
    v_cvt_pk_bf16_f32 v177, v66, v67
    v_cvt_pk_bf16_f32 v178, v68, v69
    v_cvt_pk_bf16_f32 v179, v70, v71
    v_mfma_f32_32x32x16_bf16 a[0:15], a[116:119], v[96:99], a[0:15]
    buffer_load_dwordx4 a[156:159], v19, s[40:43], s59 offen offset:0
    buffer_load_dwordx4 a[160:163], v19, s[40:43], s59 offen offset:512
    buffer_load_dwordx4 a[140:143], v18, s[40:43], s58 offen offset:0
    buffer_load_dwordx4 a[144:147], v18, s[40:43], s58 offen offset:1024
    buffer_load_dwordx4 a[148:151], v18, s[40:43], s58 offen offset:2048
    buffer_load_dwordx4 a[152:155], v18, s[40:43], s58 offen offset:3072
    v_exp_f32 v72, v72
    v_exp_f32 v73, v73
    v_exp_f32 v74, v74
    v_exp_f32 v75, v75
    v_cvt_pk_bf16_f32 v180, v72, v73
    v_cvt_pk_bf16_f32 v181, v74, v75
    v_mfma_f32_32x32x16_bf16 a[16:31], a[116:119], v[104:107], a[16:31]
    v_exp_f32 v76, v76
    v_exp_f32 v77, v77
    v_exp_f32 v78, v78
    v_exp_f32 v79, v79
    v_cvt_pk_bf16_f32 v182, v76, v77
    v_cvt_pk_bf16_f32 v183, v78, v79
    v_mfma_f32_32x32x16_bf16 v[32:47], a[92:95], a[64:67], v[32:47]
    v_exp_f32 v80, v80
    v_exp_f32 v81, v81
    v_exp_f32 v82, v82
    v_exp_f32 v83, v83
    v_cvt_pk_bf16_f32 v184, v80, v81
    v_cvt_pk_bf16_f32 v185, v82, v83
    v_mfma_f32_32x32x16_bf16 a[0:15], a[120:123], v[100:103], a[0:15]
    v_exp_f32 v84, v84
    v_exp_f32 v85, v85
    v_exp_f32 v86, v86
    v_exp_f32 v87, v87
    v_cvt_pk_bf16_f32 v186, v84, v85
    v_cvt_pk_bf16_f32 v187, v86, v87
    v_mfma_f32_32x32x16_bf16 v[48:63], a[92:95], a[68:71], v[48:63]
    v_exp_f32 v88, v88
    v_exp_f32 v89, v89
    v_exp_f32 v90, v90
    v_exp_f32 v91, v91
    v_cvt_pk_bf16_f32 v188, v88, v89
    v_cvt_pk_bf16_f32 v189, v90, v91
    v_mfma_f32_32x32x16_bf16 a[16:31], a[120:123], v[108:111], a[16:31]
    v_exp_f32 v92, v92
    v_exp_f32 v93, v93
    v_exp_f32 v94, v94
    v_exp_f32 v95, v95
    v_cvt_pk_bf16_f32 v190, v92, v93
    v_cvt_pk_bf16_f32 v191, v94, v95
    v_mfma_f32_32x32x4_2b_bf16 v[64:95], a[104:105], a[82:83], 0
    v_exp_f32 v32, v32
    v_exp_f32 v33, v33
    v_exp_f32 v34, v34
    v_exp_f32 v35, v35
    v_exp_f32 v36, v36
    v_exp_f32 v37, v37
    v_exp_f32 v38, v38
    v_exp_f32 v39, v39
    v_cvt_pk_bf16_f32 v96, v32, v33
    v_cvt_pk_bf16_f32 v97, v34, v35
    v_cvt_pk_bf16_f32 v98, v36, v37
    v_cvt_pk_bf16_f32 v99, v38, v39
    v_mfma_f32_32x32x16_bf16 a[32:47], a[116:119], v[176:179], a[32:47]
    buffer_load_dwordx4 a[164:167], v20, s[40:43], s60 offen offset:0
    buffer_load_dwordx4 a[168:171], v20, s[40:43], s60 offen offset:1024
    buffer_load_dwordx4 a[172:175], v20, s[40:43], s60 offen offset:2048
    buffer_load_dwordx4 a[176:179], v20, s[40:43], s60 offen offset:3072
    v_exp_f32 v40, v40
    v_exp_f32 v41, v41
    v_exp_f32 v42, v42
    v_exp_f32 v43, v43
    v_cvt_pk_bf16_f32 v100, v40, v41
    v_cvt_pk_bf16_f32 v101, v42, v43
    v_mfma_f32_32x32x16_bf16 a[48:63], a[116:119], v[184:187], a[48:63]
    v_exp_f32 v44, v44
    v_exp_f32 v45, v45
    v_exp_f32 v46, v46
    v_exp_f32 v47, v47
    v_cvt_pk_bf16_f32 v102, v44, v45
    v_cvt_pk_bf16_f32 v103, v46, v47
    v_mfma_f32_32x32x16_bf16 v[64:79], a[92:95], a[72:75], v[64:79]
    v_exp_f32 v48, v48
    v_exp_f32 v49, v49
    v_exp_f32 v50, v50
    v_exp_f32 v51, v51
    v_cvt_pk_bf16_f32 v104, v48, v49
    v_cvt_pk_bf16_f32 v105, v50, v51
    v_mfma_f32_32x32x16_bf16 a[32:47], a[120:123], v[180:183], a[32:47]
    v_exp_f32 v52, v52
    v_exp_f32 v53, v53
    v_exp_f32 v54, v54
    v_exp_f32 v55, v55
    v_cvt_pk_bf16_f32 v106, v52, v53
    v_cvt_pk_bf16_f32 v107, v54, v55
    v_mfma_f32_32x32x16_bf16 v[80:95], a[92:95], a[76:79], v[80:95]
    v_exp_f32 v56, v56
    v_exp_f32 v57, v57
    v_exp_f32 v58, v58
    v_exp_f32 v59, v59
    v_cvt_pk_bf16_f32 v108, v56, v57
    v_cvt_pk_bf16_f32 v109, v58, v59
    v_mfma_f32_32x32x16_bf16 a[48:63], a[120:123], v[188:191], a[48:63]
    v_exp_f32 v60, v60
    v_exp_f32 v61, v61
    v_exp_f32 v62, v62
    v_exp_f32 v63, v63
    v_cvt_pk_bf16_f32 v110, v60, v61
    v_cvt_pk_bf16_f32 v111, v62, v63
    v_mfma_f32_32x32x4_2b_bf16 v[32:63], a[106:107], a[80:81], 0
    v_exp_f32 v64, v64
    v_exp_f32 v65, v65
    v_exp_f32 v66, v66
    v_exp_f32 v67, v67
    v_exp_f32 v68, v68
    v_exp_f32 v69, v69
    v_exp_f32 v70, v70
    v_exp_f32 v71, v71
    v_cvt_pk_bf16_f32 v176, v64, v65
    v_cvt_pk_bf16_f32 v177, v66, v67
    v_cvt_pk_bf16_f32 v178, v68, v69
    v_cvt_pk_bf16_f32 v179, v70, v71
    v_mfma_f32_32x32x16_bf16 a[0:15], a[124:127], v[96:99], a[0:15]
    buffer_load_dwordx4 a[180:183], v20, s[40:43], s61 offen offset:0
    buffer_load_dwordx4 a[184:187], v20, s[40:43], s61 offen offset:1024
    buffer_load_dwordx4 a[188:191], v20, s[40:43], s61 offen offset:2048
    buffer_load_dwordx4 a[192:195], v20, s[40:43], s61 offen offset:3072
    buffer_load_dwordx4 v4, s[40:43], s65 offen offset:0 lds
    v_exp_f32 v72, v72
    v_exp_f32 v73, v73
    v_exp_f32 v74, v74
    v_exp_f32 v75, v75
    v_cvt_pk_bf16_f32 v180, v72, v73
    v_cvt_pk_bf16_f32 v181, v74, v75
    v_mfma_f32_32x32x16_bf16 a[16:31], a[124:127], v[104:107], a[16:31]
    v_exp_f32 v76, v76
    v_exp_f32 v77, v77
    v_exp_f32 v78, v78
    v_exp_f32 v79, v79
    v_cvt_pk_bf16_f32 v182, v76, v77
    v_cvt_pk_bf16_f32 v183, v78, v79
    v_mfma_f32_32x32x16_bf16 v[32:47], a[96:99], a[64:67], v[32:47]
    v_exp_f32 v80, v80
    v_exp_f32 v81, v81
    v_exp_f32 v82, v82
    v_exp_f32 v83, v83
    v_cvt_pk_bf16_f32 v184, v80, v81
    v_cvt_pk_bf16_f32 v185, v82, v83
    v_mfma_f32_32x32x16_bf16 a[0:15], a[128:131], v[100:103], a[0:15]
    v_exp_f32 v84, v84
    v_exp_f32 v85, v85
    v_exp_f32 v86, v86
    v_exp_f32 v87, v87
    v_cvt_pk_bf16_f32 v186, v84, v85
    v_cvt_pk_bf16_f32 v187, v86, v87
    v_mfma_f32_32x32x16_bf16 v[48:63], a[96:99], a[68:71], v[48:63]
    v_exp_f32 v88, v88
    v_exp_f32 v89, v89
    v_exp_f32 v90, v90
    v_exp_f32 v91, v91
    v_cvt_pk_bf16_f32 v188, v88, v89
    v_cvt_pk_bf16_f32 v189, v90, v91
    v_mfma_f32_32x32x16_bf16 a[16:31], a[128:131], v[108:111], a[16:31]
    v_exp_f32 v92, v92
    v_exp_f32 v93, v93
    v_exp_f32 v94, v94
    v_exp_f32 v95, v95
    v_cvt_pk_bf16_f32 v190, v92, v93
    v_cvt_pk_bf16_f32 v191, v94, v95
    v_mfma_f32_32x32x4_2b_bf16 v[64:95], a[106:107], a[82:83], 0
    v_exp_f32 v32, v32
    v_exp_f32 v33, v33
    v_exp_f32 v34, v34
    v_exp_f32 v35, v35
    v_exp_f32 v36, v36
    v_exp_f32 v37, v37
    v_exp_f32 v38, v38
    v_exp_f32 v39, v39
    v_cvt_pk_bf16_f32 v96, v32, v33
    v_cvt_pk_bf16_f32 v97, v34, v35
    v_cvt_pk_bf16_f32 v98, v36, v37
    v_cvt_pk_bf16_f32 v99, v38, v39
    v_mfma_f32_32x32x16_bf16 a[32:47], a[124:127], v[176:179], a[32:47]
    buffer_load_dwordx4 v4, s[40:43], s65 offen offset:1024 lds
    buffer_load_dwordx4 v4, s[40:43], s65 offen offset:2048 lds
    v_exp_f32 v40, v40
    v_exp_f32 v41, v41
    v_exp_f32 v42, v42
    v_exp_f32 v43, v43
    v_cvt_pk_bf16_f32 v100, v40, v41
    v_cvt_pk_bf16_f32 v101, v42, v43
    v_mfma_f32_32x32x16_bf16 a[48:63], a[124:127], v[184:187], a[48:63]
    v_exp_f32 v44, v44
    v_exp_f32 v45, v45
    v_exp_f32 v46, v46
    v_exp_f32 v47, v47
    v_cvt_pk_bf16_f32 v102, v44, v45
    v_cvt_pk_bf16_f32 v103, v46, v47
    v_mfma_f32_32x32x16_bf16 v[64:79], a[96:99], a[72:75], v[64:79]
    v_exp_f32 v48, v48
    v_exp_f32 v49, v49
    v_exp_f32 v50, v50
    v_exp_f32 v51, v51
    v_cvt_pk_bf16_f32 v104, v48, v49
    v_cvt_pk_bf16_f32 v105, v50, v51
    v_mfma_f32_32x32x16_bf16 a[32:47], a[128:131], v[180:183], a[32:47]
    v_exp_f32 v52, v52
    v_exp_f32 v53, v53
    v_exp_f32 v54, v54
    v_exp_f32 v55, v55
    v_cvt_pk_bf16_f32 v106, v52, v53
    v_cvt_pk_bf16_f32 v107, v54, v55
    v_mfma_f32_32x32x16_bf16 v[80:95], a[96:99], a[76:79], v[80:95]
    v_exp_f32 v56, v56
    v_exp_f32 v57, v57
    v_exp_f32 v58, v58
    v_exp_f32 v59, v59
    v_cvt_pk_bf16_f32 v108, v56, v57
    v_cvt_pk_bf16_f32 v109, v58, v59
    v_mfma_f32_32x32x16_bf16 a[48:63], a[128:131], v[188:191], a[48:63]
    s_waitcnt vmcnt(11)
    v_exp_f32 v60, v60
    v_exp_f32 v61, v61
    v_exp_f32 v62, v62
    v_exp_f32 v63, v63
    v_cvt_pk_bf16_f32 v110, v60, v61
    v_cvt_pk_bf16_f32 v111, v62, v63
    v_mfma_f32_32x32x4_2b_bf16 v[32:63], a[156:157], a[80:81], 0
    v_exp_f32 v64, v64
    v_exp_f32 v65, v65
    v_exp_f32 v66, v66
    v_exp_f32 v67, v67
    v_exp_f32 v68, v68
    v_exp_f32 v69, v69
    v_exp_f32 v70, v70
    v_exp_f32 v71, v71
    v_cvt_pk_bf16_f32 v176, v64, v65
    v_cvt_pk_bf16_f32 v177, v66, v67
    v_cvt_pk_bf16_f32 v178, v68, v69
    v_cvt_pk_bf16_f32 v179, v70, v71
    v_mfma_f32_32x32x16_bf16 a[0:15], a[132:135], v[96:99], a[0:15]
    s_add_u32 s96, s96, 1
    v_exp_f32 v72, v72
    v_exp_f32 v73, v73
    v_exp_f32 v74, v74
    v_exp_f32 v75, v75
    v_cvt_pk_bf16_f32 v180, v72, v73
    v_cvt_pk_bf16_f32 v181, v74, v75
    v_mfma_f32_32x32x16_bf16 a[16:31], a[132:135], v[104:107], a[16:31]
    s_and_b32 s96, s96, 7
    v_exp_f32 v76, v76
    v_exp_f32 v77, v77
    v_exp_f32 v78, v78
    v_exp_f32 v79, v79
    v_cvt_pk_bf16_f32 v182, v76, v77
    v_cvt_pk_bf16_f32 v183, v78, v79
    v_mfma_f32_32x32x16_bf16 v[32:47], a[140:143], a[64:67], v[32:47]
    s_add_u32 s65, s65, 3072
    v_exp_f32 v80, v80
    v_exp_f32 v81, v81
    v_exp_f32 v82, v82
    v_exp_f32 v83, v83
    v_cvt_pk_bf16_f32 v184, v80, v81
    v_cvt_pk_bf16_f32 v185, v82, v83
    v_mfma_f32_32x32x16_bf16 a[0:15], a[136:139], v[100:103], a[0:15]
    s_add_u32 s66, s66, 3072
    v_exp_f32 v84, v84
    v_exp_f32 v85, v85
    v_exp_f32 v86, v86
    v_exp_f32 v87, v87
    v_cvt_pk_bf16_f32 v186, v84, v85
    v_cvt_pk_bf16_f32 v187, v86, v87
    v_mfma_f32_32x32x16_bf16 v[48:63], a[140:143], a[68:71], v[48:63]
    v_exp_f32 v88, v88
    v_exp_f32 v89, v89
    v_exp_f32 v90, v90
    v_exp_f32 v91, v91
    v_cvt_pk_bf16_f32 v188, v88, v89
    v_cvt_pk_bf16_f32 v189, v90, v91
    v_mfma_f32_32x32x16_bf16 a[16:31], a[136:139], v[108:111], a[16:31]
    v_exp_f32 v92, v92
    v_exp_f32 v93, v93
    v_exp_f32 v94, v94
    v_exp_f32 v95, v95
    v_cvt_pk_bf16_f32 v190, v92, v93
    v_cvt_pk_bf16_f32 v191, v94, v95
    v_mfma_f32_32x32x4_2b_bf16 v[64:95], a[156:157], a[82:83], 0
    s_lshl_b32 s58, s96, 13
    v_exp_f32 v32, v32
    v_exp_f32 v33, v33
    v_exp_f32 v34, v34
    v_exp_f32 v35, v35
    v_exp_f32 v36, v36
    v_exp_f32 v37, v37
    v_exp_f32 v38, v38
    v_exp_f32 v39, v39
    v_cvt_pk_bf16_f32 v96, v32, v33
    v_cvt_pk_bf16_f32 v97, v34, v35
    v_cvt_pk_bf16_f32 v98, v36, v37
    v_cvt_pk_bf16_f32 v99, v38, v39
    v_mfma_f32_32x32x16_bf16 a[32:47], a[132:135], v[176:179], a[32:47]
    s_lshl_b32 s59, s96, 11
    v_exp_f32 v40, v40
    v_exp_f32 v41, v41
    v_exp_f32 v42, v42
    v_exp_f32 v43, v43
    v_cvt_pk_bf16_f32 v100, v40, v41
    v_cvt_pk_bf16_f32 v101, v42, v43
    v_mfma_f32_32x32x16_bf16 a[48:63], a[132:135], v[184:187], a[48:63]
    s_lshl_b32 s60, s96, 14
    v_exp_f32 v44, v44
    v_exp_f32 v45, v45
    v_exp_f32 v46, v46
    v_exp_f32 v47, v47
    v_cvt_pk_bf16_f32 v102, v44, v45
    v_cvt_pk_bf16_f32 v103, v46, v47
    v_mfma_f32_32x32x16_bf16 v[64:79], a[140:143], a[72:75], v[64:79]
    s_add_u32 s58, s58, s92
    v_exp_f32 v48, v48
    v_exp_f32 v49, v49
    v_exp_f32 v50, v50
    v_exp_f32 v51, v51
    v_cvt_pk_bf16_f32 v104, v48, v49
    v_cvt_pk_bf16_f32 v105, v50, v51
    v_mfma_f32_32x32x16_bf16 a[32:47], a[136:139], v[180:183], a[32:47]
    s_add_u32 s59, s59, s92
    v_exp_f32 v52, v52
    v_exp_f32 v53, v53
    v_exp_f32 v54, v54
    v_exp_f32 v55, v55
    v_cvt_pk_bf16_f32 v106, v52, v53
    v_cvt_pk_bf16_f32 v107, v54, v55
    v_mfma_f32_32x32x16_bf16 v[80:95], a[140:143], a[76:79], v[80:95]
    s_add_u32 s60, s60, s92
    v_exp_f32 v56, v56
    v_exp_f32 v57, v57
    v_exp_f32 v58, v58
    v_exp_f32 v59, v59
    v_cvt_pk_bf16_f32 v108, v56, v57
    v_cvt_pk_bf16_f32 v109, v58, v59
    v_mfma_f32_32x32x16_bf16 a[48:63], a[136:139], v[188:191], a[48:63]
    s_add_u32 s61, s60, 4096
    s_cmp_lt_u32 s95, s52
    v_exp_f32 v60, v60
    v_exp_f32 v61, v61
    v_exp_f32 v62, v62
    v_exp_f32 v63, v63
    v_cvt_pk_bf16_f32 v110, v60, v61
    v_cvt_pk_bf16_f32 v111, v62, v63
    v_mfma_f32_32x32x4_2b_bf16 v[32:63], a[158:159], a[80:81], 0
    s_waitcnt vmcnt(0)
    s_cbranch_scc1 L_stg1
L_stgb1:
    v_exp_f32 v64, v64
    v_exp_f32 v65, v65
    v_exp_f32 v66, v66
    v_exp_f32 v67, v67
    v_exp_f32 v68, v68
    v_exp_f32 v69, v69
    v_exp_f32 v70, v70
    v_exp_f32 v71, v71
    v_cvt_pk_bf16_f32 v176, v64, v65
    v_cvt_pk_bf16_f32 v177, v66, v67
    v_cvt_pk_bf16_f32 v178, v68, v69
    v_cvt_pk_bf16_f32 v179, v70, v71
    v_mfma_f32_32x32x16_bf16 a[0:15], a[164:167], v[96:99], a[0:15]
    v_exp_f32 v72, v72
    v_exp_f32 v73, v73
    v_exp_f32 v74, v74
    v_exp_f32 v75, v75
    v_cvt_pk_bf16_f32 v180, v72, v73
    v_cvt_pk_bf16_f32 v181, v74, v75
    v_mfma_f32_32x32x16_bf16 a[16:31], a[164:167], v[104:107], a[16:31]
    s_mov_b32 m0, s66
    v_exp_f32 v76, v76
    v_exp_f32 v77, v77
    v_exp_f32 v78, v78
    v_exp_f32 v79, v79
    v_cvt_pk_bf16_f32 v182, v76, v77
    v_cvt_pk_bf16_f32 v183, v78, v79
    v_mfma_f32_32x32x16_bf16 v[32:47], a[144:147], a[64:67], v[32:47]
    v_exp_f32 v80, v80
    v_exp_f32 v81, v81
    v_exp_f32 v82, v82
    v_exp_f32 v83, v83
    v_cvt_pk_bf16_f32 v184, v80, v81
    v_cvt_pk_bf16_f32 v185, v82, v83
    v_mfma_f32_32x32x16_bf16 a[0:15], a[168:171], v[100:103], a[0:15]
    v_exp_f32 v84, v84
    v_exp_f32 v85, v85
    v_exp_f32 v86, v86
    v_exp_f32 v87, v87
    v_cvt_pk_bf16_f32 v186, v84, v85
    v_cvt_pk_bf16_f32 v187, v86, v87
    v_mfma_f32_32x32x16_bf16 v[48:63], a[144:147], a[68:71], v[48:63]
    v_exp_f32 v88, v88
    v_exp_f32 v89, v89
    v_exp_f32 v90, v90
    v_exp_f32 v91, v91
    v_cvt_pk_bf16_f32 v188, v88, v89
    v_cvt_pk_bf16_f32 v189, v90, v91
    v_mfma_f32_32x32x16_bf16 a[16:31], a[168:171], v[108:111], a[16:31]
    v_exp_f32 v92, v92
    v_exp_f32 v93, v93
    v_exp_f32 v94, v94
    v_exp_f32 v95, v95
    v_cvt_pk_bf16_f32 v190, v92, v93
    v_cvt_pk_bf16_f32 v191, v94, v95
    v_mfma_f32_32x32x4_2b_bf16 v[64:95], a[158:159], a[82:83], 0
    v_exp_f32 v32, v32
    v_exp_f32 v33, v33
    v_exp_f32 v34, v34
    v_exp_f32 v35, v35
    v_exp_f32 v36, v36
    v_exp_f32 v37, v37
    v_exp_f32 v38, v38
    v_exp_f32 v39, v39
    v_cvt_pk_bf16_f32 v96, v32, v33
    v_cvt_pk_bf16_f32 v97, v34, v35
    v_cvt_pk_bf16_f32 v98, v36, v37
    v_cvt_pk_bf16_f32 v99, v38, v39
    v_mfma_f32_32x32x16_bf16 a[32:47], a[164:167], v[176:179], a[32:47]
    v_exp_f32 v40, v40
    v_exp_f32 v41, v41
    v_exp_f32 v42, v42
    v_exp_f32 v43, v43
    v_cvt_pk_bf16_f32 v100, v40, v41
    v_cvt_pk_bf16_f32 v101, v42, v43
    v_mfma_f32_32x32x16_bf16 a[48:63], a[164:167], v[184:187], a[48:63]
    v_exp_f32 v44, v44
    v_exp_f32 v45, v45
    v_exp_f32 v46, v46
    v_exp_f32 v47, v47
    v_cvt_pk_bf16_f32 v102, v44, v45
    v_cvt_pk_bf16_f32 v103, v46, v47
    v_mfma_f32_32x32x16_bf16 v[64:79], a[144:147], a[72:75], v[64:79]
    v_exp_f32 v48, v48
    v_exp_f32 v49, v49
    v_exp_f32 v50, v50
    v_exp_f32 v51, v51
    v_cvt_pk_bf16_f32 v104, v48, v49
    v_cvt_pk_bf16_f32 v105, v50, v51
    v_mfma_f32_32x32x16_bf16 a[32:47], a[168:171], v[180:183], a[32:47]
    v_exp_f32 v52, v52
    v_exp_f32 v53, v53
    v_exp_f32 v54, v54
    v_exp_f32 v55, v55
    v_cvt_pk_bf16_f32 v106, v52, v53
    v_cvt_pk_bf16_f32 v107, v54, v55
    v_mfma_f32_32x32x16_bf16 v[80:95], a[144:147], a[76:79], v[80:95]
    v_exp_f32 v56, v56
    v_exp_f32 v57, v57
    v_exp_f32 v58, v58
    v_exp_f32 v59, v59
    v_cvt_pk_bf16_f32 v108, v56, v57
    v_cvt_pk_bf16_f32 v109, v58, v59
    v_mfma_f32_32x32x16_bf16 a[48:63], a[168:171], v[188:191], a[48:63]
    v_exp_f32 v60, v60
    v_exp_f32 v61, v61
    v_exp_f32 v62, v62
    v_exp_f32 v63, v63
    v_cvt_pk_bf16_f32 v110, v60, v61
    v_cvt_pk_bf16_f32 v111, v62, v63
    v_mfma_f32_32x32x4_2b_bf16 v[32:63], a[160:161], a[80:81], 0
    v_exp_f32 v64, v64
    v_exp_f32 v65, v65
    v_exp_f32 v66, v66
    v_exp_f32 v67, v67
    v_exp_f32 v68, v68
    v_exp_f32 v69, v69
    v_exp_f32 v70, v70
    v_exp_f32 v71, v71
    v_cvt_pk_bf16_f32 v176, v64, v65
    v_cvt_pk_bf16_f32 v177, v66, v67
    v_cvt_pk_bf16_f32 v178, v68, v69
    v_cvt_pk_bf16_f32 v179, v70, v71
    v_mfma_f32_32x32x16_bf16 a[0:15], a[172:175], v[96:99], a[0:15]
    buffer_load_dwordx4 a[100:103], v19, s[40:43], s59 offen offset:0
    buffer_load_dwordx4 a[104:107], v19, s[40:43], s59 offen offset:512
    buffer_load_dwordx4 a[84:87], v18, s[40:43], s58 offen offset:0
    buffer_load_dwordx4 a[88:91], v18, s[40:43], s58 offen offset:1024
    buffer_load_dwordx4 a[92:95], v18, s[40:43], s58 offen offset:2048
    buffer_load_dwordx4 a[96:99], v18, s[40:43], s58 offen offset:3072
    v_exp_f32 v72, v72
    v_exp_f32 v73, v73
    v_exp_f32 v74, v74
    v_exp_f32 v75, v75
    v_cvt_pk_bf16_f32 v180, v72, v73
    v_cvt_pk_bf16_f32 v181, v74, v75
    v_mfma_f32_32x32x16_bf16 a[16:31], a[172:175], v[104:107], a[16:31]
    v_exp_f32 v76, v76
    v_exp_f32 v77, v77
    v_exp_f32 v78, v78
    v_exp_f32 v79, v79
    v_cvt_pk_bf16_f32 v182, v76, v77
    v_cvt_pk_bf16_f32 v183, v78, v79
    v_mfma_f32_32x32x16_bf16 v[32:47], a[148:151], a[64:67], v[32:47]
    v_exp_f32 v80, v80
    v_exp_f32 v81, v81
    v_exp_f32 v82, v82
    v_exp_f32 v83, v83
    v_cvt_pk_bf16_f32 v184, v80, v81
    v_cvt_pk_bf16_f32 v185, v82, v83
    v_mfma_f32_32x32x16_bf16 a[0:15], a[176:179], v[100:103], a[0:15]
    v_exp_f32 v84, v84
    v_exp_f32 v85, v85
    v_exp_f32 v86, v86
    v_exp_f32 v87, v87
    v_cvt_pk_bf16_f32 v186, v84, v85
    v_cvt_pk_bf16_f32 v187, v86, v87
    v_mfma_f32_32x32x16_bf16 v[48:63], a[148:151], a[68:71], v[48:63]
    v_exp_f32 v88, v88
    v_exp_f32 v89, v89
    v_exp_f32 v90, v90
    v_exp_f32 v91, v91
    v_cvt_pk_bf16_f32 v188, v88, v89
    v_cvt_pk_bf16_f32 v189, v90, v91
    v_mfma_f32_32x32x16_bf16 a[16:31], a[176:179], v[108:111], a[16:31]
    v_exp_f32 v92, v92
    v_exp_f32 v93, v93
    v_exp_f32 v94, v94
    v_exp_f32 v95, v95
    v_cvt_pk_bf16_f32 v190, v92, v93
    v_cvt_pk_bf16_f32 v191, v94, v95
    v_mfma_f32_32x32x4_2b_bf16 v[64:95], a[160:161], a[82:83], 0
    v_exp_f32 v32, v32
    v_exp_f32 v33, v33
    v_exp_f32 v34, v34
    v_exp_f32 v35, v35
    v_exp_f32 v36, v36
    v_exp_f32 v37, v37
    v_exp_f32 v38, v38
    v_exp_f32 v39, v39
    v_cvt_pk_bf16_f32 v96, v32, v33
    v_cvt_pk_bf16_f32 v97, v34, v35
    v_cvt_pk_bf16_f32 v98, v36, v37
    v_cvt_pk_bf16_f32 v99, v38, v39
    v_mfma_f32_32x32x16_bf16 a[32:47], a[172:175], v[176:179], a[32:47]
    buffer_load_dwordx4 a[108:111], v20, s[40:43], s60 offen offset:0
    buffer_load_dwordx4 a[112:115], v20, s[40:43], s60 offen offset:1024
    buffer_load_dwordx4 a[116:119], v20, s[40:43], s60 offen offset:2048
    buffer_load_dwordx4 a[120:123], v20, s[40:43], s60 offen offset:3072
    v_exp_f32 v40, v40
    v_exp_f32 v41, v41
    v_exp_f32 v42, v42
    v_exp_f32 v43, v43
    v_cvt_pk_bf16_f32 v100, v40, v41
    v_cvt_pk_bf16_f32 v101, v42, v43
    v_mfma_f32_32x32x16_bf16 a[48:63], a[172:175], v[184:187], a[48:63]
    v_exp_f32 v44, v44
    v_exp_f32 v45, v45
    v_exp_f32 v46, v46
    v_exp_f32 v47, v47
    v_cvt_pk_bf16_f32 v102, v44, v45
    v_cvt_pk_bf16_f32 v103, v46, v47
    v_mfma_f32_32x32x16_bf16 v[64:79], a[148:151], a[72:75], v[64:79]
    v_exp_f32 v48, v48
    v_exp_f32 v49, v49
    v_exp_f32 v50, v50
    v_exp_f32 v51, v51
    v_cvt_pk_bf16_f32 v104, v48, v49
    v_cvt_pk_bf16_f32 v105, v50, v51
    v_mfma_f32_32x32x16_bf16 a[32:47], a[176:179], v[180:183], a[32:47]
    v_exp_f32 v52, v52
    v_exp_f32 v53, v53
    v_exp_f32 v54, v54
    v_exp_f32 v55, v55
    v_cvt_pk_bf16_f32 v106, v52, v53
    v_cvt_pk_bf16_f32 v107, v54, v55
    v_mfma_f32_32x32x16_bf16 v[80:95], a[148:151], a[76:79], v[80:95]
    v_exp_f32 v56, v56
    v_exp_f32 v57, v57
    v_exp_f32 v58, v58
    v_exp_f32 v59, v59
    v_cvt_pk_bf16_f32 v108, v56, v57
    v_cvt_pk_bf16_f32 v109, v58, v59
    v_mfma_f32_32x32x16_bf16 a[48:63], a[176:179], v[188:191], a[48:63]
    v_exp_f32 v60, v60
    v_exp_f32 v61, v61
    v_exp_f32 v62, v62
    v_exp_f32 v63, v63
    v_cvt_pk_bf16_f32 v110, v60, v61
    v_cvt_pk_bf16_f32 v111, v62, v63
    v_mfma_f32_32x32x4_2b_bf16 v[32:63], a[162:163], a[80:81], 0
    v_exp_f32 v64, v64
    v_exp_f32 v65, v65
    v_exp_f32 v66, v66
    v_exp_f32 v67, v67
    v_exp_f32 v68, v68
    v_exp_f32 v69, v69
    v_exp_f32 v70, v70
    v_exp_f32 v71, v71
    v_cvt_pk_bf16_f32 v176, v64, v65
    v_cvt_pk_bf16_f32 v177, v66, v67
    v_cvt_pk_bf16_f32 v178, v68, v69
    v_cvt_pk_bf16_f32 v179, v70, v71
    v_mfma_f32_32x32x16_bf16 a[0:15], a[180:183], v[96:99], a[0:15]
    buffer_load_dwordx4 a[124:127], v20, s[40:43], s61 offen offset:0
    buffer_load_dwordx4 a[128:131], v20, s[40:43], s61 offen offset:1024
    buffer_load_dwordx4 a[132:135], v20, s[40:43], s61 offen offset:2048
    buffer_load_dwordx4 a[136:139], v20, s[40:43], s61 offen offset:3072
    buffer_load_dwordx4 v4, s[40:43], s65 offen offset:0 lds
    v_exp_f32 v72, v72
    v_exp_f32 v73, v73
    v_exp_f32 v74, v74
    v_exp_f32 v75, v75
    v_cvt_pk_bf16_f32 v180, v72, v73
    v_cvt_pk_bf16_f32 v181, v74, v75
    v_mfma_f32_32x32x16_bf16 a[16:31], a[180:183], v[104:107], a[16:31]
    v_exp_f32 v76, v76
    v_exp_f32 v77, v77
    v_exp_f32 v78, v78
    v_exp_f32 v79, v79
    v_cvt_pk_bf16_f32 v182, v76, v77
    v_cvt_pk_bf16_f32 v183, v78, v79
    v_mfma_f32_32x32x16_bf16 v[32:47], a[152:155], a[64:67], v[32:47]
    v_exp_f32 v80, v80
    v_exp_f32 v81, v81
    v_exp_f32 v82, v82
    v_exp_f32 v83, v83
    v_cvt_pk_bf16_f32 v184, v80, v81
    v_cvt_pk_bf16_f32 v185, v82, v83
    v_mfma_f32_32x32x16_bf16 a[0:15], a[184:187], v[100:103], a[0:15]
    v_exp_f32 v84, v84
    v_exp_f32 v85, v85
    v_exp_f32 v86, v86
    v_exp_f32 v87, v87
    v_cvt_pk_bf16_f32 v186, v84, v85
    v_cvt_pk_bf16_f32 v187, v86, v87
    v_mfma_f32_32x32x16_bf16 v[48:63], a[152:155], a[68:71], v[48:63]
    v_exp_f32 v88, v88
    v_exp_f32 v89, v89
    v_exp_f32 v90, v90
    v_exp_f32 v91, v91
    v_cvt_pk_bf16_f32 v188, v88, v89
    v_cvt_pk_bf16_f32 v189, v90, v91
    v_mfma_f32_32x32x16_bf16 a[16:31], a[184:187], v[108:111], a[16:31]
    v_exp_f32 v92, v92
    v_exp_f32 v93, v93
    v_exp_f32 v94, v94
    v_exp_f32 v95, v95
    v_cvt_pk_bf16_f32 v190, v92, v93
    v_cvt_pk_bf16_f32 v191, v94, v95
    v_mfma_f32_32x32x4_2b_bf16 v[64:95], a[162:163], a[82:83], 0
    v_exp_f32 v32, v32
    v_exp_f32 v33, v33
    v_exp_f32 v34, v34
    v_exp_f32 v35, v35
    v_exp_f32 v36, v36
    v_exp_f32 v37, v37
    v_exp_f32 v38, v38
    v_exp_f32 v39, v39
    v_cvt_pk_bf16_f32 v96, v32, v33
    v_cvt_pk_bf16_f32 v97, v34, v35
    v_cvt_pk_bf16_f32 v98, v36, v37
    v_cvt_pk_bf16_f32 v99, v38, v39
    v_mfma_f32_32x32x16_bf16 a[32:47], a[180:183], v[176:179], a[32:47]
    buffer_load_dwordx4 v4, s[40:43], s65 offen offset:1024 lds
    buffer_load_dwordx4 v4, s[40:43], s65 offen offset:2048 lds
    v_exp_f32 v40, v40
    v_exp_f32 v41, v41
    v_exp_f32 v42, v42
    v_exp_f32 v43, v43
    v_cvt_pk_bf16_f32 v100, v40, v41
    v_cvt_pk_bf16_f32 v101, v42, v43
    v_mfma_f32_32x32x16_bf16 a[48:63], a[180:183], v[184:187], a[48:63]
    v_exp_f32 v44, v44
    v_exp_f32 v45, v45
    v_exp_f32 v46, v46
    v_exp_f32 v47, v47
    v_cvt_pk_bf16_f32 v102, v44, v45
    v_cvt_pk_bf16_f32 v103, v46, v47
    v_mfma_f32_32x32x16_bf16 v[64:79], a[152:155], a[72:75], v[64:79]
    v_exp_f32 v48, v48
    v_exp_f32 v49, v49
    v_exp_f32 v50, v50
    v_exp_f32 v51, v51
    v_cvt_pk_bf16_f32 v104, v48, v49
    v_cvt_pk_bf16_f32 v105, v50, v51
    v_mfma_f32_32x32x16_bf16 a[32:47], a[184:187], v[180:183], a[32:47]
    v_exp_f32 v52, v52
    v_exp_f32 v53, v53
    v_exp_f32 v54, v54
    v_exp_f32 v55, v55
    v_cvt_pk_bf16_f32 v106, v52, v53
    v_cvt_pk_bf16_f32 v107, v54, v55
    v_mfma_f32_32x32x16_bf16 v[80:95], a[152:155], a[76:79], v[80:95]
    v_exp_f32 v56, v56
    v_exp_f32 v57, v57
    v_exp_f32 v58, v58
    v_exp_f32 v59, v59
    v_cvt_pk_bf16_f32 v108, v56, v57
    v_cvt_pk_bf16_f32 v109, v58, v59
    v_mfma_f32_32x32x16_bf16 a[48:63], a[184:187], v[188:191], a[48:63]
    s_waitcnt vmcnt(11)
    v_exp_f32 v60, v60
    v_exp_f32 v61, v61
    v_exp_f32 v62, v62
    v_exp_f32 v63, v63
    v_cvt_pk_bf16_f32 v110, v60, v61
    v_cvt_pk_bf16_f32 v111, v62, v63
    v_mfma_f32_32x32x4_2b_bf16 v[32:63], a[100:101], a[80:81], 0
    v_exp_f32 v64, v64
    v_exp_f32 v65, v65
    v_exp_f32 v66, v66
    v_exp_f32 v67, v67
    v_exp_f32 v68, v68
    v_exp_f32 v69, v69
    v_exp_f32 v70, v70
    v_exp_f32 v71, v71
    v_cvt_pk_bf16_f32 v176, v64, v65
    v_cvt_pk_bf16_f32 v177, v66, v67
    v_cvt_pk_bf16_f32 v178, v68, v69
    v_cvt_pk_bf16_f32 v179, v70, v71
    v_mfma_f32_32x32x16_bf16 a[0:15], a[188:191], v[96:99], a[0:15]
    s_add_u32 s96, s96, 1
    v_exp_f32 v72, v72
    v_exp_f32 v73, v73
    v_exp_f32 v74, v74
    v_exp_f32 v75, v75
    v_cvt_pk_bf16_f32 v180, v72, v73
    v_cvt_pk_bf16_f32 v181, v74, v75
    v_mfma_f32_32x32x16_bf16 a[16:31], a[188:191], v[104:107], a[16:31]
    s_and_b32 s96, s96, 7
    v_exp_f32 v76, v76
    v_exp_f32 v77, v77
    v_exp_f32 v78, v78
    v_exp_f32 v79, v79
    v_cvt_pk_bf16_f32 v182, v76, v77
    v_cvt_pk_bf16_f32 v183, v78, v79
    v_mfma_f32_32x32x16_bf16 v[32:47], a[84:87], a[64:67], v[32:47]
    s_add_u32 s65, s65, 3072
    v_exp_f32 v80, v80
    v_exp_f32 v81, v81
    v_exp_f32 v82, v82
    v_exp_f32 v83, v83
    v_cvt_pk_bf16_f32 v184, v80, v81
    v_cvt_pk_bf16_f32 v185, v82, v83
    v_mfma_f32_32x32x16_bf16 a[0:15], a[192:195], v[100:103], a[0:15]
    s_add_u32 s66, s66, 3072
    v_exp_f32 v84, v84
    v_exp_f32 v85, v85
    v_exp_f32 v86, v86
    v_exp_f32 v87, v87
    v_cvt_pk_bf16_f32 v186, v84, v85
    v_cvt_pk_bf16_f32 v187, v86, v87
    v_mfma_f32_32x32x16_bf16 v[48:63], a[84:87], a[68:71], v[48:63]
    s_add_u32 s95, s95, 1
    v_exp_f32 v88, v88
    v_exp_f32 v89, v89
    v_exp_f32 v90, v90
    v_exp_f32 v91, v91
    v_cvt_pk_bf16_f32 v188, v88, v89
    v_cvt_pk_bf16_f32 v189, v90, v91
    v_mfma_f32_32x32x16_bf16 a[16:31], a[192:195], v[108:111], a[16:31]
    s_cmp_lt_u32 s95, 4
    v_exp_f32 v92, v92
    v_exp_f32 v93, v93
    v_exp_f32 v94, v94
    v_exp_f32 v95, v95
    v_cvt_pk_bf16_f32 v190, v92, v93
    v_cvt_pk_bf16_f32 v191, v94, v95
    s_cbranch_scc1 L_att_loop
    v_mfma_f32_32x32x16_bf16 a[32:47], a[188:191], v[176:179], a[32:47]
    v_mfma_f32_32x32x16_bf16 a[48:63], a[188:191], v[184:187], a[48:63]
    v_mfma_f32_32x32x16_bf16 a[32:47], a[192:195], v[180:183], a[32:47]
    v_mfma_f32_32x32x16_bf16 a[48:63], a[192:195], v[188:191], a[48:63]
L_att_done:
    s_or_b32 s49, s2, s77
    s_cmp_lg_u32 s49, 0
    s_cbranch_scc1 Lep_33
    s_cmp_lg_u32 s71, 0
    s_cbranch_scc1 Lfl_34
    v_mov_b32 v22, s70
    s_mov_b64 exec, 1
    buffer_store_dword v22, off, s[40:43], s49 sc1
    s_mov_b64 exec, -1
Lfl_34:
Lep_33:
    s_mul_i32 s49, s71, 6144
    s_xor_b32 s50, s71, 2
    s_mul_i32 s50, s50, 6144
    v_add_u32 v25, s50, v6
    v_add_u32 v24, s49, v6
    v_accvgpr_read_b32 v26, a204
    v_accvgpr_read_b32 v27, a205
    s_cmp_eq_u32 s94, 0
    s_cbranch_scc0 L_red1
    v_accvgpr_read_b32 v32, a0
    v_accvgpr_read_b32 v33, a1
    v_accvgpr_read_b32 v34, a2
    v_accvgpr_read_b32 v35, a3
    v_accvgpr_read_b32 v36, a4
    v_accvgpr_read_b32 v37, a5
    v_accvgpr_read_b32 v38, a6
    v_accvgpr_read_b32 v39, a7
    v_accvgpr_read_b32 v40, a8
    v_accvgpr_read_b32 v41, a9
    v_accvgpr_read_b32 v42, a10
    v_accvgpr_read_b32 v44, a16
    v_accvgpr_read_b32 v45, a17
    v_accvgpr_read_b32 v46, a18
    v_accvgpr_read_b32 v47, a19
    v_accvgpr_read_b32 v48, a20
    v_accvgpr_read_b32 v49, a21
    v_accvgpr_read_b32 v50, a22
    v_accvgpr_read_b32 v51, a23
    v_accvgpr_read_b32 v52, a24
    v_accvgpr_read_b32 v53, a25
    v_accvgpr_read_b32 v54, a26
    ds_write_b128 v24, a[32:35] offset:0
    ds_write_b128 v24, a[36:39] offset:1024
    ds_write_b128 v24, a[40:43] offset:2048
    ds_write_b128 v24, a[48:51] offset:3072
    ds_write_b128 v24, a[52:55] offset:4096
    ds_write_b128 v24, a[56:59] offset:5120
    s_branch L_red2
L_red1:
    ds_write_b128 v24, a[0:3] offset:0
    ds_write_b128 v24, a[4:7] offset:1024
    ds_write_b128 v24, a[8:11] offset:2048
    ds_write_b128 v24, a[16:19] offset:3072
    ds_write_b128 v24, a[20:23] offset:4096
    ds_write_b128 v24, a[24:27] offset:5120
    v_accvgpr_read_b32 v32, a32
    v_accvgpr_read_b32 v33, a33
    v_accvgpr_read_b32 v34, a34
    v_accvgpr_read_b32 v35, a35
    v_accvgpr_read_b32 v36, a36
    v_accvgpr_read_b32 v37, a37
    v_accvgpr_read_b32 v38, a38
    v_accvgpr_read_b32 v39, a39
    v_accvgpr_read_b32 v40, a40
    v_accvgpr_read_b32 v41, a41
    v_accvgpr_read_b32 v42, a42
    v_accvgpr_read_b32 v44, a48
    v_accvgpr_read_b32 v45, a49
    v_accvgpr_read_b32 v46, a50
    v_accvgpr_read_b32 v47, a51
    v_accvgpr_read_b32 v48, a52
    v_accvgpr_read_b32 v49, a53
    v_accvgpr_read_b32 v50, a54
    v_accvgpr_read_b32 v51, a55
    v_accvgpr_read_b32 v52, a56
    v_accvgpr_read_b32 v53, a57
    v_accvgpr_read_b32 v54, a58
L_red2:
    s_mov_b32 s52, 0x7f800000
    s_mov_b32 s53, 0x1f800000
    s_mov_b32 s54, 0x71800000
    s_lshl_b32 s55, s71, 2
    s_add_u32 s55, s55, 161792
    s_waitcnt vmcnt(0) lgkmcnt(0)
    s_barrier
    ds_read_b128 v[64:67], v25 offset:2048
    ds_read_b128 v[76:79], v25 offset:5120
    ds_read_b128 v[56:59], v25 offset:0
    ds_read_b128 v[60:63], v25 offset:1024
    ds_read_b128 v[68:71], v25 offset:3072
    ds_read_b128 v[72:75], v25 offset:4096
    s_waitcnt lgkmcnt(4)
    v_pk_add_f32 v[40:41], v[40:41], v[64:65]
    v_add_f32 v42, v42, v66
    v_pk_add_f32 v[52:53], v[52:53], v[76:77]
    v_add_f32 v54, v54, v78
    v_rcp_f32 v43, v42
    v_rcp_f32 v55, v54
    s_waitcnt lgkmcnt(0)
    v_pk_add_f32 v[32:33], v[32:33], v[56:57]
    v_pk_add_f32 v[34:35], v[34:35], v[58:59]
    v_pk_add_f32 v[36:37], v[36:37], v[60:61]
    v_pk_add_f32 v[38:39], v[38:39], v[62:63]
    v_pk_add_f32 v[44:45], v[44:45], v[68:69]
    v_pk_add_f32 v[46:47], v[46:47], v[70:71]
    v_pk_add_f32 v[48:49], v[48:49], v[72:73]
    v_pk_add_f32 v[50:51], v[50:51], v[74:75]
    v_pk_mul_f32 v[32:33], v[32:33], v[42:43] op_sel:[0,1] op_sel_hi:[1,1]
    v_pk_mul_f32 v[34:35], v[34:35], v[42:43] op_sel:[0,1] op_sel_hi:[1,1]
    v_pk_mul_f32 v[36:37], v[36:37], v[42:43] op_sel:[0,1] op_sel_hi:[1,1]
    v_pk_mul_f32 v[38:39], v[38:39], v[42:43] op_sel:[0,1] op_sel_hi:[1,1]
    v_pk_mul_f32 v[40:41], v[40:41], v[42:43] op_sel:[0,1] op_sel_hi:[1,1]
    v_cvt_pk_bf16_f32 v176, v32, v33
    v_cvt_pk_bf16_f32 v177, v34, v35
    v_cvt_pk_bf16_f32 v178, v36, v37
    v_cvt_pk_bf16_f32 v179, v38, v39
    v_cvt_pk_bf16_f32 v184, v40, v41
    v_pk_mul_f32 v[44:45], v[44:45], v[54:55] op_sel:[0,1] op_sel_hi:[1,1]
    v_pk_mul_f32 v[46:47], v[46:47], v[54:55] op_sel:[0,1] op_sel_hi:[1,1]
    v_pk_mul_f32 v[48:49], v[48:49], v[54:55] op_sel:[0,1] op_sel_hi:[1,1]
    v_pk_mul_f32 v[50:51], v[50:51], v[54:55] op_sel:[0,1] op_sel_hi:[1,1]
    v_pk_mul_f32 v[52:53], v[52:53], v[54:55] op_sel:[0,1] op_sel_hi:[1,1]
    v_cvt_pk_bf16_f32 v180, v44, v45
    v_cvt_pk_bf16_f32 v181, v46, v47
    v_cvt_pk_bf16_f32 v182, v48, v49
    v_cvt_pk_bf16_f32 v183, v50, v51
    v_cvt_pk_bf16_f32 v185, v52, v53
    s_cmp_eq_u32 s79, 0
    s_cbranch_scc1 Lsg_35
    buffer_store_dwordx4 v[176:179], v26, s[40:43], s31 offen
    buffer_store_dwordx4 v[180:183], v26, s[40:43], s31 offen offset:512
    buffer_store_dwordx2 v[184:185], v27, s[40:43], s32 offen
    s_branch Lse_36
Lsg_35:
    buffer_store_dwordx4 v[176:179], v26, s[40:43], s31 offen sc1
    buffer_store_dwordx4 v[180:183], v26, s[40:43], s31 offen offset:512 sc1
    buffer_store_dwordx2 v[184:185], v27, s[40:43], s32 offen sc1
Lse_36:
    v_add_f32 v28, |v32|, |v44|
    v_add_f32 v29, |v33|, |v45|
    v_add_f32 v28, |v34|, v28
    v_add_f32 v29, |v46|, v29
    v_add_f32 v28, |v35|, v28
    v_add_f32 v29, |v47|, v29
    v_add_f32 v28, |v36|, v28
    v_add_f32 v29, |v48|, v29
    v_add_f32 v28, |v37|, v28
    v_add_f32 v29, |v49|, v29
    v_add_f32 v28, |v38|, v28
    v_add_f32 v29, |v50|, v29
    v_add_f32 v28, |v39|, v28
    v_add_f32 v29, |v51|, v29
    v_add_f32 v28, |v40|, v28
    v_add_f32 v29, |v52|, v29
    v_add_f32 v28, |v41|, v28
    v_add_f32 v29, |v53|, v29
    v_add_f32 v28, v28, v29
    v_cmp_nlt_f32 s[84:85], v28, s52
    v_cmp_nle_f32 vcc, s53, v42
    s_nop 0
    s_or_b64 s[84:85], s[84:85], vcc
    v_cmp_nge_f32 vcc, s54, v42
    s_nop 0
    s_or_b64 s[84:85], s[84:85], vcc
    v_cmp_nle_f32 vcc, s53, v54
    s_nop 0
    s_or_b64 s[84:85], s[84:85], vcc
    v_cmp_nge_f32 vcc, s54, v54
    s_nop 0
    s_or_b64 s[84:85], s[84:85], vcc
    s_cmp_lg_u64 s[84:85], 0
    s_cselect_b32 s52, 1, 0
    v_mov_b32 v28, s52
    v_mov_b32 v29, s55
    ds_write_b32 v29, v28
    v_mov_b32 v29, 161792
    s_waitcnt vmcnt(0) lgkmcnt(0)
    s_barrier
    ds_read_b128 v[32:35], v29
    s_waitcnt lgkmcnt(0)
    v_or_b32 v32, v32, v33
    v_or3_b32 v32, v32, v34, v35
    s_nop 0
    v_readfirstlane_b32 s52, v32
    s_nop 0
    s_andn2_b32 s52, s52, s91
    s_cbranch_scc1 L_fallback
    s_cmp_lg_u32 s71, 0
    s_cbranch_scc1 Lfl_37
    v_mov_b32 v22, s78
    s_mov_b64 exec, 1
    s_cmp_eq_u32 s79, 0
    s_cbranch_scc1 Lsg_38
    buffer_store_dword v22, off, s[40:43], s27
    s_branch Lse_39
Lsg_38:
    buffer_store_dword v22, off, s[40:43], s27 sc1
Lse_39:
    s_mov_b64 exec, -1
Lfl_37:
    v_and_b32 v24, 28, v8
    s_mov_b32 s95, s18
    s_cmp_eq_u32 s77, 1
    s_cbranch_scc1 L_wob1
    s_mul_i32 s49, s71, 12800
    v_add_u32 v31, s49, v6
    ds_write_b128 v31, v[192:195] offset:0
    ds_write_b128 v31, v[196:199] offset:1024
    ds_write_b128 v31, v[200:203] offset:2048
    ds_write_b128 v31, v[204:207] offset:3072
    ds_write_b128 v31, v[208:211] offset:4096
    ds_write_b128 v31, v[212:215] offset:5120
    ds_write_b128 v31, v[216:219] offset:6144
    ds_write_b128 v31, v[220:223] offset:7168
    s_cmp_lg_u32 s71, 0
    s_cbranch_scc1 Lfl_40
    buffer_load_dword v22, v24, s[40:43], s28 offen sc1
Lfl_40:
    ds_write_b128 v31, v[224:227] offset:8192
    ds_write_b128 v31, v[228:231] offset:9216
    ds_write_b128 v31, v[232:235] offset:10240
    ds_write_b128 v31, v[236:239] offset:11264
    s_mov_b32 exec_hi, 0
    ds_write_b128 v31, v[240:243] offset:12288
    s_mov_b32 exec_hi, -1
    s_waitcnt lgkmcnt(0)
    s_branch L_wob2
L_wob1:
    s_cmp_lg_u32 s71, 0
    s_cbranch_scc1 Lfl_41
    buffer_load_dword v22, v24, s[40:43], s28 offen sc1
Lfl_41:
L_wob2:
    s_cmp_lg_u32 s71, 0
    s_cbranch_scc1 Lp2d_43
    s_mov_b32 s48, 0
Lp2_42:
    s_waitcnt vmcnt(0)
    v_cmp_ne_u32 vcc, s78, v22
    s_cbranch_vccz Lp2d_43
    buffer_load_dword v22, v24, s[40:43], s28 offen sc1
    s_add_u32 s48, s48, 1
    s_cmp_lt_u32 s48, 0x20000
    s_cbranch_scc1 Lp2_42
Lp2d_43:
    s_barrier
    buffer_load_dwordx4 v[32:35], v4, s[40:43], s95 offen offset:0 sc1
    buffer_load_dwordx4 v[36:39], v4, s[40:43], s95 offen offset:1024 sc1
    buffer_load_dwordx4 v[40:43], v4, s[40:43], s95 offen offset:2048 sc1
    buffer_load_dwordx4 v[44:47], v4, s[40:43], s95 offen offset:3072 sc1
    s_add_u32 s95, s95, 4096
    buffer_load_dwordx4 v[48:51], v4, s[40:43], s95 offen offset:0 sc1
    buffer_load_dwordx4 v[52:55], v4, s[40:43], s95 offen offset:1024 sc1
    buffer_load_dwordx4 v[56:59], v4, s[40:43], s95 offen offset:2048 sc1
    buffer_load_dwordx4 v[60:63], v4, s[40:43], s95 offen offset:3072 sc1
    s_add_u32 s95, s95, 4096
    ds_read_b128 a[0:3], v4 offset:0
    ds_read_b128 a[4:7], v4 offset:1024
    ds_read_b128 a[8:11], v4 offset:2048
    ds_read_b128 a[12:15], v4 offset:3072
    ds_read_b128 a[16:19], v4 offset:4096
    ds_read_b128 a[20:23], v4 offset:5120
    ds_read_b128 a[24:27], v4 offset:6144
    ds_read_b128 a[28:31], v4 offset:7168
    s_waitcnt lgkmcnt(6)
    s_waitcnt vmcnt(7)
    v_mfma_f32_16x16x32_bf16 v[112:115], a[0:3], v[32:35], 0
    ds_read_b128 a[32:35], v4 offset:8192
    buffer_load_dwordx4 v[64:67], v4, s[40:43], s95 offen offset:0 sc1
    v_mfma_f32_16x16x32_bf16 v[116:119], a[4:7], v[32:35], 0
    ds_read_b128 a[36:39], v4 offset:9216
    s_waitcnt lgkmcnt(6)
    v_mfma_f32_16x16x32_bf16 v[120:123], a[8:11], v[32:35], 0
    ds_read_b128 a[0:3], v4 offset:10240
    v_mfma_f32_16x16x32_bf16 v[124:127], a[12:15], v[32:35], 0
    ds_read_b128 a[4:7], v4 offset:11264
    s_waitcnt lgkmcnt(6)
    v_mfma_f32_16x16x32_bf16 v[128:131], a[16:19], v[32:35], 0
    ds_read_b128 a[8:11], v4 offset:12288
    s_waitcnt vmcnt(7)
    v_mfma_f32_16x16x32_bf16 v[112:115], a[20:23], v[36:39], v[112:115]
    ds_read_b128 a[12:15], v4 offset:13312
    buffer_load_dwordx4 v[68:71], v4, s[40:43], s95 offen offset:1024 sc1
    s_waitcnt lgkmcnt(6)
    v_mfma_f32_16x16x32_bf16 v[116:119], a[24:27], v[36:39], v[116:119]
    ds_read_b128 a[16:19], v4 offset:14336
    v_mfma_f32_16x16x32_bf16 v[120:123], a[28:31], v[36:39], v[120:123]
    ds_read_b128 a[20:23], v4 offset:15360
    s_waitcnt lgkmcnt(6)
    v_mfma_f32_16x16x32_bf16 v[124:127], a[32:35], v[36:39], v[124:127]
    ds_read_b128 a[24:27], v4 offset:16384
    v_mfma_f32_16x16x32_bf16 v[128:131], a[36:39], v[36:39], v[128:131]
    ds_read_b128 a[28:31], v4 offset:17408
    s_waitcnt lgkmcnt(6)
    s_waitcnt vmcnt(7)
    v_mfma_f32_16x16x32_bf16 v[112:115], a[0:3], v[40:43], v[112:115]
    ds_read_b128 a[32:35], v4 offset:18432
    buffer_load_dwordx4 v[72:75], v4, s[40:43], s95 offen offset:2048 sc1
    v_mfma_f32_16x16x32_bf16 v[116:119], a[4:7], v[40:43], v[116:119]
    ds_read_b128 a[36:39], v4 offset:19456
    s_waitcnt lgkmcnt(6)
    v_mfma_f32_16x16x32_bf16 v[120:123], a[8:11], v[40:43], v[120:123]
    ds_read_b128 a[0:3], v4 offset:20480
    v_mfma_f32_16x16x32_bf16 v[124:127], a[12:15], v[40:43], v[124:127]
    ds_read_b128 a[4:7], v4 offset:21504
    s_waitcnt lgkmcnt(6)
    v_mfma_f32_16x16x32_bf16 v[128:131], a[16:19], v[40:43], v[128:131]
    ds_read_b128 a[8:11], v4 offset:22528
    s_waitcnt vmcnt(7)
    v_mfma_f32_16x16x32_bf16 v[112:115], a[20:23], v[44:47], v[112:115]
    ds_read_b128 a[12:15], v4 offset:23552
    buffer_load_dwordx4 v[76:79], v4, s[40:43], s95 offen offset:3072 sc1
    s_add_u32 s95, s95, 4096
    s_waitcnt lgkmcnt(6)
    v_mfma_f32_16x16x32_bf16 v[116:119], a[24:27], v[44:47], v[116:119]
    ds_read_b128 a[16:19], v4 offset:24576
    v_mfma_f32_16x16x32_bf16 v[120:123], a[28:31], v[44:47], v[120:123]
    ds_read_b128 a[20:23], v4 offset:25600
    s_waitcnt lgkmcnt(6)
    v_mfma_f32_16x16x32_bf16 v[124:127], a[32:35], v[44:47], v[124:127]
    ds_read_b128 a[24:27], v4 offset:26624
    v_mfma_f32_16x16x32_bf16 v[128:131], a[36:39], v[44:47], v[128:131]
    ds_read_b128 a[28:31], v4 offset:27648
    s_waitcnt lgkmcnt(6)
    s_waitcnt vmcnt(7)
    v_mfma_f32_16x16x32_bf16 v[112:115], a[0:3], v[48:51], v[112:115]
    ds_read_b128 a[32:35], v4 offset:28672
    buffer_load_dwordx4 v[80:83], v4, s[40:43], s95 offen offset:0 sc1
    v_mfma_f32_16x16x32_bf16 v[116:119], a[4:7], v[48:51], v[116:119]
    ds_read_b128 a[36:39], v4 offset:29696
    s_waitcnt lgkmcnt(6)
    v_mfma_f32_16x16x32_bf16 v[120:123], a[8:11], v[48:51], v[120:123]
    ds_read_b128 a[0:3], v4 offset:30720
    v_mfma_f32_16x16x32_bf16 v[124:127], a[12:15], v[48:51], v[124:127]
    ds_read_b128 a[4:7], v4 offset:31744
    s_waitcnt lgkmcnt(6)
    v_mfma_f32_16x16x32_bf16 v[128:131], a[16:19], v[48:51], v[128:131]
    ds_read_b128 a[8:11], v4 offset:32768
    s_waitcnt vmcnt(7)
    v_mfma_f32_16x16x32_bf16 v[112:115], a[20:23], v[52:55], v[112:115]
    ds_read_b128 a[12:15], v4 offset:33792
    buffer_load_dwordx4 v[84:87], v4, s[40:43], s95 offen offset:1024 sc1
    s_waitcnt lgkmcnt(6)
    v_mfma_f32_16x16x32_bf16 v[116:119], a[24:27], v[52:55], v[116:119]
    ds_read_b128 a[16:19], v4 offset:34816
    v_mfma_f32_16x16x32_bf16 v[120:123], a[28:31], v[52:55], v[120:123]
    ds_read_b128 a[20:23], v4 offset:35840
    s_waitcnt lgkmcnt(6)
    v_mfma_f32_16x16x32_bf16 v[124:127], a[32:35], v[52:55], v[124:127]
    ds_read_b128 a[24:27], v4 offset:36864
    v_mfma_f32_16x16x32_bf16 v[128:131], a[36:39], v[52:55], v[128:131]
    ds_read_b128 a[28:31], v4 offset:37888
    s_waitcnt lgkmcnt(6)
    s_waitcnt vmcnt(7)
    v_mfma_f32_16x16x32_bf16 v[112:115], a[0:3], v[56:59], v[112:115]
    ds_read_b128 a[32:35], v4 offset:38912
    buffer_load_dwordx4 v[88:91], v4, s[40:43], s95 offen offset:2048 sc1
    v_mfma_f32_16x16x32_bf16 v[116:119], a[4:7], v[56:59], v[116:119]
    ds_read_b128 a[36:39], v4 offset:39936
    s_waitcnt lgkmcnt(6)
    v_mfma_f32_16x16x32_bf16 v[120:123], a[8:11], v[56:59], v[120:123]
    ds_read_b128 a[0:3], v4 offset:40960
    v_mfma_f32_16x16x32_bf16 v[124:127], a[12:15], v[56:59], v[124:127]
    ds_read_b128 a[4:7], v4 offset:41984
    s_waitcnt lgkmcnt(6)
    v_mfma_f32_16x16x32_bf16 v[128:131], a[16:19], v[56:59], v[128:131]
    ds_read_b128 a[8:11], v4 offset:43008
    s_waitcnt vmcnt(7)
    v_mfma_f32_16x16x32_bf16 v[112:115], a[20:23], v[60:63], v[112:115]
    ds_read_b128 a[12:15], v4 offset:44032
    buffer_load_dwordx4 v[92:95], v4, s[40:43], s95 offen offset:3072 sc1
    s_add_u32 s95, s95, 4096
    s_waitcnt lgkmcnt(6)
    v_mfma_f32_16x16x32_bf16 v[116:119], a[24:27], v[60:63], v[116:119]
    ds_read_b128 a[16:19], v4 offset:45056
    v_mfma_f32_16x16x32_bf16 v[120:123], a[28:31], v[60:63], v[120:123]
    ds_read_b128 a[20:23], v4 offset:46080
    s_waitcnt lgkmcnt(6)
    v_mfma_f32_16x16x32_bf16 v[124:127], a[32:35], v[60:63], v[124:127]
    ds_read_b128 a[24:27], v4 offset:47104
    v_mfma_f32_16x16x32_bf16 v[128:131], a[36:39], v[60:63], v[128:131]
    ds_read_b128 a[28:31], v4 offset:48128
    s_waitcnt lgkmcnt(6)
    s_waitcnt vmcnt(7)
    v_mfma_f32_16x16x32_bf16 v[112:115], a[0:3], v[64:67], v[112:115]
    ds_read_b128 a[32:35], v4 offset:49152
    buffer_load_dwordx4 v[96:99], v4, s[40:43], s95 offen offset:0 sc1
    v_mfma_f32_16x16x32_bf16 v[116:119], a[4:7], v[64:67], v[116:119]
    ds_read_b128 a[36:39], v4 offset:50176
    s_waitcnt lgkmcnt(6)
    v_mfma_f32_16x16x32_bf16 v[120:123], a[8:11], v[64:67], v[120:123]
    ds_read_b128 a[0:3], v5 offset:0
    v_mfma_f32_16x16x32_bf16 v[124:127], a[12:15], v[64:67], v[124:127]
    ds_read_b128 a[4:7], v5 offset:1024
    s_waitcnt lgkmcnt(6)
    v_mfma_f32_16x16x32_bf16 v[128:131], a[16:19], v[64:67], v[128:131]
    ds_read_b128 a[8:11], v5 offset:2048
    s_waitcnt vmcnt(7)
    v_mfma_f32_16x16x32_bf16 v[112:115], a[20:23], v[68:71], v[112:115]
    ds_read_b128 a[12:15], v5 offset:3072
    buffer_load_dwordx4 v[100:103], v4, s[40:43], s95 offen offset:1024 sc1
    s_waitcnt lgkmcnt(6)
    v_mfma_f32_16x16x32_bf16 v[116:119], a[24:27], v[68:71], v[116:119]
    ds_read_b128 a[16:19], v5 offset:4096
    v_mfma_f32_16x16x32_bf16 v[120:123], a[28:31], v[68:71], v[120:123]
    ds_read_b128 a[20:23], v5 offset:5120
    s_waitcnt lgkmcnt(6)
    v_mfma_f32_16x16x32_bf16 v[124:127], a[32:35], v[68:71], v[124:127]
    ds_read_b128 a[24:27], v5 offset:6144
    v_mfma_f32_16x16x32_bf16 v[128:131], a[36:39], v[68:71], v[128:131]
    ds_read_b128 a[28:31], v5 offset:7168
    s_waitcnt lgkmcnt(6)
    s_waitcnt vmcnt(7)
    v_mfma_f32_16x16x32_bf16 v[112:115], a[0:3], v[72:75], v[112:115]
    ds_read_b128 a[32:35], v5 offset:8192
    buffer_load_dwordx4 v[104:107], v4, s[40:43], s95 offen offset:2048 sc1
    v_mfma_f32_16x16x32_bf16 v[116:119], a[4:7], v[72:75], v[116:119]
    ds_read_b128 a[36:39], v5 offset:9216
    s_waitcnt lgkmcnt(6)
    v_mfma_f32_16x16x32_bf16 v[120:123], a[8:11], v[72:75], v[120:123]
    ds_read_b128 a[0:3], v5 offset:10240
    v_mfma_f32_16x16x32_bf16 v[124:127], a[12:15], v[72:75], v[124:127]
    ds_read_b128 a[4:7], v5 offset:11264
    s_waitcnt lgkmcnt(6)
    v_mfma_f32_16x16x32_bf16 v[128:131], a[16:19], v[72:75], v[128:131]
    ds_read_b128 a[8:11], v5 offset:12288
    s_waitcnt vmcnt(7)
    v_mfma_f32_16x16x32_bf16 v[112:115], a[20:23], v[76:79], v[112:115]
    ds_read_b128 a[12:15], v5 offset:13312
    buffer_load_dwordx4 v[108:111], v4, s[40:43], s95 offen offset:3072 sc1
    s_waitcnt lgkmcnt(6)
    v_mfma_f32_16x16x32_bf16 v[116:119], a[24:27], v[76:79], v[116:119]
    ds_read_b128 a[16:19], v5 offset:14336
    v_mfma_f32_16x16x32_bf16 v[120:123], a[28:31], v[76:79], v[120:123]
    ds_read_b128 a[20:23], v5 offset:15360
    s_waitcnt lgkmcnt(6)
    v_mfma_f32_16x16x32_bf16 v[124:127], a[32:35], v[76:79], v[124:127]
    ds_read_b128 a[24:27], v5 offset:16384
    v_mfma_f32_16x16x32_bf16 v[128:131], a[36:39], v[76:79], v[128:131]
    ds_read_b128 a[28:31], v5 offset:17408
    s_waitcnt lgkmcnt(6)
    s_waitcnt vmcnt(7)
    v_mfma_f32_16x16x32_bf16 v[112:115], a[0:3], v[80:83], v[112:115]
    ds_read_b128 a[32:35], v5 offset:18432
    v_mfma_f32_16x16x32_bf16 v[116:119], a[4:7], v[80:83], v[116:119]
    ds_read_b128 a[36:39], v5 offset:19456
    s_waitcnt lgkmcnt(6)
    v_mfma_f32_16x16x32_bf16 v[120:123], a[8:11], v[80:83], v[120:123]
    ds_read_b128 a[0:3], v5 offset:20480
    v_mfma_f32_16x16x32_bf16 v[124:127], a[12:15], v[80:83], v[124:127]
    ds_read_b128 a[4:7], v5 offset:21504
    s_waitcnt lgkmcnt(6)
    v_mfma_f32_16x16x32_bf16 v[128:131], a[16:19], v[80:83], v[128:131]
    ds_read_b128 a[8:11], v5 offset:22528
    s_waitcnt vmcnt(6)
    v_mfma_f32_16x16x32_bf16 v[112:115], a[20:23], v[84:87], v[112:115]
    ds_read_b128 a[12:15], v5 offset:23552
    s_waitcnt lgkmcnt(6)
    v_mfma_f32_16x16x32_bf16 v[116:119], a[24:27], v[84:87], v[116:119]
    ds_read_b128 a[16:19], v5 offset:24576
    v_mfma_f32_16x16x32_bf16 v[120:123], a[28:31], v[84:87], v[120:123]
    ds_read_b128 a[20:23], v5 offset:25600
    s_waitcnt lgkmcnt(6)
    v_mfma_f32_16x16x32_bf16 v[124:127], a[32:35], v[84:87], v[124:127]
    ds_read_b128 a[24:27], v5 offset:26624
    v_mfma_f32_16x16x32_bf16 v[128:131], a[36:39], v[84:87], v[128:131]
    ds_read_b128 a[28:31], v5 offset:27648
    s_waitcnt lgkmcnt(6)
    s_waitcnt vmcnt(5)
    v_mfma_f32_16x16x32_bf16 v[112:115], a[0:3], v[88:91], v[112:115]
    ds_read_b128 a[32:35], v5 offset:28672
    v_mfma_f32_16x16x32_bf16 v[116:119], a[4:7], v[88:91], v[116:119]
    ds_read_b128 a[36:39], v5 offset:29696
    s_waitcnt lgkmcnt(6)
    v_mfma_f32_16x16x32_bf16 v[120:123], a[8:11], v[88:91], v[120:123]
    ds_read_b128 a[0:3], v5 offset:30720
    v_mfma_f32_16x16x32_bf16 v[124:127], a[12:15], v[88:91], v[124:127]
    ds_read_b128 a[4:7], v5 offset:31744
    s_waitcnt lgkmcnt(6)
    v_mfma_f32_16x16x32_bf16 v[128:131], a[16:19], v[88:91], v[128:131]
    ds_read_b128 a[8:11], v5 offset:32768
    s_waitcnt vmcnt(4)
    v_mfma_f32_16x16x32_bf16 v[112:115], a[20:23], v[92:95], v[112:115]
    ds_read_b128 a[12:15], v5 offset:33792
    s_waitcnt lgkmcnt(6)
    v_mfma_f32_16x16x32_bf16 v[116:119], a[24:27], v[92:95], v[116:119]
    ds_read_b128 a[16:19], v5 offset:34816
    v_mfma_f32_16x16x32_bf16 v[120:123], a[28:31], v[92:95], v[120:123]
    ds_read_b128 a[20:23], v5 offset:35840
    s_waitcnt lgkmcnt(6)
    v_mfma_f32_16x16x32_bf16 v[124:127], a[32:35], v[92:95], v[124:127]
    ds_read_b128 a[24:27], v5 offset:36864
    v_mfma_f32_16x16x32_bf16 v[128:131], a[36:39], v[92:95], v[128:131]
    ds_read_b128 a[28:31], v5 offset:37888
    s_waitcnt lgkmcnt(6)
    s_waitcnt vmcnt(3)
    v_mfma_f32_16x16x32_bf16 v[112:115], a[0:3], v[96:99], v[112:115]
    ds_read_b128 a[32:35], v5 offset:38912
    v_mfma_f32_16x16x32_bf16 v[116:119], a[4:7], v[96:99], v[116:119]
    ds_read_b128 a[36:39], v5 offset:39936
    s_waitcnt lgkmcnt(6)
    v_mfma_f32_16x16x32_bf16 v[120:123], a[8:11], v[96:99], v[120:123]
    ds_read_b128 a[0:3], v5 offset:40960
    v_mfma_f32_16x16x32_bf16 v[124:127], a[12:15], v[96:99], v[124:127]
    ds_read_b128 a[4:7], v5 offset:41984
    s_waitcnt lgkmcnt(6)
    v_mfma_f32_16x16x32_bf16 v[128:131], a[16:19], v[96:99], v[128:131]
    ds_read_b128 a[8:11], v5 offset:43008
    s_waitcnt vmcnt(2)
    v_mfma_f32_16x16x32_bf16 v[112:115], a[20:23], v[100:103], v[112:115]
    ds_read_b128 a[12:15], v5 offset:44032
    s_waitcnt lgkmcnt(6)
    v_mfma_f32_16x16x32_bf16 v[116:119], a[24:27], v[100:103], v[116:119]
    ds_read_b128 a[16:19], v5 offset:45056
    v_mfma_f32_16x16x32_bf16 v[120:123], a[28:31], v[100:103], v[120:123]
    ds_read_b128 a[20:23], v5 offset:46080
    s_waitcnt lgkmcnt(6)
    v_mfma_f32_16x16x32_bf16 v[124:127], a[32:35], v[100:103], v[124:127]
    ds_read_b128 a[24:27], v5 offset:47104
    v_mfma_f32_16x16x32_bf16 v[128:131], a[36:39], v[100:103], v[128:131]
    ds_read_b128 a[28:31], v5 offset:48128
    s_waitcnt lgkmcnt(6)
    s_waitcnt vmcnt(1)
    v_mfma_f32_16x16x32_bf16 v[112:115], a[0:3], v[104:107], v[112:115]
    ds_read_b128 a[32:35], v5 offset:49152
    v_mfma_f32_16x16x32_bf16 v[116:119], a[4:7], v[104:107], v[116:119]
    ds_read_b128 a[36:39], v5 offset:50176
    s_waitcnt lgkmcnt(6)
    v_mfma_f32_16x16x32_bf16 v[120:123], a[8:11], v[104:107], v[120:123]
    v_mfma_f32_16x16x32_bf16 v[124:127], a[12:15], v[104:107], v[124:127]
    s_waitcnt lgkmcnt(4)
    v_mfma_f32_16x16x32_bf16 v[128:131], a[16:19], v[104:107], v[128:131]
    s_waitcnt vmcnt(0)
    v_mfma_f32_16x16x32_bf16 v[112:115], a[20:23], v[108:111], v[112:115]
    s_waitcnt lgkmcnt(2)
    v_mfma_f32_16x16x32_bf16 v[116:119], a[24:27], v[108:111], v[116:119]
    v_mfma_f32_16x16x32_bf16 v[120:123], a[28:31], v[108:111], v[120:123]
    s_waitcnt lgkmcnt(0)
    v_mfma_f32_16x16x32_bf16 v[124:127], a[32:35], v[108:111], v[124:127]
    v_mfma_f32_16x16x32_bf16 v[128:131], a[36:39], v[108:111], v[128:131]
    s_cmp_eq_u32 s77, 1
    s_cbranch_scc1 L_final
    v_accvgpr_read_b32 v30, a201
    v_accvgpr_read_b32 v31, a202
    v_accvgpr_read_b32 v150, a246
    v_accvgpr_read_b32 v151, a247
    v_accvgpr_read_b32 v152, a248
    v_accvgpr_read_b32 v153, a249
    v_accvgpr_read_b32 v154, a250
    v_accvgpr_read_b32 v155, a251
    v_accvgpr_read_b32 v156, a252
    v_accvgpr_read_b32 v157, a253
    v_accvgpr_read_b32 v158, a254
    v_accvgpr_read_b32 v159, a255
    v_lshlrev_b32 v24, 16, v150
    v_and_b32 v25, 0xffff0000, v150
    v_pk_add_f32 v[112:113], v[112:113], v[24:25]
    v_cvt_pk_bf16_f32 v150, v112, v113
    v_lshlrev_b32 v26, 16, v151
    v_and_b32 v27, 0xffff0000, v151
    v_pk_add_f32 v[114:115], v[114:115], v[26:27]
    v_cvt_pk_bf16_f32 v151, v114, v115
    v_lshlrev_b32 v24, 16, v152
    v_and_b32 v25, 0xffff0000, v152
    v_pk_add_f32 v[116:117], v[116:117], v[24:25]
    v_cvt_pk_bf16_f32 v152, v116, v117
    v_lshlrev_b32 v26, 16, v153
    v_and_b32 v27, 0xffff0000, v153
    v_pk_add_f32 v[118:119], v[118:119], v[26:27]
    v_cvt_pk_bf16_f32 v153, v118, v119
    v_lshlrev_b32 v24, 16, v154
    v_and_b32 v25, 0xffff0000, v154
    v_pk_add_f32 v[120:121], v[120:121], v[24:25]
    v_cvt_pk_bf16_f32 v154, v120, v121
    v_lshlrev_b32 v26, 16, v155
    v_and_b32 v27, 0xffff0000, v155
    v_pk_add_f32 v[122:123], v[122:123], v[26:27]
    v_cvt_pk_bf16_f32 v155, v122, v123
    v_lshlrev_b32 v24, 16, v156
    v_and_b32 v25, 0xffff0000, v156
    v_pk_add_f32 v[124:125], v[124:125], v[24:25]
    v_cvt_pk_bf16_f32 v156, v124, v125
    v_lshlrev_b32 v26, 16, v157
    v_and_b32 v27, 0xffff0000, v157
    v_pk_add_f32 v[126:127], v[126:127], v[26:27]
    v_cvt_pk_bf16_f32 v157, v126, v127
    v_lshlrev_b32 v24, 16, v158
    v_and_b32 v25, 0xffff0000, v158
    v_pk_add_f32 v[128:129], v[128:129], v[24:25]
    v_cvt_pk_bf16_f32 v158, v128, v129
    v_lshlrev_b32 v26, 16, v159
    v_and_b32 v27, 0xffff0000, v159
    v_pk_add_f32 v[130:131], v[130:131], v[26:27]
    v_cvt_pk_bf16_f32 v159, v130, v131
    s_cmp_eq_u32 s79, 0
    s_cbranch_scc1 Lsg_44
    buffer_store_dwordx4 v[150:153], v4, s[40:43], s20 offen
    buffer_store_dwordx4 v[154:157], v4, s[40:43], s20 offen offset:1024
    buffer_store_dwordx2 v[158:159], v30, s[40:43], s21 offen
    s_branch Lse_45
Lsg_44:
    buffer_store_dwordx4 v[150:153], v4, s[40:43], s20 offen sc1
    buffer_store_dwordx4 v[154:157], v4, s[40:43], s20 offen offset:1024 sc1
    buffer_store_dwordx2 v[158:159], v30, s[40:43], s21 offen sc1
Lse_45:
    v_pk_add_f32 v[24:25], v[112:113], v[114:115]
    v_pk_mul_f32 v[26:27], v[112:113], v[112:113]
    v_pk_fma_f32 v[26:27], v[114:115], v[114:115], v[26:27]
    v_pk_add_f32 v[24:25], v[24:25], v[116:117]
    v_pk_fma_f32 v[26:27], v[116:117], v[116:117], v[26:27]
    v_pk_add_f32 v[24:25], v[24:25], v[118:119]
    v_pk_fma_f32 v[26:27], v[118:119], v[118:119], v[26:27]
    v_pk_add_f32 v[24:25], v[24:25], v[120:121]
    v_pk_fma_f32 v[26:27], v[120:121], v[120:121], v[26:27]
    v_pk_add_f32 v[24:25], v[24:25], v[122:123]
    v_pk_fma_f32 v[26:27], v[122:123], v[122:123], v[26:27]
    v_pk_add_f32 v[24:25], v[24:25], v[124:125]
    v_pk_fma_f32 v[26:27], v[124:125], v[124:125], v[26:27]
    v_pk_add_f32 v[24:25], v[24:25], v[126:127]
    v_pk_fma_f32 v[26:27], v[126:127], v[126:127], v[26:27]
    v_pk_add_f32 v[24:25], v[24:25], v[128:129]
    v_pk_fma_f32 v[26:27], v[128:129], v[128:129], v[26:27]
    v_pk_add_f32 v[24:25], v[24:25], v[130:131]
    v_pk_fma_f32 v[26:27], v[130:131], v[130:131], v[26:27]
    v_add_f32 v28, v24, v25
    v_add_f32 v29, v26, v27
    v_mov_b32 v24, v28
    v_mov_b32 v25, v29
    s_nop 0
    v_permlane16_swap_b32 v28, v24
    v_permlane16_swap_b32 v29, v25
    v_add_f32 v28, v28, v24
    v_add_f32 v29, v29, v25
    v_mov_b32 v24, v28
    v_mov_b32 v25, v29
    s_nop 0
    v_permlane32_swap_b32 v28, v24
    v_permlane32_swap_b32 v29, v25
    v_add_f32 v28, v28, v24
    v_add_f32 v29, v29, v25
    s_cmp_eq_u32 s79, 0
    s_cbranch_scc1 Lsg_46
    s_mov_b64 exec, 0xffff
    buffer_store_dwordx2 v[28:29], v31, s[40:43], s22 offen
    s_mov_b64 exec, -1
    s_branch Lse_47
Lsg_46:
    s_mov_b64 exec, 0xffff
    buffer_store_dwordx2 v[28:29], v31, s[40:43], s22 offen sc1
    s_mov_b64 exec, -1
Lse_47:
    v_accvgpr_write_b32 a246, v150
    v_accvgpr_write_b32 a247, v151
    v_accvgpr_write_b32 a248, v152
    v_accvgpr_write_b32 a249, v153
    v_accvgpr_write_b32 a250, v154
    v_accvgpr_write_b32 a251, v155
    v_accvgpr_write_b32 a252, v156
    v_accvgpr_write_b32 a253, v157
    v_accvgpr_write_b32 a254, v158
    v_accvgpr_write_b32 a255, v159
    s_xor_b32 s78, s78, 0x80000000
    s_add_u32 s92, s92, 262144
    s_mov_b32 s77, 1
    s_waitcnt vmcnt(0)
    s_barrier
    s_cmp_lg_u32 s71, 0
    s_cbranch_scc1 Lfl_48
    v_mov_b32 v22, s78
    s_mov_b64 exec, 1
    s_cmp_eq_u32 s79, 0
    s_cbranch_scc1 Lsg_49
    buffer_store_dword v22, off, s[40:43], s29
    s_branch Lse_50
Lsg_49:
    buffer_store_dword v22, off, s[40:43], s29 sc1
Lse_50:
    s_mov_b64 exec, -1
Lfl_48:
    s_branch L_pair
L_final:
    v_mul_u32_u24 v30, 1280, v2
    v_lshl_add_u32 v30, v3, 3, v30
    s_mul_i32 s49, s81, 20480
    s_mul_i32 s69, s76, 160
    s_add_u32 s49, s49, s69
    v_accvgpr_read_b32 v150, a246
    v_accvgpr_read_b32 v151, a247
    v_accvgpr_read_b32 v152, a248
    v_accvgpr_read_b32 v153, a249
    v_accvgpr_read_b32 v154, a250
    v_accvgpr_read_b32 v155, a251
    v_accvgpr_read_b32 v156, a252
    v_accvgpr_read_b32 v157, a253
    v_accvgpr_read_b32 v158, a254
    v_accvgpr_read_b32 v159, a255
    v_lshlrev_b32 v24, 16, v150
    v_and_b32 v25, 0xffff0000, v150
    v_pk_add_f32 v[112:113], v[112:113], v[24:25]
    v_cvt_pk_bf16_f32 v150, v112, v113
    v_lshlrev_b32 v26, 16, v151
    v_and_b32 v27, 0xffff0000, v151
    v_pk_add_f32 v[114:115], v[114:115], v[26:27]
    v_cvt_pk_bf16_f32 v151, v114, v115
    v_lshlrev_b32 v24, 16, v152
    v_and_b32 v25, 0xffff0000, v152
    v_pk_add_f32 v[116:117], v[116:117], v[24:25]
    v_cvt_pk_bf16_f32 v152, v116, v117
    v_lshlrev_b32 v26, 16, v153
    v_and_b32 v27, 0xffff0000, v153
    v_pk_add_f32 v[118:119], v[118:119], v[26:27]
    v_cvt_pk_bf16_f32 v153, v118, v119
    v_lshlrev_b32 v24, 16, v154
    v_and_b32 v25, 0xffff0000, v154
    v_pk_add_f32 v[120:121], v[120:121], v[24:25]
    v_cvt_pk_bf16_f32 v154, v120, v121
    v_lshlrev_b32 v26, 16, v155
    v_and_b32 v27, 0xffff0000, v155
    v_pk_add_f32 v[122:123], v[122:123], v[26:27]
    v_cvt_pk_bf16_f32 v155, v122, v123
    v_lshlrev_b32 v24, 16, v156
    v_and_b32 v25, 0xffff0000, v156
    v_pk_add_f32 v[124:125], v[124:125], v[24:25]
    v_cvt_pk_bf16_f32 v156, v124, v125
    v_lshlrev_b32 v26, 16, v157
    v_and_b32 v27, 0xffff0000, v157
    v_pk_add_f32 v[126:127], v[126:127], v[26:27]
    v_cvt_pk_bf16_f32 v157, v126, v127
    v_lshlrev_b32 v24, 16, v158
    v_and_b32 v25, 0xffff0000, v158
    v_pk_add_f32 v[128:129], v[128:129], v[24:25]
    v_cvt_pk_bf16_f32 v158, v128, v129
    v_lshlrev_b32 v26, 16, v159
    v_and_b32 v27, 0xffff0000, v159
    v_pk_add_f32 v[130:131], v[130:131], v[26:27]
    v_cvt_pk_bf16_f32 v159, v130, v131
    buffer_store_dwordx2 v[150:151], v30, s[36:39], s49 offen offset:0
    buffer_store_dwordx2 v[152:153], v30, s[36:39], s49 offen offset:32
    buffer_store_dwordx2 v[154:155], v30, s[36:39], s49 offen offset:64
    buffer_store_dwordx2 v[156:157], v30, s[36:39], s49 offen offset:96
    buffer_store_dwordx2 v[158:159], v30, s[36:39], s49 offen offset:128
L_fin:
L_end:
    s_endpgm
L_stg0:
    s_cmp_eq_u32 s95, 0
    s_cbranch_scc0 L_stg0x
    buffer_load_dwordx4 v[132:135], v21, s[40:43], 0 offen sc1
    s_cmp_lg_u32 s77, 0
    s_cbranch_scc1 L_stgb0
    s_add_u32 s51, s50, 0
    buffer_load_dwordx4 v[192:195], v4, s[40:43], s51 offen
    s_add_u32 s51, s50, 1024
    buffer_load_dwordx4 v[196:199], v4, s[40:43], s51 offen
    s_add_u32 s51, s50, 2048
    buffer_load_dwordx4 v[200:203], v4, s[40:43], s51 offen
    s_add_u32 s51, s50, 3072
    buffer_load_dwordx4 v[204:207], v4, s[40:43], s51 offen
    s_add_u32 s51, s50, 4096
    buffer_load_dwordx4 v[208:211], v4, s[40:43], s51 offen
    s_add_u32 s51, s50, 5120
    buffer_load_dwordx4 v[212:215], v4, s[40:43], s51 offen
    s_add_u32 s51, s50, 6144
    buffer_load_dwordx4 v[216:219], v4, s[40:43], s51 offen
    s_branch L_stgb0
L_stg0x:
    s_add_u32 s51, s50, 52224
    buffer_load_dwordx4 v[248:251], v4, s[40:43], s51 offen
    s_add_u32 s51, s50, 53248
    buffer_load_dwordx4 v[252:255], v4, s[40:43], s51 offen
    s_add_u32 s51, s50, 54272
    buffer_load_dwordx4 v[160:163], v4, s[40:43], s51 offen
    s_add_u32 s51, s50, 55296
    buffer_load_dwordx4 v[164:167], v4, s[40:43], s51 offen
    s_add_u32 s51, s50, 56320
    buffer_load_dwordx4 v[168:171], v4, s[40:43], s51 offen
    s_add_u32 s51, s50, 57344
    buffer_load_dwordx4 v[172:175], v4, s[40:43], s51 offen
    s_add_u32 s51, s50, 58368
    buffer_load_dwordx4 a[216:219], v4, s[40:43], s51 offen
    s_branch L_stgb0
L_stg1:
    s_cmp_eq_u32 s95, 0
    s_cbranch_scc0 L_stg1x
    s_add_u32 s51, s50, 7168
    buffer_load_dwordx4 v[220:223], v4, s[40:43], s51 offen
    s_add_u32 s51, s50, 8192
    buffer_load_dwordx4 v[224:227], v4, s[40:43], s51 offen
    s_add_u32 s51, s50, 9216
    buffer_load_dwordx4 v[228:231], v4, s[40:43], s51 offen
    s_add_u32 s51, s50, 10240
    buffer_load_dwordx4 v[232:235], v4, s[40:43], s51 offen
    s_add_u32 s51, s50, 11264
    buffer_load_dwordx4 v[236:239], v4, s[40:43], s51 offen
    s_add_u32 s51, s50, 12288
    buffer_load_dwordx4 v[240:243], v4, s[40:43], s51 offen
    s_add_u32 s51, s50, 51200
    buffer_load_dwordx4 v[244:247], v4, s[40:43], s51 offen
    s_branch L_stgb1
L_stg1x:
    s_add_u32 s51, s50, 59392
    buffer_load_dwordx4 a[220:223], v4, s[40:43], s51 offen
    s_add_u32 s51, s50, 60416
    buffer_load_dwordx4 a[224:227], v4, s[40:43], s51 offen
    s_add_u32 s51, s50, 61440
    buffer_load_dwordx4 a[228:231], v4, s[40:43], s51 offen
    s_add_u32 s51, s50, 62464
    buffer_load_dwordx4 a[232:235], v4, s[40:43], s51 offen
    s_add_u32 s51, s50, 63488
    buffer_load_dwordx4 a[236:239], v4, s[40:43], s51 offen
    s_branch L_stgb1
L_g2chk:
    s_mov_b32 s48, 0
    s_waitcnt vmcnt(7)
    s_cmp_eq_u32 s77, 0
    s_cbranch_scc1 L_g2c1
L_g2c0:
    s_waitcnt vmcnt(0)
L_g2c1:
    v_xor_b32 v132, s78, v132
    v_xor_b32 v133, s78, v133
    v_xor_b32 v134, s78, v134
    v_xor_b32 v135, s78, v135
    v_or3_b32 v132, v132, v133, v134
    v_or_b32 v132, v132, v135
    v_cmp_ne_u32 vcc, 0, v132
    s_cbranch_vccz L_g2back
    s_sleep 4
    buffer_load_dwordx4 v[132:135], v21, s[40:43], 0 offen sc1
    s_add_u32 s48, s48, 1
    s_cmp_lt_u32 s48, 0x20000
    s_cbranch_scc1 L_g2c0
    s_branch L_g2back
L_codeend:
L_fallback:
    v_mov_b32 v96, 0xff800000
    v_mov_b32 v97, 0xff800000
    v_mov_b32 v98, 0xff800000
    v_mov_b32 v99, 0xff800000
    s_mov_b32 s96, 0
    s_mov_b32 s95, 0
L_fb_loop:
    s_lshl_b32 s58, s96, 13
    s_lshl_b32 s59, s96, 11
    s_lshl_b32 s60, s96, 14
    s_add_u32 s58, s58, s92
    s_add_u32 s59, s59, s92
    s_add_u32 s60, s60, s92
    s_add_u32 s61, s60, 4096
    s_add_u32 s96, s96, 1
    s_and_b32 s96, s96, 7
    buffer_load_dwordx4 a[100:103], v19, s[40:43], s59 offen offset:0
    buffer_load_dwordx4 a[104:107], v19, s[40:43], s59 offen offset:512
    buffer_load_dwordx4 a[84:87], v18, s[40:43], s58 offen offset:0
    buffer_load_dwordx4 a[88:91], v18, s[40:43], s58 offen offset:1024
    buffer_load_dwordx4 a[92:95], v18, s[40:43], s58 offen offset:2048
    buffer_load_dwordx4 a[96:99], v18, s[40:43], s58 offen offset:3072
    s_waitcnt vmcnt(0)
    v_mfma_f32_32x32x4_2b_bf16 v[32:63], a[100:101], a[80:81], 0
    s_nop 15
    s_nop 1
    v_mfma_f32_32x32x16_bf16 v[32:47], a[84:87], a[64:67], v[32:47]
    v_mfma_f32_32x32x16_bf16 v[48:63], a[84:87], a[68:71], v[48:63]
    s_nop 10
    v_max3_f32 v96, v32, v33, v96
    v_max3_f32 v96, v34, v35, v96
    v_max3_f32 v96, v36, v37, v96
    v_max3_f32 v96, v38, v39, v96
    v_max3_f32 v96, v40, v41, v96
    v_max3_f32 v96, v42, v43, v96
    v_max3_f32 v96, v44, v45, v96
    v_max3_f32 v96, v46, v47, v96
    v_max3_f32 v97, v48, v49, v97
    v_max3_f32 v97, v50, v51, v97
    v_max3_f32 v97, v52, v53, v97
    v_max3_f32 v97, v54, v55, v97
    v_max3_f32 v97, v56, v57, v97
    v_max3_f32 v97, v58, v59, v97
    v_max3_f32 v97, v60, v61, v97
    v_max3_f32 v97, v62, v63, v97
    v_mfma_f32_32x32x4_2b_bf16 v[64:95], a[100:101], a[82:83], 0
    s_nop 15
    s_nop 1
    v_mfma_f32_32x32x16_bf16 v[64:79], a[84:87], a[72:75], v[64:79]
    v_mfma_f32_32x32x16_bf16 v[80:95], a[84:87], a[76:79], v[80:95]
    s_nop 10
    v_max3_f32 v98, v64, v65, v98
    v_max3_f32 v98, v66, v67, v98
    v_max3_f32 v98, v68, v69, v98
    v_max3_f32 v98, v70, v71, v98
    v_max3_f32 v98, v72, v73, v98
    v_max3_f32 v98, v74, v75, v98
    v_max3_f32 v98, v76, v77, v98
    v_max3_f32 v98, v78, v79, v98
    v_max3_f32 v99, v80, v81, v99
    v_max3_f32 v99, v82, v83, v99
    v_max3_f32 v99, v84, v85, v99
    v_max3_f32 v99, v86, v87, v99
    v_max3_f32 v99, v88, v89, v99
    v_max3_f32 v99, v90, v91, v99
    v_max3_f32 v99, v92, v93, v99
    v_max3_f32 v99, v94, v95, v99
    v_mfma_f32_32x32x4_2b_bf16 v[32:63], a[102:103], a[80:81], 0
    s_nop 15
    s_nop 1
    v_mfma_f32_32x32x16_bf16 v[32:47], a[88:91], a[64:67], v[32:47]
    v_mfma_f32_32x32x16_bf16 v[48:63], a[88:91], a[68:71], v[48:63]
    s_nop 10
    v_max3_f32 v96, v32, v33, v96
    v_max3_f32 v96, v34, v35, v96
    v_max3_f32 v96, v36, v37, v96
    v_max3_f32 v96, v38, v39, v96
    v_max3_f32 v96, v40, v41, v96
    v_max3_f32 v96, v42, v43, v96
    v_max3_f32 v96, v44, v45, v96
    v_max3_f32 v96, v46, v47, v96
    v_max3_f32 v97, v48, v49, v97
    v_max3_f32 v97, v50, v51, v97
    v_max3_f32 v97, v52, v53, v97
    v_max3_f32 v97, v54, v55, v97
    v_max3_f32 v97, v56, v57, v97
    v_max3_f32 v97, v58, v59, v97
    v_max3_f32 v97, v60, v61, v97
    v_max3_f32 v97, v62, v63, v97
    v_mfma_f32_32x32x4_2b_bf16 v[64:95], a[102:103], a[82:83], 0
    s_nop 15
    s_nop 1
    v_mfma_f32_32x32x16_bf16 v[64:79], a[88:91], a[72:75], v[64:79]
    v_mfma_f32_32x32x16_bf16 v[80:95], a[88:91], a[76:79], v[80:95]
    s_nop 10
    v_max3_f32 v98, v64, v65, v98
    v_max3_f32 v98, v66, v67, v98
    v_max3_f32 v98, v68, v69, v98
    v_max3_f32 v98, v70, v71, v98
    v_max3_f32 v98, v72, v73, v98
    v_max3_f32 v98, v74, v75, v98
    v_max3_f32 v98, v76, v77, v98
    v_max3_f32 v98, v78, v79, v98
    v_max3_f32 v99, v80, v81, v99
    v_max3_f32 v99, v82, v83, v99
    v_max3_f32 v99, v84, v85, v99
    v_max3_f32 v99, v86, v87, v99
    v_max3_f32 v99, v88, v89, v99
    v_max3_f32 v99, v90, v91, v99
    v_max3_f32 v99, v92, v93, v99
    v_max3_f32 v99, v94, v95, v99
    v_mfma_f32_32x32x4_2b_bf16 v[32:63], a[104:105], a[80:81], 0
    s_nop 15
    s_nop 1
    v_mfma_f32_32x32x16_bf16 v[32:47], a[92:95], a[64:67], v[32:47]
    v_mfma_f32_32x32x16_bf16 v[48:63], a[92:95], a[68:71], v[48:63]
    s_nop 10
    v_max3_f32 v96, v32, v33, v96
    v_max3_f32 v96, v34, v35, v96
    v_max3_f32 v96, v36, v37, v96
    v_max3_f32 v96, v38, v39, v96
    v_max3_f32 v96, v40, v41, v96
    v_max3_f32 v96, v42, v43, v96
    v_max3_f32 v96, v44, v45, v96
    v_max3_f32 v96, v46, v47, v96
    v_max3_f32 v97, v48, v49, v97
    v_max3_f32 v97, v50, v51, v97
    v_max3_f32 v97, v52, v53, v97
    v_max3_f32 v97, v54, v55, v97
    v_max3_f32 v97, v56, v57, v97
    v_max3_f32 v97, v58, v59, v97
    v_max3_f32 v97, v60, v61, v97
    v_max3_f32 v97, v62, v63, v97
    v_mfma_f32_32x32x4_2b_bf16 v[64:95], a[104:105], a[82:83], 0
    s_nop 15
    s_nop 1
    v_mfma_f32_32x32x16_bf16 v[64:79], a[92:95], a[72:75], v[64:79]
    v_mfma_f32_32x32x16_bf16 v[80:95], a[92:95], a[76:79], v[80:95]
    s_nop 10
    v_max3_f32 v98, v64, v65, v98
    v_max3_f32 v98, v66, v67, v98
    v_max3_f32 v98, v68, v69, v98
    v_max3_f32 v98, v70, v71, v98
    v_max3_f32 v98, v72, v73, v98
    v_max3_f32 v98, v74, v75, v98
    v_max3_f32 v98, v76, v77, v98
    v_max3_f32 v98, v78, v79, v98
    v_max3_f32 v99, v80, v81, v99
    v_max3_f32 v99, v82, v83, v99
    v_max3_f32 v99, v84, v85, v99
    v_max3_f32 v99, v86, v87, v99
    v_max3_f32 v99, v88, v89, v99
    v_max3_f32 v99, v90, v91, v99
    v_max3_f32 v99, v92, v93, v99
    v_max3_f32 v99, v94, v95, v99
    v_mfma_f32_32x32x4_2b_bf16 v[32:63], a[106:107], a[80:81], 0
    s_nop 15
    s_nop 1
    v_mfma_f32_32x32x16_bf16 v[32:47], a[96:99], a[64:67], v[32:47]
    v_mfma_f32_32x32x16_bf16 v[48:63], a[96:99], a[68:71], v[48:63]
    s_nop 10
    v_max3_f32 v96, v32, v33, v96
    v_max3_f32 v96, v34, v35, v96
    v_max3_f32 v96, v36, v37, v96
    v_max3_f32 v96, v38, v39, v96
    v_max3_f32 v96, v40, v41, v96
    v_max3_f32 v96, v42, v43, v96
    v_max3_f32 v96, v44, v45, v96
    v_max3_f32 v96, v46, v47, v96
    v_max3_f32 v97, v48, v49, v97
    v_max3_f32 v97, v50, v51, v97
    v_max3_f32 v97, v52, v53, v97
    v_max3_f32 v97, v54, v55, v97
    v_max3_f32 v97, v56, v57, v97
    v_max3_f32 v97, v58, v59, v97
    v_max3_f32 v97, v60, v61, v97
    v_max3_f32 v97, v62, v63, v97
    v_mfma_f32_32x32x4_2b_bf16 v[64:95], a[106:107], a[82:83], 0
    s_nop 15
    s_nop 1
    v_mfma_f32_32x32x16_bf16 v[64:79], a[96:99], a[72:75], v[64:79]
    v_mfma_f32_32x32x16_bf16 v[80:95], a[96:99], a[76:79], v[80:95]
    s_nop 10
    v_max3_f32 v98, v64, v65, v98
    v_max3_f32 v98, v66, v67, v98
    v_max3_f32 v98, v68, v69, v98
    v_max3_f32 v98, v70, v71, v98
    v_max3_f32 v98, v72, v73, v98
    v_max3_f32 v98, v74, v75, v98
    v_max3_f32 v98, v76, v77, v98
    v_max3_f32 v98, v78, v79, v98
    v_max3_f32 v99, v80, v81, v99
    v_max3_f32 v99, v82, v83, v99
    v_max3_f32 v99, v84, v85, v99
    v_max3_f32 v99, v86, v87, v99
    v_max3_f32 v99, v88, v89, v99
    v_max3_f32 v99, v90, v91, v99
    v_max3_f32 v99, v92, v93, v99
    v_max3_f32 v99, v94, v95, v99
    s_add_u32 s95, s95, 1
    s_cmp_lt_u32 s95, 8
    s_cbranch_scc1 L_fb_loop
    v_mov_b32 v100, v96
    v_mov_b32 v101, v97
    v_mov_b32 v102, v98
    v_mov_b32 v103, v99
    v_permlane32_swap_b32 v96, v100
    v_permlane32_swap_b32 v97, v101
    v_permlane32_swap_b32 v98, v102
    v_permlane32_swap_b32 v99, v103
    v_max_f32 v96, v96, v100
    v_max_f32 v97, v97, v101
    v_max_f32 v98, v98, v102
    v_max_f32 v99, v99, v103
    s_lshl_b32 s49, s71, 10
    s_xor_b32 s50, s49, 2048
    v_add_u32 v25, s50, v6
    v_add_u32 v24, s49, v6
    ds_write_b128 v24, v[96:99]
    s_waitcnt lgkmcnt(0)
    s_barrier
    ds_read_b128 v[100:103], v25
    s_waitcnt lgkmcnt(0)
    s_barrier
    v_max_f32 v96, v96, v100
    v_max_f32 v97, v97, v101
    v_max_f32 v98, v98, v102
    v_max_f32 v99, v99, v103
    v_sub_f32 v192, 0, v96
    v_sub_f32 v193, 0, v96
    v_sub_f32 v194, 0, v96
    v_sub_f32 v195, 0, v96
    v_sub_f32 v196, 0, v96
    v_sub_f32 v197, 0, v96
    v_sub_f32 v198, 0, v96
    v_sub_f32 v199, 0, v96
    v_sub_f32 v200, 0, v96
    v_sub_f32 v201, 0, v96
    v_sub_f32 v202, 0, v96
    v_sub_f32 v203, 0, v96
    v_sub_f32 v204, 0, v96
    v_sub_f32 v205, 0, v96
    v_sub_f32 v206, 0, v96
    v_sub_f32 v207, 0, v96
    v_sub_f32 v208, 0, v97
    v_sub_f32 v209, 0, v97
    v_sub_f32 v210, 0, v97
    v_sub_f32 v211, 0, v97
    v_sub_f32 v212, 0, v97
    v_sub_f32 v213, 0, v97
    v_sub_f32 v214, 0, v97
    v_sub_f32 v215, 0, v97
    v_sub_f32 v216, 0, v97
    v_sub_f32 v217, 0, v97
    v_sub_f32 v218, 0, v97
    v_sub_f32 v219, 0, v97
    v_sub_f32 v220, 0, v97
    v_sub_f32 v221, 0, v97
    v_sub_f32 v222, 0, v97
    v_sub_f32 v223, 0, v97
    v_sub_f32 v224, 0, v98
    v_sub_f32 v225, 0, v98
    v_sub_f32 v226, 0, v98
    v_sub_f32 v227, 0, v98
    v_sub_f32 v228, 0, v98
    v_sub_f32 v229, 0, v98
    v_sub_f32 v230, 0, v98
    v_sub_f32 v231, 0, v98
    v_sub_f32 v232, 0, v98
    v_sub_f32 v233, 0, v98
    v_sub_f32 v234, 0, v98
    v_sub_f32 v235, 0, v98
    v_sub_f32 v236, 0, v98
    v_sub_f32 v237, 0, v98
    v_sub_f32 v238, 0, v98
    v_sub_f32 v239, 0, v98
    v_sub_f32 v240, 0, v99
    v_sub_f32 v241, 0, v99
    v_sub_f32 v242, 0, v99
    v_sub_f32 v243, 0, v99
    v_sub_f32 v244, 0, v99
    v_sub_f32 v245, 0, v99
    v_sub_f32 v246, 0, v99
    v_sub_f32 v247, 0, v99
    v_sub_f32 v248, 0, v99
    v_sub_f32 v249, 0, v99
    v_sub_f32 v250, 0, v99
    v_sub_f32 v251, 0, v99
    v_sub_f32 v252, 0, v99
    v_sub_f32 v253, 0, v99
    v_sub_f32 v254, 0, v99
    v_sub_f32 v255, 0, v99
    v_pk_mul_f32 v[176:177], 0, 0
    v_pk_mul_f32 v[178:179], 0, 0
    v_pk_mul_f32 v[180:181], 0, 0
    v_pk_mul_f32 v[182:183], 0, 0
    v_pk_mul_f32 v[184:185], 0, 0
    v_pk_mul_f32 v[186:187], 0, 0
    v_pk_mul_f32 v[188:189], 0, 0
    v_pk_mul_f32 v[190:191], 0, 0
    v_mfma_f32_32x32x16_bf16 a[0:15], v[176:179], v[176:179], 0
    v_mfma_f32_32x32x16_bf16 a[16:31], v[176:179], v[176:179], 0
    v_mfma_f32_32x32x16_bf16 a[32:47], v[176:179], v[176:179], 0
    v_mfma_f32_32x32x16_bf16 a[48:63], v[176:179], v[176:179], 0
    s_mov_b32 s96, s72
    s_lshl_b32 s58, s96, 13
    s_lshl_b32 s59, s96, 11
    s_lshl_b32 s60, s96, 14
    s_add_u32 s58, s58, s92
    s_add_u32 s59, s59, s92
    s_add_u32 s60, s60, s92
    s_add_u32 s61, s60, 4096
    s_add_u32 s96, s96, 1
    s_and_b32 s96, s96, 7
    buffer_load_dwordx4 a[100:103], v19, s[40:43], s59 offen offset:0
    buffer_load_dwordx4 a[104:107], v19, s[40:43], s59 offen offset:512
    buffer_load_dwordx4 a[84:87], v18, s[40:43], s58 offen offset:0
    buffer_load_dwordx4 a[88:91], v18, s[40:43], s58 offen offset:1024
    buffer_load_dwordx4 a[92:95], v18, s[40:43], s58 offen offset:2048
    buffer_load_dwordx4 a[96:99], v18, s[40:43], s58 offen offset:3072
    buffer_load_dwordx4 a[108:111], v20, s[40:43], s60 offen offset:0
    buffer_load_dwordx4 a[112:115], v20, s[40:43], s60 offen offset:1024
    s_sub_u32 s65, s65, 24576
    s_sub_u32 s66, s66, 24576
    s_mov_b32 s91, 1
    v_accvgpr_write_b32 a188, 0
    v_accvgpr_write_b32 a189, 0
    v_accvgpr_write_b32 a190, 0
    v_accvgpr_write_b32 a191, 0
    v_accvgpr_write_b32 a192, 0
    v_accvgpr_write_b32 a193, 0
    v_accvgpr_write_b32 a194, 0
    v_accvgpr_write_b32 a195, 0
    s_add_u32 m0, s66, 24576
    s_add_u32 s57, s65, 24576
    s_mov_b32 s95, 0
    s_waitcnt vmcnt(5) lgkmcnt(0)
    v_mfma_f32_32x32x4_2b_bf16 v[32:63], a[100:101], a[80:81], v[192:223]
    buffer_load_dwordx4 a[116:119], v20, s[40:43], s60 offen offset:2048 sc1
    buffer_load_dwordx4 a[120:123], v20, s[40:43], s60 offen offset:3072 sc1
    buffer_load_dwordx4 a[124:127], v20, s[40:43], s61 offen offset:0 sc1
    buffer_load_dwordx4 a[128:131], v20, s[40:43], s61 offen offset:1024 sc1
    buffer_load_dwordx4 a[132:135], v20, s[40:43], s61 offen offset:2048 sc1
    buffer_load_dwordx4 a[136:139], v20, s[40:43], s61 offen offset:3072 sc1
    buffer_load_dwordx4 v4, s[40:43], s57 offen lds
    s_nop 10
    v_mfma_f32_32x32x16_bf16 v[32:47], a[84:87], a[64:67], v[32:47]
    v_mfma_f32_32x32x16_bf16 v[48:63], a[84:87], a[68:71], v[48:63]
    s_waitcnt vmcnt(9)
    s_nop 9
.p2align 6
L_att_loop2:
    v_mfma_f32_32x32x4_2b_bf16 v[64:95], a[100:101], a[82:83], v[224:255]
    s_lshl_b32 s58, s96, 13
    v_exp_f32 v32, v32
    v_exp_f32 v33, v33
    v_exp_f32 v34, v34
    v_exp_f32 v35, v35
    v_exp_f32 v36, v36
    v_exp_f32 v37, v37
    v_exp_f32 v38, v38
    v_exp_f32 v39, v39
    v_cvt_pk_bf16_f32 v96, v32, v33
    v_cvt_pk_bf16_f32 v97, v34, v35
    v_cvt_pk_bf16_f32 v98, v36, v37
    v_cvt_pk_bf16_f32 v99, v38, v39
    v_mfma_f32_32x32x16_bf16 a[32:47], a[188:191], v[176:179], a[32:47]
    s_lshl_b32 s59, s96, 11
    v_exp_f32 v40, v40
    v_exp_f32 v41, v41
    v_exp_f32 v42, v42
    v_exp_f32 v43, v43
    v_cvt_pk_bf16_f32 v100, v40, v41
    v_cvt_pk_bf16_f32 v101, v42, v43
    v_mfma_f32_32x32x16_bf16 a[48:63], a[188:191], v[184:187], a[48:63]
    s_lshl_b32 s60, s96, 14
    v_exp_f32 v44, v44
    v_exp_f32 v45, v45
    v_exp_f32 v46, v46
    v_exp_f32 v47, v47
    v_cvt_pk_bf16_f32 v102, v44, v45
    v_cvt_pk_bf16_f32 v103, v46, v47
    v_mfma_f32_32x32x16_bf16 v[64:79], a[84:87], a[72:75], v[64:79]
    s_add_u32 s58, s58, s92
    v_exp_f32 v48, v48
    v_exp_f32 v49, v49
    v_exp_f32 v50, v50
    v_exp_f32 v51, v51
    v_cvt_pk_bf16_f32 v104, v48, v49
    v_cvt_pk_bf16_f32 v105, v50, v51
    v_mfma_f32_32x32x16_bf16 a[32:47], a[192:195], v[180:183], a[32:47]
    s_add_u32 s59, s59, s92
    v_exp_f32 v52, v52
    v_exp_f32 v53, v53
    v_exp_f32 v54, v54
    v_exp_f32 v55, v55
    v_cvt_pk_bf16_f32 v106, v52, v53
    v_cvt_pk_bf16_f32 v107, v54, v55
    v_mfma_f32_32x32x16_bf16 v[80:95], a[84:87], a[76:79], v[80:95]
    s_add_u32 s60, s60, s92
    v_exp_f32 v56, v56
    v_exp_f32 v57, v57
    v_exp_f32 v58, v58
    v_exp_f32 v59, v59
    v_cvt_pk_bf16_f32 v108, v56, v57
    v_cvt_pk_bf16_f32 v109, v58, v59
    v_mfma_f32_32x32x16_bf16 a[48:63], a[192:195], v[188:191], a[48:63]
    s_add_u32 s61, s60, 4096
    v_exp_f32 v60, v60
    v_exp_f32 v61, v61
    v_exp_f32 v62, v62
    v_exp_f32 v63, v63
    v_cvt_pk_bf16_f32 v110, v60, v61
    v_cvt_pk_bf16_f32 v111, v62, v63
    v_mfma_f32_32x32x4_2b_bf16 v[32:63], a[102:103], a[80:81], v[192:223]
    s_waitcnt vmcnt(0)
    v_exp_f32 v64, v64
    v_exp_f32 v65, v65
    v_exp_f32 v66, v66
    v_exp_f32 v67, v67
    v_exp_f32 v68, v68
    v_exp_f32 v69, v69
    v_exp_f32 v70, v70
    v_exp_f32 v71, v71
    v_cvt_pk_bf16_f32 v176, v64, v65
    v_cvt_pk_bf16_f32 v177, v66, v67
    v_cvt_pk_bf16_f32 v178, v68, v69
    v_cvt_pk_bf16_f32 v179, v70, v71
    v_mfma_f32_32x32x16_bf16 a[0:15], a[108:111], v[96:99], a[0:15]
    v_exp_f32 v72, v72
    v_exp_f32 v73, v73
    v_exp_f32 v74, v74
    v_exp_f32 v75, v75
    v_cvt_pk_bf16_f32 v180, v72, v73
    v_cvt_pk_bf16_f32 v181, v74, v75
    v_mfma_f32_32x32x16_bf16 a[16:31], a[108:111], v[104:107], a[16:31]
    s_mov_b32 m0, s66
    v_exp_f32 v76, v76
    v_exp_f32 v77, v77
    v_exp_f32 v78, v78
    v_exp_f32 v79, v79
    v_cvt_pk_bf16_f32 v182, v76, v77
    v_cvt_pk_bf16_f32 v183, v78, v79
    v_mfma_f32_32x32x16_bf16 v[32:47], a[88:91], a[64:67], v[32:47]
    v_exp_f32 v80, v80
    v_exp_f32 v81, v81
    v_exp_f32 v82, v82
    v_exp_f32 v83, v83
    v_cvt_pk_bf16_f32 v184, v80, v81
    v_cvt_pk_bf16_f32 v185, v82, v83
    v_mfma_f32_32x32x16_bf16 a[0:15], a[112:115], v[100:103], a[0:15]
    v_exp_f32 v84, v84
    v_exp_f32 v85, v85
    v_exp_f32 v86, v86
    v_exp_f32 v87, v87
    v_cvt_pk_bf16_f32 v186, v84, v85
    v_cvt_pk_bf16_f32 v187, v86, v87
    v_mfma_f32_32x32x16_bf16 v[48:63], a[88:91], a[68:71], v[48:63]
    v_exp_f32 v88, v88
    v_exp_f32 v89, v89
    v_exp_f32 v90, v90
    v_exp_f32 v91, v91
    v_cvt_pk_bf16_f32 v188, v88, v89
    v_cvt_pk_bf16_f32 v189, v90, v91
    v_mfma_f32_32x32x16_bf16 a[16:31], a[112:115], v[108:111], a[16:31]
    v_exp_f32 v92, v92
    v_exp_f32 v93, v93
    v_exp_f32 v94, v94
    v_exp_f32 v95, v95
    v_cvt_pk_bf16_f32 v190, v92, v93
    v_cvt_pk_bf16_f32 v191, v94, v95
    v_mfma_f32_32x32x4_2b_bf16 v[64:95], a[102:103], a[82:83], v[224:255]
    v_exp_f32 v32, v32
    v_exp_f32 v33, v33
    v_exp_f32 v34, v34
    v_exp_f32 v35, v35
    v_exp_f32 v36, v36
    v_exp_f32 v37, v37
    v_exp_f32 v38, v38
    v_exp_f32 v39, v39
    v_cvt_pk_bf16_f32 v96, v32, v33
    v_cvt_pk_bf16_f32 v97, v34, v35
    v_cvt_pk_bf16_f32 v98, v36, v37
    v_cvt_pk_bf16_f32 v99, v38, v39
    v_mfma_f32_32x32x16_bf16 a[32:47], a[108:111], v[176:179], a[32:47]
    v_exp_f32 v40, v40
    v_exp_f32 v41, v41
    v_exp_f32 v42, v42
    v_exp_f32 v43, v43
    v_cvt_pk_bf16_f32 v100, v40, v41
    v_cvt_pk_bf16_f32 v101, v42, v43
    v_mfma_f32_32x32x16_bf16 a[48:63], a[108:111], v[184:187], a[48:63]
    v_exp_f32 v44, v44
    v_exp_f32 v45, v45
    v_exp_f32 v46, v46
    v_exp_f32 v47, v47
    v_cvt_pk_bf16_f32 v102, v44, v45
    v_cvt_pk_bf16_f32 v103, v46, v47
    v_mfma_f32_32x32x16_bf16 v[64:79], a[88:91], a[72:75], v[64:79]
    v_exp_f32 v48, v48
    v_exp_f32 v49, v49
    v_exp_f32 v50, v50
    v_exp_f32 v51, v51
    v_cvt_pk_bf16_f32 v104, v48, v49
    v_cvt_pk_bf16_f32 v105, v50, v51
    v_mfma_f32_32x32x16_bf16 a[32:47], a[112:115], v[180:183], a[32:47]
    v_exp_f32 v52, v52
    v_exp_f32 v53, v53
    v_exp_f32 v54, v54
    v_exp_f32 v55, v55
    v_cvt_pk_bf16_f32 v106, v52, v53
    v_cvt_pk_bf16_f32 v107, v54, v55
    v_mfma_f32_32x32x16_bf16 v[80:95], a[88:91], a[76:79], v[80:95]
    v_exp_f32 v56, v56
    v_exp_f32 v57, v57
    v_exp_f32 v58, v58
    v_exp_f32 v59, v59
    v_cvt_pk_bf16_f32 v108, v56, v57
    v_cvt_pk_bf16_f32 v109, v58, v59
    v_mfma_f32_32x32x16_bf16 a[48:63], a[112:115], v[188:191], a[48:63]
    v_exp_f32 v60, v60
    v_exp_f32 v61, v61
    v_exp_f32 v62, v62
    v_exp_f32 v63, v63
    v_cvt_pk_bf16_f32 v110, v60, v61
    v_cvt_pk_bf16_f32 v111, v62, v63
    v_mfma_f32_32x32x4_2b_bf16 v[32:63], a[104:105], a[80:81], v[192:223]
    v_exp_f32 v64, v64
    v_exp_f32 v65, v65
    v_exp_f32 v66, v66
    v_exp_f32 v67, v67
    v_exp_f32 v68, v68
    v_exp_f32 v69, v69
    v_exp_f32 v70, v70
    v_exp_f32 v71, v71
    v_cvt_pk_bf16_f32 v176, v64, v65
    v_cvt_pk_bf16_f32 v177, v66, v67
    v_cvt_pk_bf16_f32 v178, v68, v69
    v_cvt_pk_bf16_f32 v179, v70, v71
    v_mfma_f32_32x32x16_bf16 a[0:15], a[116:119], v[96:99], a[0:15]
    buffer_load_dwordx4 a[156:159], v19, s[40:43], s59 offen offset:0
    buffer_load_dwordx4 a[160:163], v19, s[40:43], s59 offen offset:512
    buffer_load_dwordx4 a[140:143], v18, s[40:43], s58 offen offset:0
    buffer_load_dwordx4 a[144:147], v18, s[40:43], s58 offen offset:1024
    buffer_load_dwordx4 a[148:151], v18, s[40:43], s58 offen offset:2048
    buffer_load_dwordx4 a[152:155], v18, s[40:43], s58 offen offset:3072
    v_exp_f32 v72, v72
    v_exp_f32 v73, v73
    v_exp_f32 v74, v74
    v_exp_f32 v75, v75
    v_cvt_pk_bf16_f32 v180, v72, v73
    v_cvt_pk_bf16_f32 v181, v74, v75
    v_mfma_f32_32x32x16_bf16 a[16:31], a[116:119], v[104:107], a[16:31]
    v_exp_f32 v76, v76
    v_exp_f32 v77, v77
    v_exp_f32 v78, v78
    v_exp_f32 v79, v79
    v_cvt_pk_bf16_f32 v182, v76, v77
    v_cvt_pk_bf16_f32 v183, v78, v79
    v_mfma_f32_32x32x16_bf16 v[32:47], a[92:95], a[64:67], v[32:47]
    v_exp_f32 v80, v80
    v_exp_f32 v81, v81
    v_exp_f32 v82, v82
    v_exp_f32 v83, v83
    v_cvt_pk_bf16_f32 v184, v80, v81
    v_cvt_pk_bf16_f32 v185, v82, v83
    v_mfma_f32_32x32x16_bf16 a[0:15], a[120:123], v[100:103], a[0:15]
    v_exp_f32 v84, v84
    v_exp_f32 v85, v85
    v_exp_f32 v86, v86
    v_exp_f32 v87, v87
    v_cvt_pk_bf16_f32 v186, v84, v85
    v_cvt_pk_bf16_f32 v187, v86, v87
    v_mfma_f32_32x32x16_bf16 v[48:63], a[92:95], a[68:71], v[48:63]
    v_exp_f32 v88, v88
    v_exp_f32 v89, v89
    v_exp_f32 v90, v90
    v_exp_f32 v91, v91
    v_cvt_pk_bf16_f32 v188, v88, v89
    v_cvt_pk_bf16_f32 v189, v90, v91
    v_mfma_f32_32x32x16_bf16 a[16:31], a[120:123], v[108:111], a[16:31]
    v_exp_f32 v92, v92
    v_exp_f32 v93, v93
    v_exp_f32 v94, v94
    v_exp_f32 v95, v95
    v_cvt_pk_bf16_f32 v190, v92, v93
    v_cvt_pk_bf16_f32 v191, v94, v95
    v_mfma_f32_32x32x4_2b_bf16 v[64:95], a[104:105], a[82:83], v[224:255]
    v_exp_f32 v32, v32
    v_exp_f32 v33, v33
    v_exp_f32 v34, v34
    v_exp_f32 v35, v35
    v_exp_f32 v36, v36
    v_exp_f32 v37, v37
    v_exp_f32 v38, v38
    v_exp_f32 v39, v39
    v_cvt_pk_bf16_f32 v96, v32, v33
    v_cvt_pk_bf16_f32 v97, v34, v35
    v_cvt_pk_bf16_f32 v98, v36, v37
    v_cvt_pk_bf16_f32 v99, v38, v39
    v_mfma_f32_32x32x16_bf16 a[32:47], a[116:119], v[176:179], a[32:47]
    buffer_load_dwordx4 a[164:167], v20, s[40:43], s60 offen offset:0
    buffer_load_dwordx4 a[168:171], v20, s[40:43], s60 offen offset:1024
    buffer_load_dwordx4 a[172:175], v20, s[40:43], s60 offen offset:2048
    buffer_load_dwordx4 a[176:179], v20, s[40:43], s60 offen offset:3072
    v_exp_f32 v40, v40
    v_exp_f32 v41, v41
    v_exp_f32 v42, v42
    v_exp_f32 v43, v43
    v_cvt_pk_bf16_f32 v100, v40, v41
    v_cvt_pk_bf16_f32 v101, v42, v43
    v_mfma_f32_32x32x16_bf16 a[48:63], a[116:119], v[184:187], a[48:63]
    v_exp_f32 v44, v44
    v_exp_f32 v45, v45
    v_exp_f32 v46, v46
    v_exp_f32 v47, v47
    v_cvt_pk_bf16_f32 v102, v44, v45
    v_cvt_pk_bf16_f32 v103, v46, v47
    v_mfma_f32_32x32x16_bf16 v[64:79], a[92:95], a[72:75], v[64:79]
    v_exp_f32 v48, v48
    v_exp_f32 v49, v49
    v_exp_f32 v50, v50
    v_exp_f32 v51, v51
    v_cvt_pk_bf16_f32 v104, v48, v49
    v_cvt_pk_bf16_f32 v105, v50, v51
    v_mfma_f32_32x32x16_bf16 a[32:47], a[120:123], v[180:183], a[32:47]
    v_exp_f32 v52, v52
    v_exp_f32 v53, v53
    v_exp_f32 v54, v54
    v_exp_f32 v55, v55
    v_cvt_pk_bf16_f32 v106, v52, v53
    v_cvt_pk_bf16_f32 v107, v54, v55
    v_mfma_f32_32x32x16_bf16 v[80:95], a[92:95], a[76:79], v[80:95]
    v_exp_f32 v56, v56
    v_exp_f32 v57, v57
    v_exp_f32 v58, v58
    v_exp_f32 v59, v59
    v_cvt_pk_bf16_f32 v108, v56, v57
    v_cvt_pk_bf16_f32 v109, v58, v59
    v_mfma_f32_32x32x16_bf16 a[48:63], a[120:123], v[188:191], a[48:63]
    v_exp_f32 v60, v60
    v_exp_f32 v61, v61
    v_exp_f32 v62, v62
    v_exp_f32 v63, v63
    v_cvt_pk_bf16_f32 v110, v60, v61
    v_cvt_pk_bf16_f32 v111, v62, v63
    v_mfma_f32_32x32x4_2b_bf16 v[32:63], a[106:107], a[80:81], v[192:223]
    v_exp_f32 v64, v64
    v_exp_f32 v65, v65
    v_exp_f32 v66, v66
    v_exp_f32 v67, v67
    v_exp_f32 v68, v68
    v_exp_f32 v69, v69
    v_exp_f32 v70, v70
    v_exp_f32 v71, v71
    v_cvt_pk_bf16_f32 v176, v64, v65
    v_cvt_pk_bf16_f32 v177, v66, v67
    v_cvt_pk_bf16_f32 v178, v68, v69
    v_cvt_pk_bf16_f32 v179, v70, v71
    v_mfma_f32_32x32x16_bf16 a[0:15], a[124:127], v[96:99], a[0:15]
    buffer_load_dwordx4 a[180:183], v20, s[40:43], s61 offen offset:0
    buffer_load_dwordx4 a[184:187], v20, s[40:43], s61 offen offset:1024
    buffer_load_dwordx4 a[188:191], v20, s[40:43], s61 offen offset:2048
    buffer_load_dwordx4 a[192:195], v20, s[40:43], s61 offen offset:3072
    buffer_load_dwordx4 v4, s[40:43], s65 offen offset:0 lds
    v_exp_f32 v72, v72
    v_exp_f32 v73, v73
    v_exp_f32 v74, v74
    v_exp_f32 v75, v75
    v_cvt_pk_bf16_f32 v180, v72, v73
    v_cvt_pk_bf16_f32 v181, v74, v75
    v_mfma_f32_32x32x16_bf16 a[16:31], a[124:127], v[104:107], a[16:31]
    v_exp_f32 v76, v76
    v_exp_f32 v77, v77
    v_exp_f32 v78, v78
    v_exp_f32 v79, v79
    v_cvt_pk_bf16_f32 v182, v76, v77
    v_cvt_pk_bf16_f32 v183, v78, v79
    v_mfma_f32_32x32x16_bf16 v[32:47], a[96:99], a[64:67], v[32:47]
    v_exp_f32 v80, v80
    v_exp_f32 v81, v81
    v_exp_f32 v82, v82
    v_exp_f32 v83, v83
    v_cvt_pk_bf16_f32 v184, v80, v81
    v_cvt_pk_bf16_f32 v185, v82, v83
    v_mfma_f32_32x32x16_bf16 a[0:15], a[128:131], v[100:103], a[0:15]
    v_exp_f32 v84, v84
    v_exp_f32 v85, v85
    v_exp_f32 v86, v86
    v_exp_f32 v87, v87
    v_cvt_pk_bf16_f32 v186, v84, v85
    v_cvt_pk_bf16_f32 v187, v86, v87
    v_mfma_f32_32x32x16_bf16 v[48:63], a[96:99], a[68:71], v[48:63]
    v_exp_f32 v88, v88
    v_exp_f32 v89, v89
    v_exp_f32 v90, v90
    v_exp_f32 v91, v91
    v_cvt_pk_bf16_f32 v188, v88, v89
    v_cvt_pk_bf16_f32 v189, v90, v91
    v_mfma_f32_32x32x16_bf16 a[16:31], a[128:131], v[108:111], a[16:31]
    v_exp_f32 v92, v92
    v_exp_f32 v93, v93
    v_exp_f32 v94, v94
    v_exp_f32 v95, v95
    v_cvt_pk_bf16_f32 v190, v92, v93
    v_cvt_pk_bf16_f32 v191, v94, v95
    v_mfma_f32_32x32x4_2b_bf16 v[64:95], a[106:107], a[82:83], v[224:255]
    v_exp_f32 v32, v32
    v_exp_f32 v33, v33
    v_exp_f32 v34, v34
    v_exp_f32 v35, v35
    v_exp_f32 v36, v36
    v_exp_f32 v37, v37
    v_exp_f32 v38, v38
    v_exp_f32 v39, v39
    v_cvt_pk_bf16_f32 v96, v32, v33
    v_cvt_pk_bf16_f32 v97, v34, v35
    v_cvt_pk_bf16_f32 v98, v36, v37
    v_cvt_pk_bf16_f32 v99, v38, v39
    v_mfma_f32_32x32x16_bf16 a[32:47], a[124:127], v[176:179], a[32:47]
    buffer_load_dwordx4 v4, s[40:43], s65 offen offset:1024 lds
    buffer_load_dwordx4 v4, s[40:43], s65 offen offset:2048 lds
    v_exp_f32 v40, v40
    v_exp_f32 v41, v41
    v_exp_f32 v42, v42
    v_exp_f32 v43, v43
    v_cvt_pk_bf16_f32 v100, v40, v41
    v_cvt_pk_bf16_f32 v101, v42, v43
    v_mfma_f32_32x32x16_bf16 a[48:63], a[124:127], v[184:187], a[48:63]
    v_exp_f32 v44, v44
    v_exp_f32 v45, v45
    v_exp_f32 v46, v46
    v_exp_f32 v47, v47
    v_cvt_pk_bf16_f32 v102, v44, v45
    v_cvt_pk_bf16_f32 v103, v46, v47
    v_mfma_f32_32x32x16_bf16 v[64:79], a[96:99], a[72:75], v[64:79]
    v_exp_f32 v48, v48
    v_exp_f32 v49, v49
    v_exp_f32 v50, v50
    v_exp_f32 v51, v51
    v_cvt_pk_bf16_f32 v104, v48, v49
    v_cvt_pk_bf16_f32 v105, v50, v51
    v_mfma_f32_32x32x16_bf16 a[32:47], a[128:131], v[180:183], a[32:47]
    v_exp_f32 v52, v52
    v_exp_f32 v53, v53
    v_exp_f32 v54, v54
    v_exp_f32 v55, v55
    v_cvt_pk_bf16_f32 v106, v52, v53
    v_cvt_pk_bf16_f32 v107, v54, v55
    v_mfma_f32_32x32x16_bf16 v[80:95], a[96:99], a[76:79], v[80:95]
    v_exp_f32 v56, v56
    v_exp_f32 v57, v57
    v_exp_f32 v58, v58
    v_exp_f32 v59, v59
    v_cvt_pk_bf16_f32 v108, v56, v57
    v_cvt_pk_bf16_f32 v109, v58, v59
    v_mfma_f32_32x32x16_bf16 a[48:63], a[128:131], v[188:191], a[48:63]
    s_waitcnt vmcnt(11)
    v_exp_f32 v60, v60
    v_exp_f32 v61, v61
    v_exp_f32 v62, v62
    v_exp_f32 v63, v63
    v_cvt_pk_bf16_f32 v110, v60, v61
    v_cvt_pk_bf16_f32 v111, v62, v63
    v_mfma_f32_32x32x4_2b_bf16 v[32:63], a[156:157], a[80:81], v[192:223]
    v_exp_f32 v64, v64
    v_exp_f32 v65, v65
    v_exp_f32 v66, v66
    v_exp_f32 v67, v67
    v_exp_f32 v68, v68
    v_exp_f32 v69, v69
    v_exp_f32 v70, v70
    v_exp_f32 v71, v71
    v_cvt_pk_bf16_f32 v176, v64, v65
    v_cvt_pk_bf16_f32 v177, v66, v67
    v_cvt_pk_bf16_f32 v178, v68, v69
    v_cvt_pk_bf16_f32 v179, v70, v71
    v_mfma_f32_32x32x16_bf16 a[0:15], a[132:135], v[96:99], a[0:15]
    s_add_u32 s96, s96, 1
    v_exp_f32 v72, v72
    v_exp_f32 v73, v73
    v_exp_f32 v74, v74
    v_exp_f32 v75, v75
    v_cvt_pk_bf16_f32 v180, v72, v73
    v_cvt_pk_bf16_f32 v181, v74, v75
    v_mfma_f32_32x32x16_bf16 a[16:31], a[132:135], v[104:107], a[16:31]
    s_and_b32 s96, s96, 7
    v_exp_f32 v76, v76
    v_exp_f32 v77, v77
    v_exp_f32 v78, v78
    v_exp_f32 v79, v79
    v_cvt_pk_bf16_f32 v182, v76, v77
    v_cvt_pk_bf16_f32 v183, v78, v79
    v_mfma_f32_32x32x16_bf16 v[32:47], a[140:143], a[64:67], v[32:47]
    s_add_u32 s65, s65, 3072
    v_exp_f32 v80, v80
    v_exp_f32 v81, v81
    v_exp_f32 v82, v82
    v_exp_f32 v83, v83
    v_cvt_pk_bf16_f32 v184, v80, v81
    v_cvt_pk_bf16_f32 v185, v82, v83
    v_mfma_f32_32x32x16_bf16 a[0:15], a[136:139], v[100:103], a[0:15]
    s_add_u32 s66, s66, 3072
    v_exp_f32 v84, v84
    v_exp_f32 v85, v85
    v_exp_f32 v86, v86
    v_exp_f32 v87, v87
    v_cvt_pk_bf16_f32 v186, v84, v85
    v_cvt_pk_bf16_f32 v187, v86, v87
    v_mfma_f32_32x32x16_bf16 v[48:63], a[140:143], a[68:71], v[48:63]
    v_exp_f32 v88, v88
    v_exp_f32 v89, v89
    v_exp_f32 v90, v90
    v_exp_f32 v91, v91
    v_cvt_pk_bf16_f32 v188, v88, v89
    v_cvt_pk_bf16_f32 v189, v90, v91
    v_mfma_f32_32x32x16_bf16 a[16:31], a[136:139], v[108:111], a[16:31]
    v_exp_f32 v92, v92
    v_exp_f32 v93, v93
    v_exp_f32 v94, v94
    v_exp_f32 v95, v95
    v_cvt_pk_bf16_f32 v190, v92, v93
    v_cvt_pk_bf16_f32 v191, v94, v95
    v_mfma_f32_32x32x4_2b_bf16 v[64:95], a[156:157], a[82:83], v[224:255]
    s_lshl_b32 s58, s96, 13
    v_exp_f32 v32, v32
    v_exp_f32 v33, v33
    v_exp_f32 v34, v34
    v_exp_f32 v35, v35
    v_exp_f32 v36, v36
    v_exp_f32 v37, v37
    v_exp_f32 v38, v38
    v_exp_f32 v39, v39
    v_cvt_pk_bf16_f32 v96, v32, v33
    v_cvt_pk_bf16_f32 v97, v34, v35
    v_cvt_pk_bf16_f32 v98, v36, v37
    v_cvt_pk_bf16_f32 v99, v38, v39
    v_mfma_f32_32x32x16_bf16 a[32:47], a[132:135], v[176:179], a[32:47]
    s_lshl_b32 s59, s96, 11
    v_exp_f32 v40, v40
    v_exp_f32 v41, v41
    v_exp_f32 v42, v42
    v_exp_f32 v43, v43
    v_cvt_pk_bf16_f32 v100, v40, v41
    v_cvt_pk_bf16_f32 v101, v42, v43
    v_mfma_f32_32x32x16_bf16 a[48:63], a[132:135], v[184:187], a[48:63]
    s_lshl_b32 s60, s96, 14
    v_exp_f32 v44, v44
    v_exp_f32 v45, v45
    v_exp_f32 v46, v46
    v_exp_f32 v47, v47
    v_cvt_pk_bf16_f32 v102, v44, v45
    v_cvt_pk_bf16_f32 v103, v46, v47
    v_mfma_f32_32x32x16_bf16 v[64:79], a[140:143], a[72:75], v[64:79]
    s_add_u32 s58, s58, s92
    v_exp_f32 v48, v48
    v_exp_f32 v49, v49
    v_exp_f32 v50, v50
    v_exp_f32 v51, v51
    v_cvt_pk_bf16_f32 v104, v48, v49
    v_cvt_pk_bf16_f32 v105, v50, v51
    v_mfma_f32_32x32x16_bf16 a[32:47], a[136:139], v[180:183], a[32:47]
    s_add_u32 s59, s59, s92
    v_exp_f32 v52, v52
    v_exp_f32 v53, v53
    v_exp_f32 v54, v54
    v_exp_f32 v55, v55
    v_cvt_pk_bf16_f32 v106, v52, v53
    v_cvt_pk_bf16_f32 v107, v54, v55
    v_mfma_f32_32x32x16_bf16 v[80:95], a[140:143], a[76:79], v[80:95]
    s_add_u32 s60, s60, s92
    v_exp_f32 v56, v56
    v_exp_f32 v57, v57
    v_exp_f32 v58, v58
    v_exp_f32 v59, v59
    v_cvt_pk_bf16_f32 v108, v56, v57
    v_cvt_pk_bf16_f32 v109, v58, v59
    v_mfma_f32_32x32x16_bf16 a[48:63], a[136:139], v[188:191], a[48:63]
    s_add_u32 s61, s60, 4096
    v_exp_f32 v60, v60
    v_exp_f32 v61, v61
    v_exp_f32 v62, v62
    v_exp_f32 v63, v63
    v_cvt_pk_bf16_f32 v110, v60, v61
    v_cvt_pk_bf16_f32 v111, v62, v63
    v_mfma_f32_32x32x4_2b_bf16 v[32:63], a[158:159], a[80:81], v[192:223]
    s_waitcnt vmcnt(0)
    v_exp_f32 v64, v64
    v_exp_f32 v65, v65
    v_exp_f32 v66, v66
    v_exp_f32 v67, v67
    v_exp_f32 v68, v68
    v_exp_f32 v69, v69
    v_exp_f32 v70, v70
    v_exp_f32 v71, v71
    v_cvt_pk_bf16_f32 v176, v64, v65
    v_cvt_pk_bf16_f32 v177, v66, v67
    v_cvt_pk_bf16_f32 v178, v68, v69
    v_cvt_pk_bf16_f32 v179, v70, v71
    v_mfma_f32_32x32x16_bf16 a[0:15], a[164:167], v[96:99], a[0:15]
    v_exp_f32 v72, v72
    v_exp_f32 v73, v73
    v_exp_f32 v74, v74
    v_exp_f32 v75, v75
    v_cvt_pk_bf16_f32 v180, v72, v73
    v_cvt_pk_bf16_f32 v181, v74, v75
    v_mfma_f32_32x32x16_bf16 a[16:31], a[164:167], v[104:107], a[16:31]
    s_mov_b32 m0, s66
    v_exp_f32 v76, v76
    v_exp_f32 v77, v77
    v_exp_f32 v78, v78
    v_exp_f32 v79, v79
    v_cvt_pk_bf16_f32 v182, v76, v77
    v_cvt_pk_bf16_f32 v183, v78, v79
    v_mfma_f32_32x32x16_bf16 v[32:47], a[144:147], a[64:67], v[32:47]
    v_exp_f32 v80, v80
    v_exp_f32 v81, v81
    v_exp_f32 v82, v82
    v_exp_f32 v83, v83
    v_cvt_pk_bf16_f32 v184, v80, v81
    v_cvt_pk_bf16_f32 v185, v82, v83
    v_mfma_f32_32x32x16_bf16 a[0:15], a[168:171], v[100:103], a[0:15]
    v_exp_f32 v84, v84
    v_exp_f32 v85, v85
    v_exp_f32 v86, v86
    v_exp_f32 v87, v87
    v_cvt_pk_bf16_f32 v186, v84, v85
    v_cvt_pk_bf16_f32 v187, v86, v87
    v_mfma_f32_32x32x16_bf16 v[48:63], a[144:147], a[68:71], v[48:63]
    v_exp_f32 v88, v88
    v_exp_f32 v89, v89
    v_exp_f32 v90, v90
    v_exp_f32 v91, v91
    v_cvt_pk_bf16_f32 v188, v88, v89
    v_cvt_pk_bf16_f32 v189, v90, v91
    v_mfma_f32_32x32x16_bf16 a[16:31], a[168:171], v[108:111], a[16:31]
    v_exp_f32 v92, v92
    v_exp_f32 v93, v93
    v_exp_f32 v94, v94
    v_exp_f32 v95, v95
    v_cvt_pk_bf16_f32 v190, v92, v93
    v_cvt_pk_bf16_f32 v191, v94, v95
    v_mfma_f32_32x32x4_2b_bf16 v[64:95], a[158:159], a[82:83], v[224:255]
    v_exp_f32 v32, v32
    v_exp_f32 v33, v33
    v_exp_f32 v34, v34
    v_exp_f32 v35, v35
    v_exp_f32 v36, v36
    v_exp_f32 v37, v37
    v_exp_f32 v38, v38
    v_exp_f32 v39, v39
    v_cvt_pk_bf16_f32 v96, v32, v33
    v_cvt_pk_bf16_f32 v97, v34, v35
    v_cvt_pk_bf16_f32 v98, v36, v37
    v_cvt_pk_bf16_f32 v99, v38, v39
    v_mfma_f32_32x32x16_bf16 a[32:47], a[164:167], v[176:179], a[32:47]
    v_exp_f32 v40, v40
    v_exp_f32 v41, v41
    v_exp_f32 v42, v42
    v_exp_f32 v43, v43
    v_cvt_pk_bf16_f32 v100, v40, v41
    v_cvt_pk_bf16_f32 v101, v42, v43
    v_mfma_f32_32x32x16_bf16 a[48:63], a[164:167], v[184:187], a[48:63]
    v_exp_f32 v44, v44
    v_exp_f32 v45, v45
    v_exp_f32 v46, v46
    v_exp_f32 v47, v47
    v_cvt_pk_bf16_f32 v102, v44, v45
    v_cvt_pk_bf16_f32 v103, v46, v47
    v_mfma_f32_32x32x16_bf16 v[64:79], a[144:147], a[72:75], v[64:79]
    v_exp_f32 v48, v48
    v_exp_f32 v49, v49
    v_exp_f32 v50, v50
    v_exp_f32 v51, v51
    v_cvt_pk_bf16_f32 v104, v48, v49
    v_cvt_pk_bf16_f32 v105, v50, v51
    v_mfma_f32_32x32x16_bf16 a[32:47], a[168:171], v[180:183], a[32:47]
    v_exp_f32 v52, v52
    v_exp_f32 v53, v53
    v_exp_f32 v54, v54
    v_exp_f32 v55, v55
    v_cvt_pk_bf16_f32 v106, v52, v53
    v_cvt_pk_bf16_f32 v107, v54, v55
    v_mfma_f32_32x32x16_bf16 v[80:95], a[144:147], a[76:79], v[80:95]
    v_exp_f32 v56, v56
    v_exp_f32 v57, v57
    v_exp_f32 v58, v58
    v_exp_f32 v59, v59
    v_cvt_pk_bf16_f32 v108, v56, v57
    v_cvt_pk_bf16_f32 v109, v58, v59
    v_mfma_f32_32x32x16_bf16 a[48:63], a[168:171], v[188:191], a[48:63]
    v_exp_f32 v60, v60
    v_exp_f32 v61, v61
    v_exp_f32 v62, v62
    v_exp_f32 v63, v63
    v_cvt_pk_bf16_f32 v110, v60, v61
    v_cvt_pk_bf16_f32 v111, v62, v63
    v_mfma_f32_32x32x4_2b_bf16 v[32:63], a[160:161], a[80:81], v[192:223]
    v_exp_f32 v64, v64
    v_exp_f32 v65, v65
    v_exp_f32 v66, v66
    v_exp_f32 v67, v67
    v_exp_f32 v68, v68
    v_exp_f32 v69, v69
    v_exp_f32 v70, v70
    v_exp_f32 v71, v71
    v_cvt_pk_bf16_f32 v176, v64, v65
    v_cvt_pk_bf16_f32 v177, v66, v67
    v_cvt_pk_bf16_f32 v178, v68, v69
    v_cvt_pk_bf16_f32 v179, v70, v71
    v_mfma_f32_32x32x16_bf16 a[0:15], a[172:175], v[96:99], a[0:15]
    buffer_load_dwordx4 a[100:103], v19, s[40:43], s59 offen offset:0
    buffer_load_dwordx4 a[104:107], v19, s[40:43], s59 offen offset:512
    buffer_load_dwordx4 a[84:87], v18, s[40:43], s58 offen offset:0
    buffer_load_dwordx4 a[88:91], v18, s[40:43], s58 offen offset:1024
    buffer_load_dwordx4 a[92:95], v18, s[40:43], s58 offen offset:2048
    buffer_load_dwordx4 a[96:99], v18, s[40:43], s58 offen offset:3072
    v_exp_f32 v72, v72
    v_exp_f32 v73, v73
    v_exp_f32 v74, v74
    v_exp_f32 v75, v75
    v_cvt_pk_bf16_f32 v180, v72, v73
    v_cvt_pk_bf16_f32 v181, v74, v75
    v_mfma_f32_32x32x16_bf16 a[16:31], a[172:175], v[104:107], a[16:31]
    v_exp_f32 v76, v76
    v_exp_f32 v77, v77
    v_exp_f32 v78, v78
    v_exp_f32 v79, v79
    v_cvt_pk_bf16_f32 v182, v76, v77
    v_cvt_pk_bf16_f32 v183, v78, v79
    v_mfma_f32_32x32x16_bf16 v[32:47], a[148:151], a[64:67], v[32:47]
    v_exp_f32 v80, v80
    v_exp_f32 v81, v81
    v_exp_f32 v82, v82
    v_exp_f32 v83, v83
    v_cvt_pk_bf16_f32 v184, v80, v81
    v_cvt_pk_bf16_f32 v185, v82, v83
    v_mfma_f32_32x32x16_bf16 a[0:15], a[176:179], v[100:103], a[0:15]
    v_exp_f32 v84, v84
    v_exp_f32 v85, v85
    v_exp_f32 v86, v86
    v_exp_f32 v87, v87
    v_cvt_pk_bf16_f32 v186, v84, v85
    v_cvt_pk_bf16_f32 v187, v86, v87
    v_mfma_f32_32x32x16_bf16 v[48:63], a[148:151], a[68:71], v[48:63]
    v_exp_f32 v88, v88
    v_exp_f32 v89, v89
    v_exp_f32 v90, v90
    v_exp_f32 v91, v91
    v_cvt_pk_bf16_f32 v188, v88, v89
    v_cvt_pk_bf16_f32 v189, v90, v91
    v_mfma_f32_32x32x16_bf16 a[16:31], a[176:179], v[108:111], a[16:31]
    v_exp_f32 v92, v92
    v_exp_f32 v93, v93
    v_exp_f32 v94, v94
    v_exp_f32 v95, v95
    v_cvt_pk_bf16_f32 v190, v92, v93
    v_cvt_pk_bf16_f32 v191, v94, v95
    v_mfma_f32_32x32x4_2b_bf16 v[64:95], a[160:161], a[82:83], v[224:255]
    v_exp_f32 v32, v32
    v_exp_f32 v33, v33
    v_exp_f32 v34, v34
    v_exp_f32 v35, v35
    v_exp_f32 v36, v36
    v_exp_f32 v37, v37
    v_exp_f32 v38, v38
    v_exp_f32 v39, v39
    v_cvt_pk_bf16_f32 v96, v32, v33
    v_cvt_pk_bf16_f32 v97, v34, v35
    v_cvt_pk_bf16_f32 v98, v36, v37
    v_cvt_pk_bf16_f32 v99, v38, v39
    v_mfma_f32_32x32x16_bf16 a[32:47], a[172:175], v[176:179], a[32:47]
    buffer_load_dwordx4 a[108:111], v20, s[40:43], s60 offen offset:0
    buffer_load_dwordx4 a[112:115], v20, s[40:43], s60 offen offset:1024
    buffer_load_dwordx4 a[116:119], v20, s[40:43], s60 offen offset:2048
    buffer_load_dwordx4 a[120:123], v20, s[40:43], s60 offen offset:3072
    v_exp_f32 v40, v40
    v_exp_f32 v41, v41
    v_exp_f32 v42, v42
    v_exp_f32 v43, v43
    v_cvt_pk_bf16_f32 v100, v40, v41
    v_cvt_pk_bf16_f32 v101, v42, v43
    v_mfma_f32_32x32x16_bf16 a[48:63], a[172:175], v[184:187], a[48:63]
    v_exp_f32 v44, v44
    v_exp_f32 v45, v45
    v_exp_f32 v46, v46
    v_exp_f32 v47, v47
    v_cvt_pk_bf16_f32 v102, v44, v45
    v_cvt_pk_bf16_f32 v103, v46, v47
    v_mfma_f32_32x32x16_bf16 v[64:79], a[148:151], a[72:75], v[64:79]
    v_exp_f32 v48, v48
    v_exp_f32 v49, v49
    v_exp_f32 v50, v50
    v_exp_f32 v51, v51
    v_cvt_pk_bf16_f32 v104, v48, v49
    v_cvt_pk_bf16_f32 v105, v50, v51
    v_mfma_f32_32x32x16_bf16 a[32:47], a[176:179], v[180:183], a[32:47]
    v_exp_f32 v52, v52
    v_exp_f32 v53, v53
    v_exp_f32 v54, v54
    v_exp_f32 v55, v55
    v_cvt_pk_bf16_f32 v106, v52, v53
    v_cvt_pk_bf16_f32 v107, v54, v55
    v_mfma_f32_32x32x16_bf16 v[80:95], a[148:151], a[76:79], v[80:95]
    v_exp_f32 v56, v56
    v_exp_f32 v57, v57
    v_exp_f32 v58, v58
    v_exp_f32 v59, v59
    v_cvt_pk_bf16_f32 v108, v56, v57
    v_cvt_pk_bf16_f32 v109, v58, v59
    v_mfma_f32_32x32x16_bf16 a[48:63], a[176:179], v[188:191], a[48:63]
    v_exp_f32 v60, v60
    v_exp_f32 v61, v61
    v_exp_f32 v62, v62
    v_exp_f32 v63, v63
    v_cvt_pk_bf16_f32 v110, v60, v61
    v_cvt_pk_bf16_f32 v111, v62, v63
    v_mfma_f32_32x32x4_2b_bf16 v[32:63], a[162:163], a[80:81], v[192:223]
    v_exp_f32 v64, v64
    v_exp_f32 v65, v65
    v_exp_f32 v66, v66
    v_exp_f32 v67, v67
    v_exp_f32 v68, v68
    v_exp_f32 v69, v69
    v_exp_f32 v70, v70
    v_exp_f32 v71, v71
    v_cvt_pk_bf16_f32 v176, v64, v65
    v_cvt_pk_bf16_f32 v177, v66, v67
    v_cvt_pk_bf16_f32 v178, v68, v69
    v_cvt_pk_bf16_f32 v179, v70, v71
    v_mfma_f32_32x32x16_bf16 a[0:15], a[180:183], v[96:99], a[0:15]
    buffer_load_dwordx4 a[124:127], v20, s[40:43], s61 offen offset:0
    buffer_load_dwordx4 a[128:131], v20, s[40:43], s61 offen offset:1024
    buffer_load_dwordx4 a[132:135], v20, s[40:43], s61 offen offset:2048
    buffer_load_dwordx4 a[136:139], v20, s[40:43], s61 offen offset:3072
    buffer_load_dwordx4 v4, s[40:43], s65 offen offset:0 lds
    v_exp_f32 v72, v72
    v_exp_f32 v73, v73
    v_exp_f32 v74, v74
    v_exp_f32 v75, v75
    v_cvt_pk_bf16_f32 v180, v72, v73
    v_cvt_pk_bf16_f32 v181, v74, v75
    v_mfma_f32_32x32x16_bf16 a[16:31], a[180:183], v[104:107], a[16:31]
    v_exp_f32 v76, v76
    v_exp_f32 v77, v77
    v_exp_f32 v78, v78
    v_exp_f32 v79, v79
    v_cvt_pk_bf16_f32 v182, v76, v77
    v_cvt_pk_bf16_f32 v183, v78, v79
    v_mfma_f32_32x32x16_bf16 v[32:47], a[152:155], a[64:67], v[32:47]
    v_exp_f32 v80, v80
    v_exp_f32 v81, v81
    v_exp_f32 v82, v82
    v_exp_f32 v83, v83
    v_cvt_pk_bf16_f32 v184, v80, v81
    v_cvt_pk_bf16_f32 v185, v82, v83
    v_mfma_f32_32x32x16_bf16 a[0:15], a[184:187], v[100:103], a[0:15]
    v_exp_f32 v84, v84
    v_exp_f32 v85, v85
    v_exp_f32 v86, v86
    v_exp_f32 v87, v87
    v_cvt_pk_bf16_f32 v186, v84, v85
    v_cvt_pk_bf16_f32 v187, v86, v87
    v_mfma_f32_32x32x16_bf16 v[48:63], a[152:155], a[68:71], v[48:63]
    v_exp_f32 v88, v88
    v_exp_f32 v89, v89
    v_exp_f32 v90, v90
    v_exp_f32 v91, v91
    v_cvt_pk_bf16_f32 v188, v88, v89
    v_cvt_pk_bf16_f32 v189, v90, v91
    v_mfma_f32_32x32x16_bf16 a[16:31], a[184:187], v[108:111], a[16:31]
    v_exp_f32 v92, v92
    v_exp_f32 v93, v93
    v_exp_f32 v94, v94
    v_exp_f32 v95, v95
    v_cvt_pk_bf16_f32 v190, v92, v93
    v_cvt_pk_bf16_f32 v191, v94, v95
    v_mfma_f32_32x32x4_2b_bf16 v[64:95], a[162:163], a[82:83], v[224:255]
    v_exp_f32 v32, v32
    v_exp_f32 v33, v33
    v_exp_f32 v34, v34
    v_exp_f32 v35, v35
    v_exp_f32 v36, v36
    v_exp_f32 v37, v37
    v_exp_f32 v38, v38
    v_exp_f32 v39, v39
    v_cvt_pk_bf16_f32 v96, v32, v33
    v_cvt_pk_bf16_f32 v97, v34, v35
    v_cvt_pk_bf16_f32 v98, v36, v37
    v_cvt_pk_bf16_f32 v99, v38, v39
    v_mfma_f32_32x32x16_bf16 a[32:47], a[180:183], v[176:179], a[32:47]
    buffer_load_dwordx4 v4, s[40:43], s65 offen offset:1024 lds
    buffer_load_dwordx4 v4, s[40:43], s65 offen offset:2048 lds
    v_exp_f32 v40, v40
    v_exp_f32 v41, v41
    v_exp_f32 v42, v42
    v_exp_f32 v43, v43
    v_cvt_pk_bf16_f32 v100, v40, v41
    v_cvt_pk_bf16_f32 v101, v42, v43
    v_mfma_f32_32x32x16_bf16 a[48:63], a[180:183], v[184:187], a[48:63]
    v_exp_f32 v44, v44
    v_exp_f32 v45, v45
    v_exp_f32 v46, v46
    v_exp_f32 v47, v47
    v_cvt_pk_bf16_f32 v102, v44, v45
    v_cvt_pk_bf16_f32 v103, v46, v47
    v_mfma_f32_32x32x16_bf16 v[64:79], a[152:155], a[72:75], v[64:79]
    v_exp_f32 v48, v48
    v_exp_f32 v49, v49
    v_exp_f32 v50, v50
    v_exp_f32 v51, v51
    v_cvt_pk_bf16_f32 v104, v48, v49
    v_cvt_pk_bf16_f32 v105, v50, v51
    v_mfma_f32_32x32x16_bf16 a[32:47], a[184:187], v[180:183], a[32:47]
    v_exp_f32 v52, v52
    v_exp_f32 v53, v53
    v_exp_f32 v54, v54
    v_exp_f32 v55, v55
    v_cvt_pk_bf16_f32 v106, v52, v53
    v_cvt_pk_bf16_f32 v107, v54, v55
    v_mfma_f32_32x32x16_bf16 v[80:95], a[152:155], a[76:79], v[80:95]
    v_exp_f32 v56, v56
    v_exp_f32 v57, v57
    v_exp_f32 v58, v58
    v_exp_f32 v59, v59
    v_cvt_pk_bf16_f32 v108, v56, v57
    v_cvt_pk_bf16_f32 v109, v58, v59
    v_mfma_f32_32x32x16_bf16 a[48:63], a[184:187], v[188:191], a[48:63]
    s_waitcnt vmcnt(11)
    v_exp_f32 v60, v60
    v_exp_f32 v61, v61
    v_exp_f32 v62, v62
    v_exp_f32 v63, v63
    v_cvt_pk_bf16_f32 v110, v60, v61
    v_cvt_pk_bf16_f32 v111, v62, v63
    v_mfma_f32_32x32x4_2b_bf16 v[32:63], a[100:101], a[80:81], v[192:223]
    v_exp_f32 v64, v64
    v_exp_f32 v65, v65
    v_exp_f32 v66, v66
    v_exp_f32 v67, v67
    v_exp_f32 v68, v68
    v_exp_f32 v69, v69
    v_exp_f32 v70, v70
    v_exp_f32 v71, v71
    v_cvt_pk_bf16_f32 v176, v64, v65
    v_cvt_pk_bf16_f32 v177, v66, v67
    v_cvt_pk_bf16_f32 v178, v68, v69
    v_cvt_pk_bf16_f32 v179, v70, v71
    v_mfma_f32_32x32x16_bf16 a[0:15], a[188:191], v[96:99], a[0:15]
    s_add_u32 s96, s96, 1
    v_exp_f32 v72, v72
    v_exp_f32 v73, v73
    v_exp_f32 v74, v74
    v_exp_f32 v75, v75
    v_cvt_pk_bf16_f32 v180, v72, v73
    v_cvt_pk_bf16_f32 v181, v74, v75
    v_mfma_f32_32x32x16_bf16 a[16:31], a[188:191], v[104:107], a[16:31]
    s_and_b32 s96, s96, 7
    v_exp_f32 v76, v76
    v_exp_f32 v77, v77
    v_exp_f32 v78, v78
    v_exp_f32 v79, v79
    v_cvt_pk_bf16_f32 v182, v76, v77
    v_cvt_pk_bf16_f32 v183, v78, v79
    v_mfma_f32_32x32x16_bf16 v[32:47], a[84:87], a[64:67], v[32:47]
    s_add_u32 s65, s65, 3072
    v_exp_f32 v80, v80
    v_exp_f32 v81, v81
    v_exp_f32 v82, v82
    v_exp_f32 v83, v83
    v_cvt_pk_bf16_f32 v184, v80, v81
    v_cvt_pk_bf16_f32 v185, v82, v83
    v_mfma_f32_32x32x16_bf16 a[0:15], a[192:195], v[100:103], a[0:15]
    s_add_u32 s66, s66, 3072
    v_exp_f32 v84, v84
    v_exp_f32 v85, v85
    v_exp_f32 v86, v86
    v_exp_f32 v87, v87
    v_cvt_pk_bf16_f32 v186, v84, v85
    v_cvt_pk_bf16_f32 v187, v86, v87
    v_mfma_f32_32x32x16_bf16 v[48:63], a[84:87], a[68:71], v[48:63]
    s_add_u32 s95, s95, 1
    v_exp_f32 v88, v88
    v_exp_f32 v89, v89
    v_exp_f32 v90, v90
    v_exp_f32 v91, v91
    v_cvt_pk_bf16_f32 v188, v88, v89
    v_cvt_pk_bf16_f32 v189, v90, v91
    v_mfma_f32_32x32x16_bf16 a[16:31], a[192:195], v[108:111], a[16:31]
    s_cmp_lt_u32 s95, 4
    v_exp_f32 v92, v92
    v_exp_f32 v93, v93
    v_exp_f32 v94, v94
    v_exp_f32 v95, v95
    v_cvt_pk_bf16_f32 v190, v92, v93
    v_cvt_pk_bf16_f32 v191, v94, v95
    s_cbranch_scc1 L_att_loop2
    v_mfma_f32_32x32x16_bf16 a[32:47], a[188:191], v[176:179], a[32:47]
    v_mfma_f32_32x32x16_bf16 a[48:63], a[188:191], v[184:187], a[48:63]
    v_mfma_f32_32x32x16_bf16 a[32:47], a[192:195], v[180:183], a[32:47]
    v_mfma_f32_32x32x16_bf16 a[48:63], a[192:195], v[188:191], a[48:63]
    s_mul_i32 s50, s71, 12800
    s_add_u32 s50, s50, s34
    s_add_u32 s50, s50, 4194304
    s_nop 15
    s_add_u32 s51, s50, 0
    buffer_load_dwordx4 v[192:195], v4, s[40:43], s51 offen
    s_add_u32 s51, s50, 1024
    buffer_load_dwordx4 v[196:199], v4, s[40:43], s51 offen
    s_add_u32 s51, s50, 2048
    buffer_load_dwordx4 v[200:203], v4, s[40:43], s51 offen
    s_add_u32 s51, s50, 3072
    buffer_load_dwordx4 v[204:207], v4, s[40:43], s51 offen
    s_add_u32 s51, s50, 4096
    buffer_load_dwordx4 v[208:211], v4, s[40:43], s51 offen
    s_add_u32 s51, s50, 5120
    buffer_load_dwordx4 v[212:215], v4, s[40:43], s51 offen
    s_add_u32 s51, s50, 6144
    buffer_load_dwordx4 v[216:219], v4, s[40:43], s51 offen
    s_add_u32 s51, s50, 7168
    buffer_load_dwordx4 v[220:223], v4, s[40:43], s51 offen
    s_add_u32 s51, s50, 8192
    buffer_load_dwordx4 v[224:227], v4, s[40:43], s51 offen
    s_add_u32 s51, s50, 9216
    buffer_load_dwordx4 v[228:231], v4, s[40:43], s51 offen
    s_add_u32 s51, s50, 10240
    buffer_load_dwordx4 v[232:235], v4, s[40:43], s51 offen
    s_add_u32 s51, s50, 11264
    buffer_load_dwordx4 v[236:239], v4, s[40:43], s51 offen
    s_add_u32 s51, s50, 12288
    buffer_load_dwordx4 v[240:243], v4, s[40:43], s51 offen
    s_add_u32 s51, s50, 51200
    buffer_load_dwordx4 v[244:247], v4, s[40:43], s51 offen
    s_add_u32 s51, s50, 52224
    buffer_load_dwordx4 v[248:251], v4, s[40:43], s51 offen
    s_add_u32 s51, s50, 53248
    buffer_load_dwordx4 v[252:255], v4, s[40:43], s51 offen
    s_add_u32 s51, s50, 54272
    buffer_load_dwordx4 v[160:163], v4, s[40:43], s51 offen
    s_add_u32 s51, s50, 55296
    buffer_load_dwordx4 v[164:167], v4, s[40:43], s51 offen
    s_add_u32 s51, s50, 56320
    buffer_load_dwordx4 v[168:171], v4, s[40:43], s51 offen
    s_add_u32 s51, s50, 57344
    buffer_load_dwordx4 v[172:175], v4, s[40:43], s51 offen
    s_add_u32 s51, s50, 58368
    buffer_load_dwordx4 a[216:219], v4, s[40:43], s51 offen
    s_add_u32 s51, s50, 59392
    buffer_load_dwordx4 a[220:223], v4, s[40:43], s51 offen
    s_add_u32 s51, s50, 60416
    buffer_load_dwordx4 a[224:227], v4, s[40:43], s51 offen
    s_add_u32 s51, s50, 61440
    buffer_load_dwordx4 a[228:231], v4, s[40:43], s51 offen
    s_add_u32 s51, s50, 62464
    buffer_load_dwordx4 a[232:235], v4, s[40:43], s51 offen
    s_add_u32 s51, s50, 63488
    buffer_load_dwordx4 a[236:239], v4, s[40:43], s51 offen
    s_branch L_att_done
.section .rodata,"a"
.p2align 6
.amdhsa_kernel interleave_layers__linear_attn_block__grouped_kv_mqa__prompt_kernel
  .amdhsa_next_free_vgpr 512
  .amdhsa_next_free_sgpr 102
  .amdhsa_accum_offset 256
  .amdhsa_group_segment_fixed_size 0
  .amdhsa_kernarg_size 88
  .amdhsa_user_sgpr_count 2
  .amdhsa_user_sgpr_kernarg_segment_ptr 1
  .amdhsa_system_sgpr_workgroup_id_x 1
.end_amdhsa_kernel
```
